```python
import torch

def _softmax(x, axis=-1):
    return torch.softmax(x, dim=axis)
def _gelu(x):
    return torch.nn.functional.gelu(x, approximate="tanh")
def _silu(x):
    return torch.nn.functional.silu(x)
def _sigmoid(x):
    return torch.sigmoid(x)
def _layernorm(x, axis=-1, eps=1e-5):
    m = x.mean(dim=axis, keepdim=True)
    v = x.var(dim=axis, keepdim=True, unbiased=False)
    return (x - m) / torch.sqrt(v + eps)
def _scatter_add(tgt, idx, src, axis=0):
    return tgt.clone().index_add_(axis, idx, src)
def _segment_sum(src, seg, n):
    out = torch.zeros((n,) + src.shape[1:], dtype=src.dtype)
    return out.index_add_(0, seg, src)
def _pad(x, pw):
    flat = tuple(v for pair in reversed(pw) for v in pair)
    return torch.nn.functional.pad(x, flat)

kernel_name = 'parallel_sum__sliding_local_dilated__dense_activation_relu__prompt'

def setup_inputs():

    _w = (lambda a: (lambda t: t.to(torch.bfloat16) if t.is_floating_point() else t)(torch.as_tensor(a)))
    def _A_setup():
        B, S, D = 1, 2048, 640
        return {
            "x": _w((lambda *s: torch.randn(*s, dtype=torch.bfloat16) * 0.05)(B, S, D)),
            "wqkv": _w((lambda *s: torch.randn(*s, dtype=torch.bfloat16) * 0.05)(D, 3 * D)),
            "wo": _w((lambda *s: torch.randn(*s, dtype=torch.bfloat16) * 0.05)(D, D)),
        }
    _A_in = _A_setup()

    def _B_setup():
        B, S, D, Dff = 1, 2048, 640, 1536
        return {
            "x": _w((lambda *s: torch.randn(*s, dtype=torch.bfloat16) * 0.05)(B, S, D)),
            "w1": _w((lambda *s: torch.randn(*s, dtype=torch.bfloat16) * 0.05)(D, Dff)),
            "w2": _w((lambda *s: torch.randn(*s, dtype=torch.bfloat16) * 0.05)(Dff, D)),
        }
    _B_in = _B_setup()

    return {
        "A_x": _A_in["x"],
        "A_wqkv": _A_in["wqkv"],
        "A_wo": _A_in["wo"],
        "B_x": _B_in["x"],
        "B_w1": _B_in["w1"],
        "B_w2": _B_in["w2"],
    }

def reference(A_x, A_wqkv, A_wo, B_x, B_w1, B_w2):
    def _A_ref(x, wqkv, wo):
        B, S, D = x.shape
        H = 32; Dh = D // H
        W, dil = 8, 2
        qkv = (lambda x, *d: x.permute(*d))((x @ wqkv).reshape(B, S, 3, H, Dh), 2, 0, 3, 1, 4)
        q, k, v = qkv[0], qkv[1], qkv[2]
        scale = Dh ** -0.5
        pos = torch.arange(S)
        off = torch.arange(W) * dil
        idx = pos[:, None] - off[None, :]
        mask = idx >= 0
        idx_c = torch.where(mask, idx, 0).reshape(-1)
        kg = k[:, :, idx_c, :].reshape(B, H, S, W, Dh)
        vg = v[:, :, idx_c, :].reshape(B, H, S, W, Dh)
        logits = torch.einsum("bhsd,bhswd->bhsw", q, kg) * scale
        logits = torch.where(mask[None, None, :, :], logits, -1e9)
        attn = _softmax(logits, axis=-1)
        o = torch.einsum("bhsw,bhswd->bhsd", attn, vg)
        return (lambda x, *d: x.permute(*d))(o, 0, 2, 1, 3).reshape(B, S, D) @ wo

    def _B_ref(x, w1, w2):
        h = torch.einsum("bsd,df->bsf", x, w1)
        zero = torch.zeros_like(h)
        h = torch.maximum(h, zero)
        return torch.einsum("bsf,fd->bsd", h, w2)

    x = A_x
    xn = _layernorm(x, axis=-1)
    return x + _A_ref(xn, A_wqkv, A_wo) + _B_ref(xn, B_w1, B_w2)
```

```asm
; @launch grid=(256,1,1) block=(512,1,1) lds=163840
.amdgcn_target "amdgcn-amd-amdhsa--gfx950"
.text
.globl parallel_sum__sliding_local_dilated__dense_activation_relu__prompt_kernel
.p2align 8
.type parallel_sum__sliding_local_dilated__dense_activation_relu__prompt_kernel,@function
parallel_sum__sliding_local_dilated__dense_activation_relu__prompt_kernel:
    s_cmp_ge_u32 s2, 256
    s_cbranch_scc1 L_end_a
    s_load_dwordx4 s[4:7], s[0:1], 0
    s_load_dwordx2 s[8:9], s[0:1], 16
    s_load_dwordx4 s[12:15], s[0:1], 32
    s_load_dwordx4 s[16:19], s[0:1], 48
    s_load_dwordx2 s[10:11], s[0:1], 64
    v_lshrrev_b32 v1, 6, v0
    v_and_b32 v0, 63, v0
    v_readfirstlane_b32 s52, v1
    s_bfe_u32 s60, s2, 0x20001
    s_bfe_u32 s61, s2, 0x20003
    s_lshl2_add_u32 s54, s60, s61
    s_and_b32 s60, s2, 1
    s_bfe_u32 s62, s2, 0x20005
    s_lshl2_add_u32 s55, s60, s62
    s_lshr_b32 s64, s2, 7
    s_mul_i32 s58, s54, 7
    s_mul_i32 s61, s64, 1
    s_add_u32 s58, s58, s61
    s_mul_i32 s61, s58, 205
    s_lshr_b32 s61, s61, 11
    s_mul_i32 s61, s61, 10
    s_sub_u32 s58, s58, s61
    s_and_b32 s53, s52, 3
    s_cmp_ge_u32 s52, 4
    s_cbranch_scc1 L_helper_a
    s_cmp_eq_u32 s64, 0
    s_cbranch_scc1 L_QC_a
    s_branch L_HC_a
L_helper_a:
    s_setprio 1
    s_cmp_eq_u32 s64, 0
    s_cbranch_scc0 L_HH_a
    v_lshrrev_b32 v2, 3, v0
    v_mul_u32_u24 v2, 1280, v2
    v_and_b32 v3, 7, v0
    v_lshrrev_b32 v4, 4, v0
    v_xor_b32 v3, v3, v4
    v_lshl_add_u32 v6, v3, 4, v2
    v_xor_b32 v7, 64, v6
    s_lshl_b32 s60, s54, 7
    s_lshl_b32 s61, s53, 5
    s_add_u32 s60, s60, s61
    s_sub_u32 s60, s60, 16
    s_mul_i32 s81, s60, 1280
    s_mul_i32 s80, s55, 160
    s_movk_i32 s59, 1120
    s_mul_i32 s69, s53, 4
    s_lshl_b32 s3, s53, 12
    s_add_u32 s3, s3, 30720
    s_add_u32 s60, s81, 0
    v_add_u32 v14, s60, v6
    s_lshl_b32 s66, s58, 7
    s_waitcnt lgkmcnt(0)
    s_mov_b32 s20, s4
    s_mov_b32 s21, s5
    s_mov_b32 s22, 2621440
    s_mov_b32 s23, 0x20000
    s_add_u32 m0, s3, 0
    s_add_u32 s60, s81, 10240
    v_add_u32 v15, s60, v7
    buffer_load_dwordx4 v14, s[20:23], s66 offen lds
    s_add_u32 m0, s3, 1024
    s_add_u32 s60, s81, 20480
    v_add_u32 v16, s60, v6
    buffer_load_dwordx4 v15, s[20:23], s66 offen lds
    s_add_u32 m0, s3, 2048
    s_add_u32 s60, s81, 30720
    v_add_u32 v17, s60, v7
    buffer_load_dwordx4 v16, s[20:23], s66 offen lds
    s_add_u32 m0, s3, 3072
    s_nop 0
    buffer_load_dwordx4 v17, s[20:23], s66 offen lds
    s_add_u32 s60, s81, 40960
    v_add_u32 v18, s60, v6
    s_add_u32 s60, s81, 51200
    v_add_u32 v19, s60, v7
    s_add_u32 s60, s69, 0
    s_lshl_b32 s60, s60, 6
    v_add_u32 v2, s60, v0
    v_mul_u32_u24 v3, 2185, v2
    v_lshrrev_b32 v3, 16, v3
    v_mul_u32_u24 v4, 30, v3
    v_sub_u32 v2, v2, v4
    v_and_b32 v4, 4, v3
    v_add_u32 v5, v3, v4
    v_bfe_u32 v4, v3, 3, 1
    v_mad_i32_i24 v5, v4, -4, v5
    v_mul_u32_u24 v5, 3840, v5
    v_mul_u32_u24 v4, 26, v2
    v_lshrrev_b32 v4, 8, v4
    v_mad_u32_u24 v5, v4, s59, v5
    v_lshl_add_u32 v5, v2, 4, v5
    v_add_u32 v11, s80, v5
    s_mov_b32 s24, s6
    s_mov_b32 s25, s7
    s_mov_b32 s26, 2457600
    s_mov_b32 s27, 0x20000
    s_cmp_lt_u32 s53, 3
    s_cselect_b32 s44, s6, s4
    s_cselect_b32 s45, s7, s5
    s_mov_b32 s46, 2457600
    s_cselect_b32 s46, s46, s22
    s_mov_b32 s47, 0x20000
    s_movk_i32 s74, 3072
    s_cselect_b32 s74, s74, 4096
    s_movk_i32 s75, 18432
    s_cselect_b32 s75, s75, 5120
    s_mov_b32 s63, s69
    s_lshl_b32 s69, s69, 10
    s_mov_b32 s68, 0
    s_mov_b32 s64, 0
    s_mov_b32 s76, 0
    s_mov_b32 s100, s58
    s_cmp_ge_u32 s58, 10
    s_cselect_b32 s60, 10, 0
    s_sub_u32 s58, s58, s60
    s_mul_i32 s65, s58, 245760
    s_lshl_b32 s66, s58, 7
    s_add_u32 s58, s58, 1
    s_add_u32 s77, s68, s69
    s_add_u32 s81, s68, s3
    s_cmp_lt_u32 s53, 3
    s_cselect_b32 s70, s64, s66
    s_cselect_b32 s72, s65, s66
    s_cselect_b32 s71, s76, s81
    s_cselect_b32 s73, s77, s81
    s_add_u32 s71, s71, s74
    s_add_u32 s73, s73, s75
    s_mov_b32 s67, s69
    s_mov_b32 s69, s63
    s_add_u32 m0, s77, 15360
    s_nop 0
    buffer_load_dwordx4 v11, s[24:27], s65 offen lds
    v_add_u32 v8, 122880, v11
    s_add_u32 s60, s69, 1
    s_lshl_b32 s60, s60, 6
    v_add_u32 v2, s60, v0
    v_mul_u32_u24 v3, 2185, v2
    v_lshrrev_b32 v3, 16, v3
    v_mul_u32_u24 v4, 30, v3
    v_sub_u32 v2, v2, v4
    v_and_b32 v4, 4, v3
    v_add_u32 v5, v3, v4
    v_bfe_u32 v4, v3, 3, 1
    v_mad_i32_i24 v5, v4, -4, v5
    v_mul_u32_u24 v5, 3840, v5
    v_mul_u32_u24 v4, 26, v2
    v_lshrrev_b32 v4, 8, v4
    v_mad_u32_u24 v5, v4, s59, v5
    v_lshl_add_u32 v5, v2, 4, v5
    v_add_u32 v12, s80, v5
    s_add_u32 m0, s77, 16384
    s_nop 0
    buffer_load_dwordx4 v12, s[24:27], s65 offen lds
    v_add_u32 v9, 122880, v12
    s_add_u32 s60, s69, 2
    s_lshl_b32 s60, s60, 6
    v_add_u32 v2, s60, v0
    v_mul_u32_u24 v3, 2185, v2
    v_lshrrev_b32 v3, 16, v3
    v_mul_u32_u24 v4, 30, v3
    v_sub_u32 v2, v2, v4
    v_and_b32 v4, 4, v3
    v_add_u32 v5, v3, v4
    v_bfe_u32 v4, v3, 3, 1
    v_mad_i32_i24 v5, v4, -4, v5
    v_mul_u32_u24 v5, 3840, v5
    v_mul_u32_u24 v4, 26, v2
    v_lshrrev_b32 v4, 8, v4
    v_mad_u32_u24 v5, v4, s59, v5
    v_lshl_add_u32 v5, v2, 4, v5
    v_add_u32 v13, s80, v5
    s_add_u32 m0, s77, 17408
    s_nop 0
    buffer_load_dwordx4 v13, s[24:27], s65 offen lds
    v_add_u32 v10, 122880, v13
    s_cmp_lt_u32 s53, 3
    s_cbranch_scc0 L_fx_1
    s_add_u32 s60, s69, 3
    s_lshl_b32 s60, s60, 6
    v_add_u32 v2, s60, v0
    v_mul_u32_u24 v3, 2185, v2
    v_lshrrev_b32 v3, 16, v3
    v_mul_u32_u24 v4, 30, v3
    v_sub_u32 v2, v2, v4
    v_and_b32 v4, 4, v3
    v_add_u32 v5, v3, v4
    v_bfe_u32 v4, v3, 3, 1
    v_mad_i32_i24 v5, v4, -4, v5
    v_mul_u32_u24 v5, 3840, v5
    v_mul_u32_u24 v4, 26, v2
    v_lshrrev_b32 v4, 8, v4
    v_mad_u32_u24 v5, v4, s59, v5
    v_lshl_add_u32 v5, v2, 4, v5
    v_add_u32 v19, s80, v5
    v_add_u32 v18, 122880, v19
    s_branch L_fd_2
L_fx_1:
    s_add_u32 m0, s71, 0
    s_nop 0
    buffer_load_dwordx4 v18, s[44:47], s70 offen lds
L_fd_2:
    s_add_u32 m0, s73, 0
    s_nop 0
    buffer_load_dwordx4 v19, s[44:47], s72 offen lds
    s_mov_b32 s69, s67
    s_mov_b32 s67, s100
    s_mov_b32 s64, s65
    s_add_u32 s76, s68, s69
    s_add_u32 s68, s68, 49152
    s_cmp_ge_u32 s68, 147456
    s_cselect_b32 s68, 0, s68
    s_cmp_ge_u32 s58, 10
    s_cselect_b32 s60, 10, 0
    s_sub_u32 s58, s58, s60
    s_mul_i32 s65, s58, 245760
    s_lshl_b32 s66, s58, 7
    s_add_u32 s58, s58, 1
    s_add_u32 s77, s68, s69
    s_add_u32 s81, s68, s3
    s_cmp_lt_u32 s53, 3
    s_cselect_b32 s70, s64, s66
    s_cselect_b32 s72, s65, s66
    s_cselect_b32 s71, s76, s81
    s_cselect_b32 s73, s77, s81
    s_add_u32 s71, s71, s74
    s_add_u32 s73, s73, s75
    s_add_u32 m0, s76, 0
    s_nop 0
    buffer_load_dwordx4 v8, s[24:27], s64 offen lds
    s_add_u32 m0, s76, 1024
    s_nop 0
    buffer_load_dwordx4 v9, s[24:27], s64 offen lds
    s_add_u32 m0, s76, 2048
    s_nop 0
    buffer_load_dwordx4 v10, s[24:27], s64 offen lds
    s_add_u32 m0, s71, 0
    s_nop 0
    buffer_load_dwordx4 v18, s[44:47], s70 offen lds
    s_add_u32 m0, s81, 0
    s_mov_b32 s64, s65
    buffer_load_dwordx4 v14, s[20:23], s66 offen lds
    s_add_u32 m0, s81, 1024
    s_add_u32 s76, s68, s69
    buffer_load_dwordx4 v15, s[20:23], s66 offen lds
    s_and_b32 s63, s55, 1
    s_lshl1_add_u32 s56, s54, s63
    s_lshr_b32 s57, s55, 1
    s_and_b32 s63, s57, 1
    s_lshr_b32 s61, s2, 7
    s_and_b32 s60, s56, 7
    s_lshl1_add_u32 s63, s61, s63
    s_mul_i32 s61, s60, 3
    s_lshr_b32 s61, s61, 1
    s_mul_i32 s78, s63, 3
    s_add_u32 s78, s78, s61
    s_mul_i32 s60, s60, 5
    s_lshr_b32 s60, s60, 3
    s_add_u32 s79, s60, s63
    s_mov_b32 s28, s14
    s_mov_b32 s29, s15
    s_mov_b32 s30, 1966080
    s_mov_b32 s31, 0x20000
    s_mov_b32 s32, s8
    s_mov_b32 s33, s9
    s_mov_b32 s34, 819200
    s_mov_b32 s35, 0x20000
    s_mov_b32 s36, s10
    s_mov_b32 s37, s11
    s_mov_b32 s38, 33554432
    s_mov_b32 s39, 0x20000
    s_mov_b32 s40, s18
    s_mov_b32 s41, s19
    s_mov_b32 s42, 256
    s_mov_b32 s43, 0x20000
    s_lshl_b32 s57, s57, 7
    s_add_u32 s57, s57, 768
    v_lshrrev_b32 v2, 3, v0
    v_and_b32 v3, 6, v2
    v_and_b32 v4, 7, v0
    v_xor_b32 v3, v3, v4
    v_mul_u32_u24 v2, 1280, v2
    v_lshl_add_u32 v2, v3, 4, v2
    s_mul_i32 s60, s53, 20480
    s_add_u32 s60, s60, s57
    v_add_u32 v48, s60, v2
    v_add_u32 v49, 9216, v48
    s_lshl_b32 s7, s53, 11
    v_lshl_add_u32 v51, v0, 4, s7
    s_lshr_b32 s16, s55, 2
    s_xor_b32 s17, s16, 1
    s_lshl_b32 s60, s54, 9
    s_add_u32 s60, s60, 16777216
    s_lshl_b32 s61, s17, 7
    s_add_u32 s61, s61, s60
    v_mov_b32 v52, s61
    v_xor_b32 v53, 128, v52
    s_mul_i32 s6, s53, 2048
    s_bfe_u32 s60, s2, 0x40003
    s_lshl2_add_u32 s60, s60, s53
    v_mul_u32_u24 v2, 52, v0
    v_lshrrev_b32 v2, 8, v2
    v_mul_u32_u24 v3, 5, v2
    v_sub_u32 v3, v0, v3
    s_lshl_b32 s61, s16, 7
    s_sub_u32 s61, 384, s61
    v_mov_b32 v4, s61
    v_cmp_le_u32 vcc, 3, v3
    s_nop 1
    v_cndmask_b32 v4, 0, v4, vcc
    v_lshl_add_u32 v3, v3, 7, v4
    s_movk_i32 s63, 1280
    v_min_u32 v4, 11, v2
    v_min_u32 v2, 9, v2
    v_mad_u32_u24 v4, v4, s63, v3
    v_mad_u32_u24 v2, v2, s63, v3
    s_mul_i32 s61, s16, 983424
    s_mul_i32 s62, s60, 15360
    s_add_u32 s61, s61, s62
    v_add_u32 v42, s61, v4
    s_mul_i32 s61, s16, 384
    s_mul_i32 s62, s60, 12800
    s_add_u32 s61, s61, s62
    v_add_u32 v43, s61, v2
    s_lshl_b32 s60, s54, 7
    s_add_u32 s60, s60, 16785408
    v_mov_b32 v20, s60
    v_mov_b32 v23, 0
    v_mov_b32 v25, 16
    s_lshl_b32 s61, s54, 7
    s_lshl_b32 s62, s53, 5
    s_add_u32 s61, s61, s62
    v_and_b32 v3, 31, v0
    v_add_u32 v21, s61, v3
    s_lshl_b32 s62, s53, 7
    s_add_u32 s62, s62, 160832
    v_lshl_add_u32 v22, v3, 2, s62
    v_mov_b32 v57, v20
    s_cmp_eq_u32 s54, 0
    s_cselect_b32 s62, 0, 128
    s_sub_u32 s60, s60, s62
    v_mov_b32 v4, s60
    s_lshl_b32 s61, s54, 7
    s_sub_u32 s61, s61, 16
    v_and_b32 v2, 15, v0
    v_add_u32 v3, s61, v2
    s_mov_b32 s61, 160768
    v_lshl_add_u32 v5, v2, 2, s61
    v_cmp_le_u32 vcc, 32, v0
    s_nop 1
    v_cndmask_b32 v20, v20, v4, vcc
    v_cndmask_b32 v21, v21, v3, vcc
    v_cndmask_b32 v22, v22, v5, vcc
    v_cmp_gt_i32 vcc, 0, v21
    v_lshlrev_b32 v21, 3, v21
    v_add_u32 v21, 18874368, v21
    v_mov_b32 v3, -16
    v_cndmask_b32 v21, v21, v3, vcc
    s_add_u32 s60, s55, 0
    s_lshl_b32 s61, s60, 7
    s_add_u32 s61, s61, 16787456
    v_mov_b32 v31, s61
    v_mov_b32 v4, 10
    v_cmp_le_u32 vcc, 48, v0
    s_nop 1
    v_cndmask_b32 v20, v20, v31, vcc
    v_cndmask_b32 v25, v25, v4, vcc
    s_mul_i32 s9, s60, 10240
    s_add_u32 s9, s9, 19922944
    s_lshl_b32 s61, s53, 8
    s_add_u32 s62, s9, s61
    v_lshl_add_u32 v28, v0, 2, s62
    s_add_u32 s61, s61, 161920
    v_lshl_add_u32 v29, v0, 2, s61
    v_bfe_u32 v2, v0, 2, 3
    v_lshrrev_b32 v3, 5, v0
    v_lshl_add_u32 v3, v3, 4, v2
    v_mul_u32_u24 v3, 480, v3
    v_and_b32 v4, 3, v0
    v_lshl_add_u32 v3, v4, 3, v3
    s_mul_i32 s61, s53, 4
    s_lshl_b32 s62, s61, 5
    v_add_u32 v44, s62, v3
    s_lshl_b32 s61, s61, 6
    s_lshl_b32 s62, s67, 10
    s_add_u32 s61, s61, s62
    s_add_u32 s61, s61, s9
    v_lshrrev_b32 v2, 4, v0
    v_lshl_add_u32 v47, v2, 4, s61
    v_mov_b32 v60, 0x3f803f80
    v_mov_b32 v61, 0x3f803f80
    v_mov_b32 v62, 0x3f803f80
    v_mov_b32 v63, 0x3f803f80
    s_waitcnt vmcnt(2)
    s_barrier
    s_add_u32 m0, s81, 2048
    s_add_u32 s68, s68, 49152
    s_cmp_ge_u32 s68, 147456
    s_cselect_b32 s68, 0, s68
    buffer_load_dwordx4 v16, s[20:23], s66 offen lds
    s_add_u32 m0, s81, 3072
    s_cmp_ge_u32 s58, 10
    s_cselect_b32 s60, 10, 0
    s_sub_u32 s58, s58, s60
    s_mul_i32 s12, s58, 245760
    s_add_u32 s13, s68, s69
    buffer_load_dwordx4 v17, s[20:23], s66 offen lds
    s_add_u32 m0, s73, 0
    s_nop 0
    buffer_load_dwordx4 v19, s[44:47], s72 offen lds
    s_add_u32 m0, s77, 15360
    s_lshl_b32 s66, s58, 7
    s_add_u32 s58, s58, 1
    s_add_u32 s81, s68, s3
    buffer_load_dwordx4 v11, s[24:27], s65 offen lds
    s_add_u32 m0, s77, 16384
    s_cmp_lt_u32 s53, 3
    s_cselect_b32 s70, s64, s66
    s_cselect_b32 s72, s12, s66
    s_cselect_b32 s71, s76, s81
    s_cselect_b32 s73, s13, s81
    buffer_load_dwordx4 v12, s[24:27], s65 offen lds
    s_add_u32 m0, s77, 17408
    s_add_u32 s71, s71, s74
    s_add_u32 s73, s73, s75
    buffer_load_dwordx4 v13, s[24:27], s65 offen lds
    s_mov_b32 s65, s12
    s_mov_b32 s77, s13
    s_mov_b32 s59, 0
L_hl_3:
    s_add_u32 m0, s76, 0
    s_nop 0
    buffer_load_dwordx4 v8, s[24:27], s64 offen lds
    s_add_u32 m0, s76, 1024
    s_nop 0
    buffer_load_dwordx4 v9, s[24:27], s64 offen lds
    s_add_u32 m0, s76, 2048
    s_nop 0
    buffer_load_dwordx4 v10, s[24:27], s64 offen lds
    s_add_u32 m0, s71, 0
    s_nop 0
    buffer_load_dwordx4 v18, s[44:47], s70 offen lds
    s_add_u32 m0, s81, 0
    s_mov_b32 s64, s65
    buffer_load_dwordx4 v14, s[20:23], s66 offen lds
    s_add_u32 m0, s81, 1024
    s_add_u32 s76, s68, s69
    buffer_load_dwordx4 v15, s[20:23], s66 offen lds
    s_add_u32 m0, s81, 2048
    s_add_u32 s68, s68, 49152
    s_cmp_ge_u32 s68, 147456
    s_cselect_b32 s68, 0, s68
    buffer_load_dwordx4 v16, s[20:23], s66 offen lds
    s_add_u32 m0, s81, 3072
    s_cmp_ge_u32 s58, 10
    s_cselect_b32 s60, 10, 0
    s_sub_u32 s58, s58, s60
    s_mul_i32 s12, s58, 245760
    s_add_u32 s13, s68, s69
    buffer_load_dwordx4 v17, s[20:23], s66 offen lds
    s_add_u32 m0, s73, 0
    s_nop 0
    buffer_load_dwordx4 v19, s[44:47], s72 offen lds
    s_add_u32 m0, s77, 15360
    s_lshl_b32 s66, s58, 7
    s_add_u32 s58, s58, 1
    s_add_u32 s81, s68, s3
    buffer_load_dwordx4 v11, s[24:27], s65 offen lds
    s_add_u32 m0, s77, 16384
    s_cmp_lt_u32 s53, 3
    s_cselect_b32 s70, s64, s66
    s_cselect_b32 s72, s12, s66
    s_cselect_b32 s71, s76, s81
    s_cselect_b32 s73, s13, s81
    buffer_load_dwordx4 v12, s[24:27], s65 offen lds
    s_add_u32 m0, s77, 17408
    s_add_u32 s71, s71, s74
    s_add_u32 s73, s73, s75
    buffer_load_dwordx4 v13, s[24:27], s65 offen lds
    s_mov_b32 s65, s12
    s_mov_b32 s77, s13
    s_bitcmp1_b32 103, s59
    s_cbranch_scc1 L_dsp_11
L_wt_4:
    s_waitcnt vmcnt(8)
L_bar_5:
    s_add_u32 s59, s59, 1
    s_cmp_lt_u32 s59, 8
    s_barrier
    s_cbranch_scc1 L_hl_3
    s_branch L_c8_12
L_dsp_11:
    s_cmp_eq_u32 s59, 1
    s_cbranch_scc1 L_x_7
    s_cmp_eq_u32 s59, 2
    s_cbranch_scc1 L_x_8
    s_cmp_eq_u32 s59, 5
    s_cbranch_scc1 L_x_9
    s_cmp_eq_u32 s59, 6
    s_cbranch_scc1 L_x_10
L_x_6:
    buffer_load_dword v24, v23, s[40:43], 0 offen sc0 sc1
    s_cmp_ge_u32 s54, 10
    s_cbranch_scc1 L_np_13
    ds_read_b64_tr_b16 v[64:65], v44 offset:15360
    ds_read_b64_tr_b16 v[66:67], v44 offset:19200
    ds_read_b64_tr_b16 v[68:69], v44 offset:0
    ds_read_b64_tr_b16 v[70:71], v44 offset:3840
    ds_read_b64_tr_b16 v[72:73], v44 offset:15392
    ds_read_b64_tr_b16 v[74:75], v44 offset:19232
    ds_read_b64_tr_b16 v[76:77], v44 offset:32
    ds_read_b64_tr_b16 v[78:79], v44 offset:3872
    ds_read_b64_tr_b16 v[80:81], v44 offset:15424
    ds_read_b64_tr_b16 v[82:83], v44 offset:19264
    ds_read_b64_tr_b16 v[84:85], v44 offset:64
    ds_read_b64_tr_b16 v[86:87], v44 offset:3904
    ds_read_b64_tr_b16 v[88:89], v44 offset:15456
    ds_read_b64_tr_b16 v[90:91], v44 offset:19296
    ds_read_b64_tr_b16 v[92:93], v44 offset:96
    ds_read_b64_tr_b16 v[94:95], v44 offset:3936
    s_waitcnt lgkmcnt(0)
    v_mfma_f32_16x16x32_bf16 v[96:99], v[64:67], v[60:63], 0
    v_mfma_f32_16x16x32_bf16 v[100:103], v[72:75], v[60:63], 0
    v_mfma_f32_16x16x32_bf16 v[104:107], v[80:83], v[60:63], 0
    v_mfma_f32_16x16x32_bf16 v[108:111], v[88:91], v[60:63], 0
    v_mfma_f32_16x16x32_bf16 v[96:99], v[68:71], v[60:63], v[96:99]
    v_mfma_f32_16x16x32_bf16 v[100:103], v[76:79], v[60:63], v[100:103]
    v_mfma_f32_16x16x32_bf16 v[104:107], v[84:87], v[60:63], v[104:107]
    v_mfma_f32_16x16x32_bf16 v[108:111], v[92:95], v[60:63], v[108:111]
    s_mov_b32 exec_lo, 0x10001
    s_mov_b32 exec_hi, 0x10001
    s_nop 2
    buffer_store_dwordx4 v[96:99], v47, s[36:39], 0 offen offset:0 sc0 sc1
    buffer_store_dwordx4 v[100:103], v47, s[36:39], 0 offen offset:64 sc0 sc1
    buffer_store_dwordx4 v[104:107], v47, s[36:39], 0 offen offset:128 sc0 sc1
    buffer_store_dwordx4 v[108:111], v47, s[36:39], 0 offen offset:192 sc0 sc1
    s_mov_b64 exec, -1
    s_waitcnt vmcnt(13)
    s_branch L_bar_5
L_np_13:
    s_waitcnt vmcnt(9)
    s_branch L_bar_5
L_x_7:
    s_waitcnt vmcnt(12)
    v_cmp_gt_u32 vcc, 1, v24
    s_nop 4
    s_cbranch_vccz L_sd_15
    s_mov_b32 s61, 20000
L_sp_14:
    buffer_load_dword v24, v23, s[40:43], 0 offen offset:0 sc0 sc1
    s_waitcnt vmcnt(0)
    v_cmp_gt_u32 vcc, 1, v24
    s_nop 4
    s_cbranch_vccz L_sd_15
    s_sub_u32 s61, s61, 1
    s_cbranch_scc0 L_sp_14
L_sd_15:
    s_cmp_lg_u32 s53, 0
    s_cbranch_scc1 L_wt_4
    v_mov_b32 v2, 1
    s_mov_b64 exec, 1
    buffer_atomic_add v2, v57, s[36:39], 0 offen sc1
    s_mov_b64 exec, -1
    s_waitcnt vmcnt(9)
    s_branch L_bar_5
L_x_8:
    s_cmp_ge_u32 s54, 10
    s_cselect_b32 s60, 1, s53
    s_cmp_lg_u32 s60, 0
    s_cbranch_scc1 L_wt_4
    v_mov_b32 v2, 1
    s_mov_b64 exec, 1
    buffer_atomic_add v2, v31, s[36:39], 0 offen sc1
    s_mov_b64 exec, -1
    s_waitcnt vmcnt(9)
    s_branch L_bar_5
L_x_9:
    buffer_load_dword v24, v20, s[36:39], 0 offen sc0 sc1
    s_waitcnt vmcnt(9)
    s_branch L_bar_5
L_x_10:
    s_waitcnt vmcnt(12)
    v_cmp_gt_u32 vcc, v25, v24
    s_nop 4
    s_cbranch_vccz L_sd_17
    s_mov_b32 s61, 20000
L_sp_16:
    buffer_load_dword v24, v20, s[36:39], 0 offen offset:0 sc0 sc1
    s_waitcnt vmcnt(0)
    v_cmp_gt_u32 vcc, v25, v24
    s_nop 4
    s_cbranch_vccz L_sd_17
    s_sub_u32 s61, s61, 1
    s_cbranch_scc0 L_sp_16
L_sd_17:
    buffer_load_dwordx2 v[26:27], v21, s[36:39], 0 offen sc0 sc1
    s_movk_i32 s60, 0
    buffer_load_dword v32, v28, s[36:39], s60 offen sc0 sc1
    s_movk_i32 s60, 1024
    buffer_load_dword v33, v28, s[36:39], s60 offen sc0 sc1
    s_movk_i32 s60, 2048
    buffer_load_dword v34, v28, s[36:39], s60 offen sc0 sc1
    s_movk_i32 s60, 3072
    buffer_load_dword v35, v28, s[36:39], s60 offen sc0 sc1
    s_movk_i32 s60, 4096
    buffer_load_dword v36, v28, s[36:39], s60 offen sc0 sc1
    s_movk_i32 s60, 5120
    buffer_load_dword v37, v28, s[36:39], s60 offen sc0 sc1
    s_movk_i32 s60, 6144
    buffer_load_dword v38, v28, s[36:39], s60 offen sc0 sc1
    s_movk_i32 s60, 7168
    buffer_load_dword v39, v28, s[36:39], s60 offen sc0 sc1
    s_movk_i32 s60, 8192
    buffer_load_dword v40, v28, s[36:39], s60 offen sc0 sc1
    s_movk_i32 s60, 9216
    buffer_load_dword v41, v28, s[36:39], s60 offen sc0 sc1
    s_waitcnt vmcnt(19)
    s_branch L_bar_5
L_c8_12:
    s_add_u32 m0, s76, 0
    s_nop 0
    buffer_load_dwordx4 v8, s[24:27], s64 offen lds
    s_add_u32 m0, s76, 1024
    s_nop 0
    buffer_load_dwordx4 v9, s[24:27], s64 offen lds
    s_add_u32 m0, s76, 2048
    s_nop 0
    buffer_load_dwordx4 v10, s[24:27], s64 offen lds
    s_cmp_lt_u32 s53, 3
    s_cbranch_scc0 L_nf_18
    s_add_u32 m0, s71, 0
    s_nop 0
    buffer_load_dwordx4 v18, s[44:47], s70 offen lds
L_nf_18:
    s_mov_b32 s4, s78
    s_mul_i32 s11, s17, 12
    s_cmp_ge_u32 s4, 12
    s_cselect_b32 s62, 12, 0
    s_sub_u32 s4, s4, s62
    s_add_u32 s62, s4, s11
    s_mul_i32 s62, s62, 81920
    s_add_u32 s4, s4, 1
    s_add_u32 m0, s6, 65536
    s_nop 0
    buffer_load_dwordx4 v48, s[28:31], s62 offen offset:0 lds
    buffer_load_dwordx4 v49, s[28:31], s62 offen offset:1024 lds
    s_cmp_ge_u32 s4, 12
    s_cselect_b32 s12, 12, 0
    s_sub_u32 s4, s4, s12
    s_add_u32 s12, s4, s11
    s_mul_i32 s12, s12, 81920
    s_add_u32 s4, s4, 1
    s_add_u32 m0, s6, 73728
    s_nop 0
    buffer_load_dwordx4 v48, s[28:31], s12 offen offset:0 lds
    buffer_load_dwordx4 v49, s[28:31], s12 offen offset:1024 lds
    s_waitcnt vmcnt(4)
    s_barrier
    ds_write_b32 v22, v26
    ds_write_b32 v22, v27 offset:576
    v_add_f32 v32, v32, v33
    v_add_f32 v32, v32, v34
    v_add_f32 v32, v32, v35
    v_add_f32 v32, v32, v36
    v_add_f32 v32, v32, v37
    v_add_f32 v32, v32, v38
    v_add_f32 v32, v32, v39
    v_add_f32 v32, v32, v40
    v_add_f32 v32, v32, v41
    ds_write_b32 v29, v32
    s_cmp_ge_u32 s4, 12
    s_cselect_b32 s62, 12, 0
    s_sub_u32 s4, s4, s62
    s_add_u32 s62, s4, s11
    s_mul_i32 s62, s62, 81920
    s_add_u32 s4, s4, 1
    s_add_u32 m0, s6, 81920
    s_nop 0
    buffer_load_dwordx4 v48, s[28:31], s62 offen offset:0 lds
    buffer_load_dwordx4 v49, s[28:31], s62 offen offset:1024 lds
    s_cmp_ge_u32 s4, 12
    s_cselect_b32 s12, 12, 0
    s_sub_u32 s4, s4, s12
    s_add_u32 s12, s4, s11
    s_mul_i32 s12, s12, 81920
    s_add_u32 s4, s4, 1
    s_add_u32 m0, s6, 90112
    s_nop 0
    buffer_load_dwordx4 v48, s[28:31], s12 offen offset:0 lds
    buffer_load_dwordx4 v49, s[28:31], s12 offen offset:1024 lds
    s_waitcnt lgkmcnt(0)
    s_barrier
    s_cmp_ge_u32 s4, 12
    s_cselect_b32 s62, 12, 0
    s_sub_u32 s4, s4, s62
    s_add_u32 s62, s4, s11
    s_mul_i32 s62, s62, 81920
    s_add_u32 s4, s4, 1
    s_add_u32 m0, s6, 114688
    s_nop 0
    buffer_load_dwordx4 v48, s[28:31], s62 offen offset:0 lds
    buffer_load_dwordx4 v49, s[28:31], s62 offen offset:1024 lds
    s_cmp_ge_u32 s4, 12
    s_cselect_b32 s12, 12, 0
    s_sub_u32 s4, s4, s12
    s_add_u32 s12, s4, s11
    s_mul_i32 s12, s12, 81920
    s_add_u32 s4, s4, 1
    s_add_u32 m0, s6, 122880
    s_nop 0
    buffer_load_dwordx4 v48, s[28:31], s12 offen offset:0 lds
    buffer_load_dwordx4 v49, s[28:31], s12 offen offset:1024 lds
    buffer_load_dword v54, v52, s[36:39], 0 offen offset:0 sc0 sc1
    s_cmp_ge_u32 s4, 12
    s_cselect_b32 s62, 12, 0
    s_sub_u32 s4, s4, s62
    s_add_u32 s62, s4, s11
    s_mul_i32 s62, s62, 81920
    s_add_u32 s4, s4, 1
    s_add_u32 m0, s6, 131072
    s_nop 0
    buffer_load_dwordx4 v48, s[28:31], s62 offen offset:0 lds
    buffer_load_dwordx4 v49, s[28:31], s62 offen offset:1024 lds
    s_cmp_ge_u32 s4, 12
    s_cselect_b32 s12, 12, 0
    s_sub_u32 s4, s4, s12
    s_add_u32 s12, s4, s11
    s_mul_i32 s12, s12, 81920
    s_add_u32 s4, s4, 1
    s_add_u32 m0, s6, 139264
    s_nop 0
    buffer_load_dwordx4 v48, s[28:31], s12 offen offset:0 lds
    buffer_load_dwordx4 v49, s[28:31], s12 offen offset:1024 lds
    s_waitcnt vmcnt(4)
    v_cmp_gt_u32 vcc, 4, v54
    s_nop 4
    s_cbranch_vccz L_sd_20
    s_mov_b32 s61, 20000
L_sp_19:
    buffer_load_dword v54, v52, s[36:39], 0 offen offset:0 sc0 sc1
    s_waitcnt vmcnt(0)
    v_cmp_gt_u32 vcc, 4, v54
    s_nop 4
    s_cbranch_vccz L_sd_20
    s_sub_u32 s61, s61, 1
    s_cbranch_scc0 L_sp_19
L_sd_20:
    s_mov_b32 s5, s78
    s_mul_i32 s8, s56, 196608
    s_mul_i32 s63, s17, 98304
    s_add_u32 s8, s8, s63
    s_add_u32 s8, s8, 0
    s_cmp_ge_u32 s5, 12
    s_cselect_b32 s63, 12, 0
    s_sub_u32 s5, s5, s63
    s_lshl_b32 s63, s5, 13
    s_add_u32 s63, s63, s8
    s_add_u32 s5, s5, 1
    s_add_u32 m0, s7, 147456
    s_nop 0
    buffer_load_dwordx4 v51, s[36:39], s63 offen offset:0 sc0 sc1 lds
    buffer_load_dwordx4 v51, s[36:39], s63 offen offset:1024 sc0 sc1 lds
    s_cmp_ge_u32 s5, 12
    s_cselect_b32 s13, 12, 0
    s_sub_u32 s5, s5, s13
    s_lshl_b32 s13, s5, 13
    s_add_u32 s13, s13, s8
    s_add_u32 s5, s5, 1
    s_add_u32 m0, s7, 49152
    s_nop 0
    buffer_load_dwordx4 v51, s[36:39], s13 offen offset:0 sc0 sc1 lds
    buffer_load_dwordx4 v51, s[36:39], s13 offen offset:1024 sc0 sc1 lds
    s_cmp_ge_u32 s5, 12
    s_cselect_b32 s63, 12, 0
    s_sub_u32 s5, s5, s63
    s_lshl_b32 s63, s5, 13
    s_add_u32 s63, s63, s8
    s_add_u32 s5, s5, 1
    s_add_u32 m0, s7, 57344
    s_nop 0
    buffer_load_dwordx4 v51, s[36:39], s63 offen offset:0 sc0 sc1 lds
    buffer_load_dwordx4 v51, s[36:39], s63 offen offset:1024 sc0 sc1 lds
    s_cmp_ge_u32 s5, 12
    s_cselect_b32 s13, 12, 0
    s_sub_u32 s5, s5, s13
    s_lshl_b32 s13, s5, 13
    s_add_u32 s13, s13, s8
    s_add_u32 s5, s5, 1
    s_add_u32 m0, s7, 98304
    s_nop 0
    buffer_load_dwordx4 v51, s[36:39], s13 offen offset:0 sc0 sc1 lds
    buffer_load_dwordx4 v51, s[36:39], s13 offen offset:1024 sc0 sc1 lds
    s_cmp_ge_u32 s5, 12
    s_cselect_b32 s63, 12, 0
    s_sub_u32 s5, s5, s63
    s_lshl_b32 s63, s5, 13
    s_add_u32 s63, s63, s8
    s_add_u32 s5, s5, 1
    s_add_u32 m0, s7, 106496
    s_nop 0
    buffer_load_dwordx4 v51, s[36:39], s63 offen offset:0 sc0 sc1 lds
    buffer_load_dwordx4 v51, s[36:39], s63 offen offset:1024 sc0 sc1 lds
    s_cmp_ge_u32 s5, 12
    s_cselect_b32 s13, 12, 0
    s_sub_u32 s5, s5, s13
    s_lshl_b32 s13, s5, 13
    s_add_u32 s13, s13, s8
    s_add_u32 s5, s5, 1
    s_add_u32 m0, s7, 40960
    s_nop 0
    buffer_load_dwordx4 v51, s[36:39], s13 offen offset:0 sc0 sc1 lds
    buffer_load_dwordx4 v51, s[36:39], s13 offen offset:1024 sc0 sc1 lds
    buffer_load_dword v58, v42, s[28:31], 0 offen
    buffer_load_dword v59, v43, s[32:35], 0 offen
    s_waitcnt vmcnt(12)
    s_barrier
    s_waitcnt vmcnt(10)
    s_barrier
    s_cmp_ge_u32 s5, 12
    s_cselect_b32 s63, 12, 0
    s_sub_u32 s5, s5, s63
    s_lshl_b32 s63, s5, 13
    s_add_u32 s63, s63, s8
    s_add_u32 s5, s5, 1
    s_cmp_ge_u32 s4, 12
    s_cselect_b32 s62, 12, 0
    s_sub_u32 s4, s4, s62
    s_add_u32 s62, s4, s11
    s_mul_i32 s62, s62, 81920
    s_add_u32 s4, s4, 1
    s_add_u32 m0, s7, 147456
    s_waitcnt vmcnt(8)
    s_barrier
    buffer_load_dwordx4 v51, s[36:39], s63 offen offset:0 sc0 sc1 lds
    s_cmp_ge_u32 s5, 12
    s_cselect_b32 s13, 12, 0
    s_sub_u32 s5, s5, s13
    s_lshl_b32 s13, s5, 13
    s_add_u32 s13, s13, s8
    s_add_u32 s5, s5, 1
    buffer_load_dwordx4 v51, s[36:39], s63 offen offset:1024 sc0 sc1 lds
    s_add_u32 m0, s6, 65536
    s_nop 0
    buffer_load_dwordx4 v48, s[28:31], s62 offen offset:0 lds
    s_cmp_ge_u32 s4, 12
    s_cselect_b32 s12, 12, 0
    s_sub_u32 s4, s4, s12
    s_add_u32 s12, s4, s11
    s_mul_i32 s12, s12, 81920
    s_add_u32 s4, s4, 1
    buffer_load_dwordx4 v49, s[28:31], s62 offen offset:1024 lds
    s_add_u32 m0, s7, 49152
    s_waitcnt vmcnt(10)
    s_barrier
    buffer_load_dwordx4 v51, s[36:39], s13 offen offset:0 sc0 sc1 lds
    s_cmp_ge_u32 s5, 12
    s_cselect_b32 s63, 12, 0
    s_sub_u32 s5, s5, s63
    s_lshl_b32 s63, s5, 13
    s_add_u32 s63, s63, s8
    s_add_u32 s5, s5, 1
    buffer_load_dwordx4 v51, s[36:39], s13 offen offset:1024 sc0 sc1 lds
    s_add_u32 m0, s6, 73728
    s_nop 0
    buffer_load_dwordx4 v48, s[28:31], s12 offen offset:0 lds
    s_cmp_ge_u32 s4, 12
    s_cselect_b32 s62, 12, 0
    s_sub_u32 s4, s4, s62
    s_add_u32 s62, s4, s11
    s_mul_i32 s62, s62, 81920
    s_add_u32 s4, s4, 1
    buffer_load_dwordx4 v49, s[28:31], s12 offen offset:1024 lds
    s_add_u32 m0, s7, 57344
    s_waitcnt vmcnt(12)
    s_barrier
    buffer_load_dwordx4 v51, s[36:39], s63 offen offset:0 sc0 sc1 lds
    s_cmp_ge_u32 s5, 12
    s_cselect_b32 s13, 12, 0
    s_sub_u32 s5, s5, s13
    s_lshl_b32 s13, s5, 13
    s_add_u32 s13, s13, s8
    s_add_u32 s5, s5, 1
    buffer_load_dwordx4 v51, s[36:39], s63 offen offset:1024 sc0 sc1 lds
    s_add_u32 m0, s6, 81920
    s_nop 0
    buffer_load_dwordx4 v48, s[28:31], s62 offen offset:0 lds
    s_cmp_ge_u32 s4, 12
    s_cselect_b32 s12, 12, 0
    s_sub_u32 s4, s4, s12
    s_add_u32 s12, s4, s11
    s_mul_i32 s12, s12, 81920
    s_add_u32 s4, s4, 1
    buffer_load_dwordx4 v49, s[28:31], s62 offen offset:1024 lds
    s_add_u32 m0, s7, 98304
    s_waitcnt vmcnt(14)
    s_barrier
    buffer_load_dwordx4 v51, s[36:39], s13 offen offset:0 sc0 sc1 lds
    s_cmp_ge_u32 s5, 12
    s_cselect_b32 s63, 12, 0
    s_sub_u32 s5, s5, s63
    s_lshl_b32 s63, s5, 13
    s_add_u32 s63, s63, s8
    s_add_u32 s5, s5, 1
    buffer_load_dwordx4 v51, s[36:39], s13 offen offset:1024 sc0 sc1 lds
    s_add_u32 m0, s6, 90112
    s_nop 0
    buffer_load_dwordx4 v48, s[28:31], s12 offen offset:0 lds
    s_mov_b32 s4, s78
    s_mul_i32 s11, s16, 12
    s_cmp_ge_u32 s4, 12
    s_cselect_b32 s62, 12, 0
    s_sub_u32 s4, s4, s62
    s_add_u32 s62, s4, s11
    s_mul_i32 s62, s62, 81920
    s_add_u32 s4, s4, 1
    buffer_load_dwordx4 v49, s[28:31], s12 offen offset:1024 lds
    s_add_u32 m0, s7, 106496
    s_waitcnt vmcnt(14)
    s_barrier
    buffer_load_dword v54, v53, s[36:39], 0 offen offset:0 sc0 sc1
    buffer_load_dwordx4 v51, s[36:39], s63 offen offset:0 sc0 sc1 lds
    s_cmp_ge_u32 s5, 12
    s_cselect_b32 s13, 12, 0
    s_sub_u32 s5, s5, s13
    s_lshl_b32 s13, s5, 13
    s_add_u32 s13, s13, s8
    s_add_u32 s5, s5, 1
    buffer_load_dwordx4 v51, s[36:39], s63 offen offset:1024 sc0 sc1 lds
    s_add_u32 m0, s6, 114688
    s_nop 0
    buffer_load_dwordx4 v48, s[28:31], s62 offen offset:0 lds
    s_cmp_ge_u32 s4, 12
    s_cselect_b32 s12, 12, 0
    s_sub_u32 s4, s4, s12
    s_add_u32 s12, s4, s11
    s_mul_i32 s12, s12, 81920
    s_add_u32 s4, s4, 1
    buffer_load_dwordx4 v49, s[28:31], s62 offen offset:1024 lds
    s_add_u32 m0, s7, 40960
    s_waitcnt vmcnt(15)
    s_barrier
    buffer_load_dwordx4 v51, s[36:39], s13 offen offset:0 sc0 sc1 lds
    s_mov_b32 s5, s78
    s_mul_i32 s8, s56, 196608
    s_mul_i32 s63, s16, 98304
    s_add_u32 s8, s8, s63
    s_add_u32 s8, s8, 0
    s_cmp_ge_u32 s5, 12
    s_cselect_b32 s63, 12, 0
    s_sub_u32 s5, s5, s63
    s_lshl_b32 s63, s5, 13
    s_add_u32 s63, s63, s8
    s_add_u32 s5, s5, 1
    buffer_load_dwordx4 v51, s[36:39], s13 offen offset:1024 sc0 sc1 lds
    s_add_u32 m0, s6, 122880
    s_nop 0
    buffer_load_dwordx4 v48, s[28:31], s12 offen offset:0 lds
    s_cmp_ge_u32 s4, 12
    s_cselect_b32 s62, 12, 0
    s_sub_u32 s4, s4, s62
    s_add_u32 s62, s4, s11
    s_mul_i32 s62, s62, 81920
    s_add_u32 s4, s4, 1
    buffer_load_dwordx4 v49, s[28:31], s12 offen offset:1024 lds
    s_add_u32 m0, s7, 147456
    s_waitcnt vmcnt(15)
    s_barrier
    s_waitcnt vmcnt(8)
    v_cmp_gt_u32 vcc, 4, v54
    s_nop 4
    s_cbranch_vccz L_sd_22
    s_mov_b32 s61, 20000
L_sp_21:
    buffer_load_dword v54, v53, s[36:39], 0 offen offset:0 sc0 sc1
    s_waitcnt vmcnt(0)
    v_cmp_gt_u32 vcc, 4, v54
    s_nop 4
    s_cbranch_vccz L_sd_22
    s_sub_u32 s61, s61, 1
    s_cbranch_scc0 L_sp_21
L_sd_22:
    buffer_load_dwordx4 v51, s[36:39], s63 offen offset:0 sc0 sc1 lds
    s_cmp_ge_u32 s5, 12
    s_cselect_b32 s13, 12, 0
    s_sub_u32 s5, s5, s13
    s_lshl_b32 s13, s5, 13
    s_add_u32 s13, s13, s8
    s_add_u32 s5, s5, 1
    buffer_load_dwordx4 v51, s[36:39], s63 offen offset:1024 sc0 sc1 lds
    s_add_u32 m0, s6, 131072
    s_nop 0
    buffer_load_dwordx4 v48, s[28:31], s62 offen offset:0 lds
    s_cmp_ge_u32 s4, 12
    s_cselect_b32 s12, 12, 0
    s_sub_u32 s4, s4, s12
    s_add_u32 s12, s4, s11
    s_mul_i32 s12, s12, 81920
    s_add_u32 s4, s4, 1
    buffer_load_dwordx4 v49, s[28:31], s62 offen offset:1024 lds
    s_add_u32 m0, s7, 49152
    s_barrier
    buffer_load_dwordx4 v51, s[36:39], s13 offen offset:0 sc0 sc1 lds
    s_cmp_ge_u32 s5, 12
    s_cselect_b32 s63, 12, 0
    s_sub_u32 s5, s5, s63
    s_lshl_b32 s63, s5, 13
    s_add_u32 s63, s63, s8
    s_add_u32 s5, s5, 1
    buffer_load_dwordx4 v51, s[36:39], s13 offen offset:1024 sc0 sc1 lds
    s_add_u32 m0, s6, 139264
    s_nop 0
    buffer_load_dwordx4 v48, s[28:31], s12 offen offset:0 lds
    s_cmp_ge_u32 s4, 12
    s_cselect_b32 s62, 12, 0
    s_sub_u32 s4, s4, s62
    s_add_u32 s62, s4, s11
    s_mul_i32 s62, s62, 81920
    s_add_u32 s4, s4, 1
    buffer_load_dwordx4 v49, s[28:31], s12 offen offset:1024 lds
    s_add_u32 m0, s7, 57344
    s_waitcnt vmcnt(14)
    s_barrier
    buffer_load_dwordx4 v51, s[36:39], s63 offen offset:0 sc0 sc1 lds
    s_cmp_ge_u32 s5, 12
    s_cselect_b32 s13, 12, 0
    s_sub_u32 s5, s5, s13
    s_lshl_b32 s13, s5, 13
    s_add_u32 s13, s13, s8
    s_add_u32 s5, s5, 1
    buffer_load_dwordx4 v51, s[36:39], s63 offen offset:1024 sc0 sc1 lds
    s_add_u32 m0, s6, 65536
    s_nop 0
    buffer_load_dwordx4 v48, s[28:31], s62 offen offset:0 lds
    s_cmp_ge_u32 s4, 12
    s_cselect_b32 s12, 12, 0
    s_sub_u32 s4, s4, s12
    s_add_u32 s12, s4, s11
    s_mul_i32 s12, s12, 81920
    s_add_u32 s4, s4, 1
    buffer_load_dwordx4 v49, s[28:31], s62 offen offset:1024 lds
    s_add_u32 m0, s7, 98304
    s_waitcnt vmcnt(14)
    s_barrier
    buffer_load_dwordx4 v51, s[36:39], s13 offen offset:0 sc0 sc1 lds
    s_cmp_ge_u32 s5, 12
    s_cselect_b32 s63, 12, 0
    s_sub_u32 s5, s5, s63
    s_lshl_b32 s63, s5, 13
    s_add_u32 s63, s63, s8
    s_add_u32 s5, s5, 1
    buffer_load_dwordx4 v51, s[36:39], s13 offen offset:1024 sc0 sc1 lds
    s_add_u32 m0, s6, 73728
    s_nop 0
    buffer_load_dwordx4 v48, s[28:31], s12 offen offset:0 lds
    s_cmp_ge_u32 s4, 12
    s_cselect_b32 s62, 12, 0
    s_sub_u32 s4, s4, s62
    s_add_u32 s62, s4, s11
    s_mul_i32 s62, s62, 81920
    s_add_u32 s4, s4, 1
    buffer_load_dwordx4 v49, s[28:31], s12 offen offset:1024 lds
    s_add_u32 m0, s7, 106496
    s_waitcnt vmcnt(14)
    s_barrier
    buffer_load_dwordx4 v51, s[36:39], s63 offen offset:0 sc0 sc1 lds
    s_cmp_ge_u32 s5, 12
    s_cselect_b32 s13, 12, 0
    s_sub_u32 s5, s5, s13
    s_lshl_b32 s13, s5, 13
    s_add_u32 s13, s13, s8
    s_add_u32 s5, s5, 1
    buffer_load_dwordx4 v51, s[36:39], s63 offen offset:1024 sc0 sc1 lds
    s_add_u32 m0, s6, 81920
    s_nop 0
    buffer_load_dwordx4 v48, s[28:31], s62 offen offset:0 lds
    s_cmp_ge_u32 s4, 12
    s_cselect_b32 s12, 12, 0
    s_sub_u32 s4, s4, s12
    s_add_u32 s12, s4, s11
    s_mul_i32 s12, s12, 81920
    s_add_u32 s4, s4, 1
    buffer_load_dwordx4 v49, s[28:31], s62 offen offset:1024 lds
    s_add_u32 m0, s7, 40960
    s_waitcnt vmcnt(14)
    s_barrier
    buffer_load_dwordx4 v51, s[36:39], s13 offen offset:0 sc0 sc1 lds
    s_cmp_ge_u32 s5, 12
    s_cselect_b32 s63, 12, 0
    s_sub_u32 s5, s5, s63
    s_lshl_b32 s63, s5, 13
    s_add_u32 s63, s63, s8
    s_add_u32 s5, s5, 1
    buffer_load_dwordx4 v51, s[36:39], s13 offen offset:1024 sc0 sc1 lds
    s_add_u32 m0, s6, 90112
    s_nop 0
    buffer_load_dwordx4 v48, s[28:31], s12 offen offset:0 lds
    s_cmp_ge_u32 s4, 12
    s_cselect_b32 s62, 12, 0
    s_sub_u32 s4, s4, s62
    s_add_u32 s62, s4, s11
    s_mul_i32 s62, s62, 81920
    s_add_u32 s4, s4, 1
    buffer_load_dwordx4 v49, s[28:31], s12 offen offset:1024 lds
    s_add_u32 m0, s7, 147456
    s_waitcnt vmcnt(14)
    s_barrier
    buffer_load_dwordx4 v51, s[36:39], s63 offen offset:0 sc0 sc1 lds
    s_cmp_ge_u32 s5, 12
    s_cselect_b32 s13, 12, 0
    s_sub_u32 s5, s5, s13
    s_lshl_b32 s13, s5, 13
    s_add_u32 s13, s13, s8
    s_add_u32 s5, s5, 1
    buffer_load_dwordx4 v51, s[36:39], s63 offen offset:1024 sc0 sc1 lds
    s_add_u32 m0, s6, 114688
    s_nop 0
    buffer_load_dwordx4 v48, s[28:31], s62 offen offset:0 lds
    s_cmp_ge_u32 s4, 12
    s_cselect_b32 s12, 12, 0
    s_sub_u32 s4, s4, s12
    s_add_u32 s12, s4, s11
    s_mul_i32 s12, s12, 81920
    s_add_u32 s4, s4, 1
    buffer_load_dwordx4 v49, s[28:31], s62 offen offset:1024 lds
    s_add_u32 m0, s7, 49152
    s_waitcnt vmcnt(14)
    s_barrier
    buffer_load_dwordx4 v51, s[36:39], s13 offen offset:0 sc0 sc1 lds
    s_cmp_ge_u32 s5, 12
    s_cselect_b32 s63, 12, 0
    s_sub_u32 s5, s5, s63
    s_lshl_b32 s63, s5, 13
    s_add_u32 s63, s63, s8
    s_add_u32 s5, s5, 1
    buffer_load_dwordx4 v51, s[36:39], s13 offen offset:1024 sc0 sc1 lds
    s_add_u32 m0, s6, 122880
    s_nop 0
    buffer_load_dwordx4 v48, s[28:31], s12 offen offset:0 lds
    s_cmp_ge_u32 s4, 12
    s_cselect_b32 s62, 12, 0
    s_sub_u32 s4, s4, s62
    s_add_u32 s62, s4, s11
    s_mul_i32 s62, s62, 81920
    s_add_u32 s4, s4, 1
    buffer_load_dwordx4 v49, s[28:31], s12 offen offset:1024 lds
    s_add_u32 m0, s7, 57344
    s_waitcnt vmcnt(14)
    s_barrier
    buffer_load_dwordx4 v51, s[36:39], s63 offen offset:0 sc0 sc1 lds
    s_cmp_ge_u32 s5, 12
    s_cselect_b32 s13, 12, 0
    s_sub_u32 s5, s5, s13
    s_lshl_b32 s13, s5, 13
    s_add_u32 s13, s13, s8
    s_add_u32 s5, s5, 1
    buffer_load_dwordx4 v51, s[36:39], s63 offen offset:1024 sc0 sc1 lds
    s_add_u32 m0, s6, 131072
    s_nop 0
    buffer_load_dwordx4 v48, s[28:31], s62 offen offset:0 lds
    s_cmp_ge_u32 s4, 12
    s_cselect_b32 s12, 12, 0
    s_sub_u32 s4, s4, s12
    s_add_u32 s12, s4, s11
    s_mul_i32 s12, s12, 81920
    s_add_u32 s4, s4, 1
    buffer_load_dwordx4 v49, s[28:31], s62 offen offset:1024 lds
    s_add_u32 m0, s7, 98304
    s_waitcnt vmcnt(14)
    s_barrier
    buffer_load_dwordx4 v51, s[36:39], s13 offen offset:0 sc0 sc1 lds
    s_cmp_ge_u32 s5, 12
    s_cselect_b32 s63, 12, 0
    s_sub_u32 s5, s5, s63
    s_lshl_b32 s63, s5, 13
    s_add_u32 s63, s63, s8
    s_add_u32 s5, s5, 1
    buffer_load_dwordx4 v51, s[36:39], s13 offen offset:1024 sc0 sc1 lds
    s_add_u32 m0, s6, 139264
    s_nop 0
    buffer_load_dwordx4 v48, s[28:31], s12 offen offset:0 lds
    s_mov_b32 s4, s79
    s_mul_i32 s11, s17, 5
    s_cmp_ge_u32 s4, 5
    s_cselect_b32 s62, 5, 0
    s_sub_u32 s4, s4, s62
    s_add_u32 s62, s4, s11
    s_mul_i32 s62, s62, 81920
    s_add_u32 s4, s4, 1
    buffer_load_dwordx4 v49, s[28:31], s12 offen offset:1024 lds
    s_add_u32 m0, s7, 106496
    s_waitcnt vmcnt(14)
    s_barrier
    buffer_load_dword v54, v52, s[36:39], 0 offen offset:256 sc0 sc1
    buffer_load_dwordx4 v51, s[36:39], s63 offen offset:0 sc0 sc1 lds
    s_cmp_ge_u32 s5, 12
    s_cselect_b32 s13, 12, 0
    s_sub_u32 s5, s5, s13
    s_lshl_b32 s13, s5, 13
    s_add_u32 s13, s13, s8
    s_add_u32 s5, s5, 1
    buffer_load_dwordx4 v51, s[36:39], s63 offen offset:1024 sc0 sc1 lds
    s_add_u32 m0, s6, 65536
    s_nop 0
    buffer_load_dwordx4 v48, s[32:35], s62 offen offset:0 lds
    s_cmp_ge_u32 s4, 5
    s_cselect_b32 s12, 5, 0
    s_sub_u32 s4, s4, s12
    s_add_u32 s12, s4, s11
    s_mul_i32 s12, s12, 81920
    s_add_u32 s4, s4, 1
    buffer_load_dwordx4 v49, s[32:35], s62 offen offset:1024 lds
    s_add_u32 m0, s7, 40960
    s_waitcnt vmcnt(15)
    s_barrier
    buffer_load_dwordx4 v51, s[36:39], s13 offen offset:0 sc0 sc1 lds
    s_mov_b32 s5, s79
    s_mul_i32 s8, s56, 81920
    s_mul_i32 s63, s17, 40960
    s_add_u32 s8, s8, s63
    s_add_u32 s8, s8, 6291456
    s_cmp_ge_u32 s5, 5
    s_cselect_b32 s63, 5, 0
    s_sub_u32 s5, s5, s63
    s_lshl_b32 s63, s5, 13
    s_add_u32 s63, s63, s8
    s_add_u32 s5, s5, 1
    buffer_load_dwordx4 v51, s[36:39], s13 offen offset:1024 sc0 sc1 lds
    s_add_u32 m0, s6, 73728
    s_nop 0
    buffer_load_dwordx4 v48, s[32:35], s12 offen offset:0 lds
    s_cmp_ge_u32 s4, 5
    s_cselect_b32 s62, 5, 0
    s_sub_u32 s4, s4, s62
    s_add_u32 s62, s4, s11
    s_mul_i32 s62, s62, 81920
    s_add_u32 s4, s4, 1
    buffer_load_dwordx4 v49, s[32:35], s12 offen offset:1024 lds
    s_add_u32 m0, s7, 147456
    s_waitcnt vmcnt(15)
    s_barrier
    s_waitcnt vmcnt(8)
    v_cmp_gt_u32 vcc, 4, v54
    s_nop 4
    s_cbranch_vccz L_sd_24
    s_mov_b32 s61, 20000
L_sp_23:
    buffer_load_dword v54, v52, s[36:39], 0 offen offset:256 sc0 sc1
    s_waitcnt vmcnt(0)
    v_cmp_gt_u32 vcc, 4, v54
    s_nop 4
    s_cbranch_vccz L_sd_24
    s_sub_u32 s61, s61, 1
    s_cbranch_scc0 L_sp_23
L_sd_24:
    buffer_load_dwordx4 v51, s[36:39], s63 offen offset:0 sc0 sc1 lds
    s_cmp_ge_u32 s5, 5
    s_cselect_b32 s13, 5, 0
    s_sub_u32 s5, s5, s13
    s_lshl_b32 s13, s5, 13
    s_add_u32 s13, s13, s8
    s_add_u32 s5, s5, 1
    buffer_load_dwordx4 v51, s[36:39], s63 offen offset:1024 sc0 sc1 lds
    s_add_u32 m0, s6, 81920
    s_nop 0
    buffer_load_dwordx4 v48, s[32:35], s62 offen offset:0 lds
    s_cmp_ge_u32 s4, 5
    s_cselect_b32 s12, 5, 0
    s_sub_u32 s4, s4, s12
    s_add_u32 s12, s4, s11
    s_mul_i32 s12, s12, 81920
    s_add_u32 s4, s4, 1
    buffer_load_dwordx4 v49, s[32:35], s62 offen offset:1024 lds
    s_add_u32 m0, s7, 49152
    s_barrier
    buffer_load_dwordx4 v51, s[36:39], s13 offen offset:0 sc0 sc1 lds
    s_cmp_ge_u32 s5, 5
    s_cselect_b32 s63, 5, 0
    s_sub_u32 s5, s5, s63
    s_lshl_b32 s63, s5, 13
    s_add_u32 s63, s63, s8
    s_add_u32 s5, s5, 1
    buffer_load_dwordx4 v51, s[36:39], s13 offen offset:1024 sc0 sc1 lds
    s_add_u32 m0, s6, 90112
    s_nop 0
    buffer_load_dwordx4 v48, s[32:35], s12 offen offset:0 lds
    s_cmp_ge_u32 s4, 5
    s_cselect_b32 s62, 5, 0
    s_sub_u32 s4, s4, s62
    s_add_u32 s62, s4, s11
    s_mul_i32 s62, s62, 81920
    s_add_u32 s4, s4, 1
    buffer_load_dwordx4 v49, s[32:35], s12 offen offset:1024 lds
    s_add_u32 m0, s7, 57344
    s_waitcnt vmcnt(14)
    s_barrier
    buffer_load_dwordx4 v51, s[36:39], s63 offen offset:0 sc0 sc1 lds
    s_cmp_ge_u32 s5, 5
    s_cselect_b32 s13, 5, 0
    s_sub_u32 s5, s5, s13
    s_lshl_b32 s13, s5, 13
    s_add_u32 s13, s13, s8
    s_add_u32 s5, s5, 1
    buffer_load_dwordx4 v51, s[36:39], s63 offen offset:1024 sc0 sc1 lds
    s_add_u32 m0, s6, 114688
    s_nop 0
    buffer_load_dwordx4 v48, s[32:35], s62 offen offset:0 lds
    s_mov_b32 s4, s79
    s_mul_i32 s11, s16, 5
    s_cmp_ge_u32 s4, 5
    s_cselect_b32 s12, 5, 0
    s_sub_u32 s4, s4, s12
    s_add_u32 s12, s4, s11
    s_mul_i32 s12, s12, 81920
    s_add_u32 s4, s4, 1
    buffer_load_dwordx4 v49, s[32:35], s62 offen offset:1024 lds
    s_add_u32 m0, s7, 98304
    s_waitcnt vmcnt(14)
    s_barrier
    buffer_load_dword v54, v53, s[36:39], 0 offen offset:256 sc0 sc1
    buffer_load_dwordx4 v51, s[36:39], s13 offen offset:0 sc0 sc1 lds
    s_cmp_ge_u32 s5, 5
    s_cselect_b32 s63, 5, 0
    s_sub_u32 s5, s5, s63
    s_lshl_b32 s63, s5, 13
    s_add_u32 s63, s63, s8
    s_add_u32 s5, s5, 1
    buffer_load_dwordx4 v51, s[36:39], s13 offen offset:1024 sc0 sc1 lds
    s_add_u32 m0, s6, 122880
    s_nop 0
    buffer_load_dwordx4 v48, s[32:35], s12 offen offset:0 lds
    s_cmp_ge_u32 s4, 5
    s_cselect_b32 s62, 5, 0
    s_sub_u32 s4, s4, s62
    s_add_u32 s62, s4, s11
    s_mul_i32 s62, s62, 81920
    s_add_u32 s4, s4, 1
    buffer_load_dwordx4 v49, s[32:35], s12 offen offset:1024 lds
    s_add_u32 m0, s7, 106496
    s_waitcnt vmcnt(15)
    s_barrier
    buffer_load_dwordx4 v51, s[36:39], s63 offen offset:0 sc0 sc1 lds
    s_mov_b32 s5, s79
    s_mul_i32 s8, s56, 81920
    s_mul_i32 s13, s16, 40960
    s_add_u32 s8, s8, s13
    s_add_u32 s8, s8, 6291456
    s_cmp_ge_u32 s5, 5
    s_cselect_b32 s13, 5, 0
    s_sub_u32 s5, s5, s13
    s_lshl_b32 s13, s5, 13
    s_add_u32 s13, s13, s8
    s_add_u32 s5, s5, 1
    buffer_load_dwordx4 v51, s[36:39], s63 offen offset:1024 sc0 sc1 lds
    s_add_u32 m0, s6, 131072
    s_nop 0
    buffer_load_dwordx4 v48, s[32:35], s62 offen offset:0 lds
    s_cmp_ge_u32 s4, 5
    s_cselect_b32 s12, 5, 0
    s_sub_u32 s4, s4, s12
    s_add_u32 s12, s4, s11
    s_mul_i32 s12, s12, 81920
    s_add_u32 s4, s4, 1
    buffer_load_dwordx4 v49, s[32:35], s62 offen offset:1024 lds
    s_add_u32 m0, s7, 40960
    s_waitcnt vmcnt(15)
    s_barrier
    s_waitcnt vmcnt(8)
    v_cmp_gt_u32 vcc, 4, v54
    s_nop 4
    s_cbranch_vccz L_sd_26
    s_mov_b32 s61, 20000
L_sp_25:
    buffer_load_dword v54, v53, s[36:39], 0 offen offset:256 sc0 sc1
    s_waitcnt vmcnt(0)
    v_cmp_gt_u32 vcc, 4, v54
    s_nop 4
    s_cbranch_vccz L_sd_26
    s_sub_u32 s61, s61, 1
    s_cbranch_scc0 L_sp_25
L_sd_26:
    buffer_load_dwordx4 v51, s[36:39], s13 offen offset:0 sc0 sc1 lds
    s_cmp_ge_u32 s5, 5
    s_cselect_b32 s63, 5, 0
    s_sub_u32 s5, s5, s63
    s_lshl_b32 s63, s5, 13
    s_add_u32 s63, s63, s8
    s_add_u32 s5, s5, 1
    buffer_load_dwordx4 v51, s[36:39], s13 offen offset:1024 sc0 sc1 lds
    s_add_u32 m0, s6, 139264
    s_nop 0
    buffer_load_dwordx4 v48, s[32:35], s12 offen offset:0 lds
    s_cmp_ge_u32 s4, 5
    s_cselect_b32 s62, 5, 0
    s_sub_u32 s4, s4, s62
    s_add_u32 s62, s4, s11
    s_mul_i32 s62, s62, 81920
    s_add_u32 s4, s4, 1
    buffer_load_dwordx4 v49, s[32:35], s12 offen offset:1024 lds
    s_add_u32 m0, s7, 147456
    s_barrier
    buffer_load_dwordx4 v51, s[36:39], s63 offen offset:0 sc0 sc1 lds
    s_cmp_ge_u32 s5, 5
    s_cselect_b32 s13, 5, 0
    s_sub_u32 s5, s5, s13
    s_lshl_b32 s13, s5, 13
    s_add_u32 s13, s13, s8
    s_add_u32 s5, s5, 1
    buffer_load_dwordx4 v51, s[36:39], s63 offen offset:1024 sc0 sc1 lds
    s_add_u32 m0, s6, 65536
    s_nop 0
    buffer_load_dwordx4 v48, s[32:35], s62 offen offset:0 lds
    s_cmp_ge_u32 s4, 5
    s_cselect_b32 s12, 5, 0
    s_sub_u32 s4, s4, s12
    s_add_u32 s12, s4, s11
    s_mul_i32 s12, s12, 81920
    s_add_u32 s4, s4, 1
    buffer_load_dwordx4 v49, s[32:35], s62 offen offset:1024 lds
    s_add_u32 m0, s7, 49152
    s_waitcnt vmcnt(14)
    s_barrier
    buffer_load_dwordx4 v51, s[36:39], s13 offen offset:0 sc0 sc1 lds
    s_cmp_ge_u32 s5, 5
    s_cselect_b32 s63, 5, 0
    s_sub_u32 s5, s5, s63
    s_lshl_b32 s63, s5, 13
    s_add_u32 s63, s63, s8
    s_add_u32 s5, s5, 1
    buffer_load_dwordx4 v51, s[36:39], s13 offen offset:1024 sc0 sc1 lds
    s_add_u32 m0, s6, 73728
    s_nop 0
    buffer_load_dwordx4 v48, s[32:35], s12 offen offset:0 lds
    buffer_load_dwordx4 v49, s[32:35], s12 offen offset:1024 lds
    s_add_u32 m0, s7, 57344
    s_waitcnt vmcnt(14)
    s_barrier
    buffer_load_dwordx4 v51, s[36:39], s63 offen offset:0 sc0 sc1 lds
    s_cmp_ge_u32 s5, 5
    s_cselect_b32 s13, 5, 0
    s_sub_u32 s5, s5, s13
    s_lshl_b32 s13, s5, 13
    s_add_u32 s13, s13, s8
    s_add_u32 s5, s5, 1
    buffer_load_dwordx4 v51, s[36:39], s63 offen offset:1024 sc0 sc1 lds
    s_add_u32 m0, s7, 98304
    s_waitcnt vmcnt(12)
    s_barrier
    buffer_load_dwordx4 v51, s[36:39], s13 offen offset:0 sc0 sc1 lds
    buffer_load_dwordx4 v51, s[36:39], s13 offen offset:1024 sc0 sc1 lds
    s_waitcnt vmcnt(10)
    s_barrier
    s_waitcnt vmcnt(6)
    s_barrier
    s_waitcnt vmcnt(2)
    s_barrier
    s_waitcnt vmcnt(0)
    s_barrier
    s_endpgm
L_HH_a:
    v_lshrrev_b32 v2, 3, v0
    v_mul_u32_u24 v2, 1280, v2
    v_and_b32 v3, 7, v0
    v_lshrrev_b32 v4, 4, v0
    v_xor_b32 v3, v3, v4
    v_lshl_add_u32 v6, v3, 4, v2
    v_xor_b32 v7, 64, v6
    s_lshl_b32 s60, s54, 7
    s_lshl_b32 s61, s53, 5
    s_add_u32 s60, s60, s61
    s_mul_i32 s81, s60, 1280
    s_mul_i32 s80, s55, 384
    s_movk_i32 s59, 1120
    s_mul_i32 s69, s53, 3
    s_lshl_b32 s3, s53, 12
    s_add_u32 s3, s3, 24576
    s_add_u32 s60, s81, 0
    v_add_u32 v14, s60, v6
    s_lshl_b32 s66, s58, 7
    s_waitcnt lgkmcnt(0)
    s_mov_b32 s20, s4
    s_mov_b32 s21, s5
    s_mov_b32 s22, 2621440
    s_mov_b32 s23, 0x20000
    s_add_u32 m0, s3, 0
    s_add_u32 s60, s81, 10240
    v_add_u32 v15, s60, v7
    buffer_load_dwordx4 v14, s[20:23], s66 offen lds
    s_add_u32 m0, s3, 1024
    s_add_u32 s60, s81, 20480
    v_add_u32 v16, s60, v6
    buffer_load_dwordx4 v15, s[20:23], s66 offen lds
    s_add_u32 m0, s3, 2048
    s_add_u32 s60, s81, 30720
    v_add_u32 v17, s60, v7
    buffer_load_dwordx4 v16, s[20:23], s66 offen lds
    s_add_u32 m0, s3, 3072
    s_nop 0
    buffer_load_dwordx4 v17, s[20:23], s66 offen lds
    s_add_u32 s60, s69, 0
    s_lshl_b32 s60, s60, 6
    v_add_u32 v2, s60, v0
    v_mul_u32_u24 v3, 2731, v2
    v_lshrrev_b32 v3, 16, v3
    v_mul_u32_u24 v4, 24, v3
    v_sub_u32 v2, v2, v4
    v_and_b32 v4, 6, v3
    v_xor_b32 v2, v2, v4
    v_and_b32 v4, 4, v3
    v_add_u32 v5, v3, v4
    v_bfe_u32 v4, v3, 3, 1
    v_mad_i32_i24 v5, v4, -4, v5
    v_mul_u32_u24 v5, 3072, v5
    v_lshl_add_u32 v5, v2, 4, v5
    v_add_u32 v11, s80, v5
    s_mov_b32 s24, s12
    s_mov_b32 s25, s13
    s_mov_b32 s26, 1966080
    s_mov_b32 s27, 0x20000
    s_mov_b32 s63, s69
    s_lshl_b32 s69, s69, 10
    s_mov_b32 s68, 0
    s_mov_b32 s64, 0
    s_mov_b32 s76, 0
    s_mov_b32 s100, s58
    s_cmp_ge_u32 s58, 10
    s_cselect_b32 s60, 10, 0
    s_sub_u32 s58, s58, s60
    s_mul_i32 s65, s58, 196608
    s_lshl_b32 s66, s58, 7
    s_add_u32 s58, s58, 1
    s_add_u32 s77, s68, s69
    s_add_u32 s81, s68, s3
    s_mov_b32 s67, s69
    s_mov_b32 s69, s63
    s_add_u32 m0, s77, 12288
    s_nop 0
    buffer_load_dwordx4 v11, s[24:27], s65 offen lds
    v_add_u32 v8, 98304, v11
    s_add_u32 s60, s69, 1
    s_lshl_b32 s60, s60, 6
    v_add_u32 v2, s60, v0
    v_mul_u32_u24 v3, 2731, v2
    v_lshrrev_b32 v3, 16, v3
    v_mul_u32_u24 v4, 24, v3
    v_sub_u32 v2, v2, v4
    v_and_b32 v4, 6, v3
    v_xor_b32 v2, v2, v4
    v_and_b32 v4, 4, v3
    v_add_u32 v5, v3, v4
    v_bfe_u32 v4, v3, 3, 1
    v_mad_i32_i24 v5, v4, -4, v5
    v_mul_u32_u24 v5, 3072, v5
    v_lshl_add_u32 v5, v2, 4, v5
    v_add_u32 v12, s80, v5
    s_add_u32 m0, s77, 13312
    s_nop 0
    buffer_load_dwordx4 v12, s[24:27], s65 offen lds
    v_add_u32 v9, 98304, v12
    s_add_u32 s60, s69, 2
    s_lshl_b32 s60, s60, 6
    v_add_u32 v2, s60, v0
    v_mul_u32_u24 v3, 2731, v2
    v_lshrrev_b32 v3, 16, v3
    v_mul_u32_u24 v4, 24, v3
    v_sub_u32 v2, v2, v4
    v_and_b32 v4, 6, v3
    v_xor_b32 v2, v2, v4
    v_and_b32 v4, 4, v3
    v_add_u32 v5, v3, v4
    v_bfe_u32 v4, v3, 3, 1
    v_mad_i32_i24 v5, v4, -4, v5
    v_mul_u32_u24 v5, 3072, v5
    v_lshl_add_u32 v5, v2, 4, v5
    v_add_u32 v13, s80, v5
    s_add_u32 m0, s77, 14336
    s_nop 0
    buffer_load_dwordx4 v13, s[24:27], s65 offen lds
    v_add_u32 v10, 98304, v13
    s_mov_b32 s69, s67
    s_mov_b32 s67, s100
    s_mov_b32 s64, s65
    s_add_u32 s76, s68, s69
    s_sub_u32 s68, s68, 40960
    s_cselect_b32 s68, 81920, s68
    s_cmp_ge_u32 s58, 10
    s_cselect_b32 s60, 10, 0
    s_sub_u32 s58, s58, s60
    s_mul_i32 s65, s58, 196608
    s_lshl_b32 s66, s58, 7
    s_add_u32 s58, s58, 1
    s_add_u32 s77, s68, s69
    s_add_u32 s81, s68, s3
    s_add_u32 m0, s76, 0
    s_nop 0
    buffer_load_dwordx4 v8, s[24:27], s64 offen lds
    s_add_u32 m0, s76, 1024
    s_nop 0
    buffer_load_dwordx4 v9, s[24:27], s64 offen lds
    s_add_u32 m0, s76, 2048
    s_nop 0
    buffer_load_dwordx4 v10, s[24:27], s64 offen lds
    s_add_u32 m0, s81, 0
    s_mov_b32 s64, s65
    buffer_load_dwordx4 v14, s[20:23], s66 offen lds
    s_add_u32 m0, s81, 1024
    s_add_u32 s76, s68, s69
    buffer_load_dwordx4 v15, s[20:23], s66 offen lds
    s_and_b32 s63, s55, 1
    s_lshl1_add_u32 s56, s54, s63
    s_lshr_b32 s57, s55, 1
    s_and_b32 s63, s57, 1
    s_lshr_b32 s61, s2, 7
    s_and_b32 s60, s56, 7
    s_lshl1_add_u32 s63, s61, s63
    s_mul_i32 s61, s60, 3
    s_lshr_b32 s61, s61, 1
    s_mul_i32 s78, s63, 3
    s_add_u32 s78, s78, s61
    s_mul_i32 s60, s60, 5
    s_lshr_b32 s60, s60, 3
    s_add_u32 s79, s60, s63
    s_mov_b32 s28, s14
    s_mov_b32 s29, s15
    s_mov_b32 s30, 1966080
    s_mov_b32 s31, 0x20000
    s_mov_b32 s32, s8
    s_mov_b32 s33, s9
    s_mov_b32 s34, 819200
    s_mov_b32 s35, 0x20000
    s_mov_b32 s36, s10
    s_mov_b32 s37, s11
    s_mov_b32 s38, 33554432
    s_mov_b32 s39, 0x20000
    s_mov_b32 s40, s18
    s_mov_b32 s41, s19
    s_mov_b32 s42, 256
    s_mov_b32 s43, 0x20000
    s_mul_i32 s57, s57, 192
    s_mul_i32 s60, s53, 192
    s_add_u32 s60, s60, 0
    v_add_u32 v2, s60, v0
    v_mul_u32_u24 v3, 5462, v2
    v_lshrrev_b32 v3, 16, v3
    v_mul_u32_u24 v4, 12, v3
    v_sub_u32 v2, v2, v4
    v_lshrrev_b32 v4, 1, v3
    v_and_b32 v4, 2, v4
    v_xor_b32 v2, v2, v4
    v_mul_u32_u24 v3, 1280, v3
    v_lshl_add_u32 v2, v2, 4, v3
    s_sub_u32 s60, s57, 0
    v_add_u32 v48, s60, v2
    s_mul_i32 s60, s53, 192
    s_add_u32 s60, s60, 64
    v_add_u32 v2, s60, v0
    v_mul_u32_u24 v3, 5462, v2
    v_lshrrev_b32 v3, 16, v3
    v_mul_u32_u24 v4, 12, v3
    v_sub_u32 v2, v2, v4
    v_lshrrev_b32 v4, 1, v3
    v_and_b32 v4, 2, v4
    v_xor_b32 v2, v2, v4
    v_mul_u32_u24 v3, 1280, v3
    v_lshl_add_u32 v2, v2, 4, v3
    s_sub_u32 s60, s57, 1024
    v_add_u32 v49, s60, v2
    s_mul_i32 s60, s53, 192
    s_add_u32 s60, s60, 128
    v_add_u32 v2, s60, v0
    v_mul_u32_u24 v3, 5462, v2
    v_lshrrev_b32 v3, 16, v3
    v_mul_u32_u24 v4, 12, v3
    v_sub_u32 v2, v2, v4
    v_lshrrev_b32 v4, 1, v3
    v_and_b32 v4, 2, v4
    v_xor_b32 v2, v2, v4
    v_mul_u32_u24 v3, 1280, v3
    v_lshl_add_u32 v2, v2, 4, v3
    s_sub_u32 s60, s57, 2048
    v_add_u32 v50, s60, v2
    s_lshl_b32 s7, s53, 11
    v_lshl_add_u32 v51, v0, 4, s7
    s_lshr_b32 s16, s55, 2
    s_xor_b32 s17, s16, 1
    s_lshl_b32 s60, s54, 9
    s_add_u32 s60, s60, 16777216
    s_lshl_b32 s61, s17, 7
    s_add_u32 s61, s61, s60
    v_mov_b32 v52, s61
    v_xor_b32 v53, 128, v52
    s_mul_i32 s6, s53, 3072
    s_bfe_u32 s60, s2, 0x40003
    s_lshl2_add_u32 s60, s60, s53
    v_mul_u32_u24 v2, 52, v0
    v_lshrrev_b32 v2, 8, v2
    v_mul_u32_u24 v3, 5, v2
    v_sub_u32 v3, v0, v3
    s_lshl_b32 s61, s16, 7
    s_sub_u32 s61, 384, s61
    v_mov_b32 v4, s61
    v_cmp_le_u32 vcc, 3, v3
    s_nop 1
    v_cndmask_b32 v4, 0, v4, vcc
    v_lshl_add_u32 v3, v3, 7, v4
    s_movk_i32 s63, 1280
    v_min_u32 v4, 11, v2
    v_min_u32 v2, 9, v2
    v_mad_u32_u24 v4, v4, s63, v3
    v_mad_u32_u24 v2, v2, s63, v3
    s_mul_i32 s61, s16, 983424
    s_mul_i32 s62, s60, 15360
    s_add_u32 s61, s61, s62
    v_add_u32 v42, s61, v4
    s_mul_i32 s61, s16, 384
    s_mul_i32 s62, s60, 12800
    s_add_u32 s61, s61, s62
    v_add_u32 v43, s61, v2
    s_lshl_b32 s60, s54, 7
    s_add_u32 s60, s60, 16785408
    v_mov_b32 v20, s60
    v_mov_b32 v23, 0
    v_mov_b32 v25, 16
    s_lshl_b32 s61, s54, 7
    s_lshl_b32 s62, s53, 5
    s_add_u32 s61, s61, s62
    v_and_b32 v3, 31, v0
    v_add_u32 v21, s61, v3
    s_lshl_b32 s62, s53, 7
    s_add_u32 s62, s62, 160768
    v_lshl_add_u32 v22, v3, 2, s62
    v_mov_b32 v57, v20
    v_cmp_gt_i32 vcc, 0, v21
    v_lshlrev_b32 v21, 3, v21
    v_add_u32 v21, 18874368, v21
    v_mov_b32 v3, -16
    v_cndmask_b32 v21, v21, v3, vcc
    s_add_u32 s60, s55, 8
    s_lshl_b32 s61, s60, 7
    s_add_u32 s61, s61, 16787456
    v_mov_b32 v31, s61
    v_mov_b32 v4, 10
    v_cmp_le_u32 vcc, 48, v0
    s_nop 1
    v_cndmask_b32 v20, v20, v31, vcc
    v_cndmask_b32 v25, v25, v4, vcc
    s_mul_i32 s9, s60, 10240
    s_add_u32 s9, s9, 19922944
    s_lshl_b32 s61, s53, 8
    s_add_u32 s62, s9, s61
    v_lshl_add_u32 v28, v0, 2, s62
    s_cmp_eq_u32 s53, 3
    s_cselect_b32 s63, 33554432, 0
    v_add_u32 v28, s63, v28
    s_add_u32 s61, s61, 161920
    v_lshl_add_u32 v29, v0, 2, s61
    v_bfe_u32 v2, v0, 2, 3
    v_lshrrev_b32 v3, 5, v0
    v_lshl_add_u32 v3, v3, 4, v2
    v_mul_u32_u24 v3, 384, v3
    v_and_b32 v4, 3, v0
    v_lshl_add_u32 v3, v4, 3, v3
    s_mul_i32 s61, s53, 3
    v_lshrrev_b32 v2, 1, v2
    s_add_u32 s62, s61, 0
    v_xor_b32 v4, s62, v2
    v_lshl_add_u32 v44, v4, 5, v3
    s_add_u32 s62, s61, 1
    v_xor_b32 v4, s62, v2
    v_lshl_add_u32 v45, v4, 5, v3
    s_add_u32 s62, s61, 2
    v_xor_b32 v4, s62, v2
    v_lshl_add_u32 v46, v4, 5, v3
    s_lshl_b32 s61, s61, 6
    s_lshl_b32 s62, s67, 10
    s_add_u32 s61, s61, s62
    s_add_u32 s61, s61, s9
    v_lshrrev_b32 v2, 4, v0
    v_lshl_add_u32 v47, v2, 4, s61
    v_mov_b32 v60, 0x3f803f80
    v_mov_b32 v61, 0x3f803f80
    v_mov_b32 v62, 0x3f803f80
    v_mov_b32 v63, 0x3f803f80
    s_waitcnt vmcnt(2)
    s_barrier
    s_add_u32 m0, s81, 2048
    s_sub_u32 s68, s68, 40960
    s_cselect_b32 s68, 81920, s68
    buffer_load_dwordx4 v16, s[20:23], s66 offen lds
    s_add_u32 m0, s81, 3072
    s_cmp_ge_u32 s58, 10
    s_cselect_b32 s60, 10, 0
    s_sub_u32 s58, s58, s60
    s_mul_i32 s12, s58, 196608
    s_add_u32 s13, s68, s69
    buffer_load_dwordx4 v17, s[20:23], s66 offen lds
    s_add_u32 m0, s77, 12288
    s_lshl_b32 s66, s58, 7
    s_add_u32 s58, s58, 1
    s_add_u32 s81, s68, s3
    buffer_load_dwordx4 v11, s[24:27], s65 offen lds
    s_add_u32 m0, s77, 13312
    s_nop 0
    buffer_load_dwordx4 v12, s[24:27], s65 offen lds
    s_add_u32 m0, s77, 14336
    s_nop 0
    buffer_load_dwordx4 v13, s[24:27], s65 offen lds
    s_mov_b32 s65, s12
    s_mov_b32 s77, s13
    s_mov_b32 s59, 0
L_hl_27:
    s_add_u32 m0, s76, 0
    s_nop 0
    buffer_load_dwordx4 v8, s[24:27], s64 offen lds
    s_add_u32 m0, s76, 1024
    s_nop 0
    buffer_load_dwordx4 v9, s[24:27], s64 offen lds
    s_add_u32 m0, s76, 2048
    s_nop 0
    buffer_load_dwordx4 v10, s[24:27], s64 offen lds
    s_add_u32 m0, s81, 0
    s_mov_b32 s64, s65
    buffer_load_dwordx4 v14, s[20:23], s66 offen lds
    s_add_u32 m0, s81, 1024
    s_add_u32 s76, s68, s69
    buffer_load_dwordx4 v15, s[20:23], s66 offen lds
    s_add_u32 m0, s81, 2048
    s_sub_u32 s68, s68, 40960
    s_cselect_b32 s68, 81920, s68
    buffer_load_dwordx4 v16, s[20:23], s66 offen lds
    s_add_u32 m0, s81, 3072
    s_cmp_ge_u32 s58, 10
    s_cselect_b32 s60, 10, 0
    s_sub_u32 s58, s58, s60
    s_mul_i32 s12, s58, 196608
    s_add_u32 s13, s68, s69
    buffer_load_dwordx4 v17, s[20:23], s66 offen lds
    s_add_u32 m0, s77, 12288
    s_lshl_b32 s66, s58, 7
    s_add_u32 s58, s58, 1
    s_add_u32 s81, s68, s3
    buffer_load_dwordx4 v11, s[24:27], s65 offen lds
    s_add_u32 m0, s77, 13312
    s_nop 0
    buffer_load_dwordx4 v12, s[24:27], s65 offen lds
    s_add_u32 m0, s77, 14336
    s_nop 0
    buffer_load_dwordx4 v13, s[24:27], s65 offen lds
    s_mov_b32 s65, s12
    s_mov_b32 s77, s13
    s_bitcmp1_b32 103, s59
    s_cbranch_scc1 L_dsp_35
L_wt_28:
    s_waitcnt vmcnt(7)
L_bar_29:
    s_add_u32 s59, s59, 1
    s_cmp_lt_u32 s59, 8
    s_barrier
    s_cbranch_scc1 L_hl_27
    s_branch L_c8_36
L_dsp_35:
    s_cmp_eq_u32 s59, 1
    s_cbranch_scc1 L_x_31
    s_cmp_eq_u32 s59, 2
    s_cbranch_scc1 L_x_32
    s_cmp_eq_u32 s59, 5
    s_cbranch_scc1 L_x_33
    s_cmp_eq_u32 s59, 6
    s_cbranch_scc1 L_x_34
L_x_30:
    buffer_load_dword v24, v23, s[40:43], 0 offen sc0 sc1
    s_cmp_ge_u32 s54, 10
    s_cbranch_scc1 L_np_37
    ds_read_b64_tr_b16 v[64:65], v44 offset:12288
    ds_read_b64_tr_b16 v[66:67], v44 offset:15360
    ds_read_b64_tr_b16 v[68:69], v44 offset:0
    ds_read_b64_tr_b16 v[70:71], v44 offset:3072
    ds_read_b64_tr_b16 v[72:73], v45 offset:12288
    ds_read_b64_tr_b16 v[74:75], v45 offset:15360
    ds_read_b64_tr_b16 v[76:77], v45 offset:0
    ds_read_b64_tr_b16 v[78:79], v45 offset:3072
    ds_read_b64_tr_b16 v[80:81], v46 offset:12288
    ds_read_b64_tr_b16 v[82:83], v46 offset:15360
    ds_read_b64_tr_b16 v[84:85], v46 offset:0
    ds_read_b64_tr_b16 v[86:87], v46 offset:3072
    s_waitcnt lgkmcnt(0)
    v_mfma_f32_16x16x32_bf16 v[96:99], v[64:67], v[60:63], 0
    v_mfma_f32_16x16x32_bf16 v[100:103], v[72:75], v[60:63], 0
    v_mfma_f32_16x16x32_bf16 v[104:107], v[80:83], v[60:63], 0
    v_mfma_f32_16x16x32_bf16 v[96:99], v[68:71], v[60:63], v[96:99]
    v_mfma_f32_16x16x32_bf16 v[100:103], v[76:79], v[60:63], v[100:103]
    v_mfma_f32_16x16x32_bf16 v[104:107], v[84:87], v[60:63], v[104:107]
    s_mov_b32 exec_lo, 0x10001
    s_mov_b32 exec_hi, 0x10001
    s_nop 3
    buffer_store_dwordx4 v[96:99], v47, s[36:39], 0 offen offset:0 sc0 sc1
    buffer_store_dwordx4 v[100:103], v47, s[36:39], 0 offen offset:64 sc0 sc1
    buffer_store_dwordx4 v[104:107], v47, s[36:39], 0 offen offset:128 sc0 sc1
    s_mov_b64 exec, -1
    s_waitcnt vmcnt(11)
    s_branch L_bar_29
L_np_37:
    s_waitcnt vmcnt(8)
    s_branch L_bar_29
L_x_31:
    s_waitcnt vmcnt(10)
    v_cmp_gt_u32 vcc, 1, v24
    s_nop 4
    s_cbranch_vccz L_sd_39
    s_mov_b32 s61, 20000
L_sp_38:
    buffer_load_dword v24, v23, s[40:43], 0 offen offset:0 sc0 sc1
    s_waitcnt vmcnt(0)
    v_cmp_gt_u32 vcc, 1, v24
    s_nop 4
    s_cbranch_vccz L_sd_39
    s_sub_u32 s61, s61, 1
    s_cbranch_scc0 L_sp_38
L_sd_39:
    s_cmp_lg_u32 s53, 0
    s_cbranch_scc1 L_wt_28
    v_mov_b32 v2, 1
    s_mov_b64 exec, 1
    buffer_atomic_add v2, v57, s[36:39], 0 offen sc1
    s_mov_b64 exec, -1
    s_waitcnt vmcnt(8)
    s_branch L_bar_29
L_x_32:
    s_cmp_ge_u32 s54, 10
    s_cselect_b32 s60, 1, s53
    s_cmp_lg_u32 s60, 0
    s_cbranch_scc1 L_wt_28
    v_mov_b32 v2, 1
    s_mov_b64 exec, 1
    buffer_atomic_add v2, v31, s[36:39], 0 offen sc1
    s_mov_b64 exec, -1
    s_waitcnt vmcnt(8)
    s_branch L_bar_29
L_x_33:
    buffer_load_dword v24, v20, s[36:39], 0 offen sc0 sc1
    s_waitcnt vmcnt(8)
    s_branch L_bar_29
L_x_34:
    s_waitcnt vmcnt(10)
    v_cmp_gt_u32 vcc, v25, v24
    s_nop 4
    s_cbranch_vccz L_sd_41
    s_mov_b32 s61, 20000
L_sp_40:
    buffer_load_dword v24, v20, s[36:39], 0 offen offset:0 sc0 sc1
    s_waitcnt vmcnt(0)
    v_cmp_gt_u32 vcc, v25, v24
    s_nop 4
    s_cbranch_vccz L_sd_41
    s_sub_u32 s61, s61, 1
    s_cbranch_scc0 L_sp_40
L_sd_41:
    buffer_load_dwordx2 v[26:27], v21, s[36:39], 0 offen sc0 sc1
    s_movk_i32 s60, 0
    buffer_load_dword v32, v28, s[36:39], s60 offen sc0 sc1
    s_movk_i32 s60, 1024
    buffer_load_dword v33, v28, s[36:39], s60 offen sc0 sc1
    s_movk_i32 s60, 2048
    buffer_load_dword v34, v28, s[36:39], s60 offen sc0 sc1
    s_movk_i32 s60, 3072
    buffer_load_dword v35, v28, s[36:39], s60 offen sc0 sc1
    s_movk_i32 s60, 4096
    buffer_load_dword v36, v28, s[36:39], s60 offen sc0 sc1
    s_movk_i32 s60, 5120
    buffer_load_dword v37, v28, s[36:39], s60 offen sc0 sc1
    s_movk_i32 s60, 6144
    buffer_load_dword v38, v28, s[36:39], s60 offen sc0 sc1
    s_movk_i32 s60, 7168
    buffer_load_dword v39, v28, s[36:39], s60 offen sc0 sc1
    s_movk_i32 s60, 8192
    buffer_load_dword v40, v28, s[36:39], s60 offen sc0 sc1
    s_movk_i32 s60, 9216
    buffer_load_dword v41, v28, s[36:39], s60 offen sc0 sc1
    s_waitcnt vmcnt(18)
    s_branch L_bar_29
L_c8_36:
    s_add_u32 m0, s76, 0
    s_nop 0
    buffer_load_dwordx4 v8, s[24:27], s64 offen lds
    s_add_u32 m0, s76, 1024
    s_nop 0
    buffer_load_dwordx4 v9, s[24:27], s64 offen lds
    s_add_u32 m0, s76, 2048
    s_nop 0
    buffer_load_dwordx4 v10, s[24:27], s64 offen lds
    s_mov_b32 s4, s78
    s_mul_i32 s11, s17, 12
    s_cmp_ge_u32 s4, 12
    s_cselect_b32 s62, 12, 0
    s_sub_u32 s4, s4, s62
    s_add_u32 s62, s4, s11
    s_mul_i32 s62, s62, 81920
    s_add_u32 s4, s4, 1
    s_add_u32 m0, s6, 147456
    s_nop 0
    buffer_load_dwordx4 v48, s[28:31], s62 offen offset:0 lds
    buffer_load_dwordx4 v49, s[28:31], s62 offen offset:1024 lds
    buffer_load_dwordx4 v50, s[28:31], s62 offen offset:2048 lds
    s_cmp_ge_u32 s4, 12
    s_cselect_b32 s12, 12, 0
    s_sub_u32 s4, s4, s12
    s_add_u32 s12, s4, s11
    s_mul_i32 s12, s12, 81920
    s_add_u32 s4, s4, 1
    s_add_u32 m0, s6, 135168
    s_nop 0
    buffer_load_dwordx4 v48, s[28:31], s12 offen offset:0 lds
    buffer_load_dwordx4 v49, s[28:31], s12 offen offset:1024 lds
    buffer_load_dwordx4 v50, s[28:31], s12 offen offset:2048 lds
    s_waitcnt vmcnt(6)
    s_barrier
    ds_write_b32 v22, v26
    ds_write_b32 v22, v27 offset:576
    v_add_f32 v32, v32, v33
    v_add_f32 v32, v32, v34
    v_add_f32 v32, v32, v35
    v_add_f32 v32, v32, v36
    v_add_f32 v32, v32, v37
    v_add_f32 v32, v32, v38
    v_add_f32 v32, v32, v39
    v_add_f32 v32, v32, v40
    v_add_f32 v32, v32, v41
    ds_write_b32 v29, v32
    s_cmp_ge_u32 s4, 12
    s_cselect_b32 s62, 12, 0
    s_sub_u32 s4, s4, s62
    s_add_u32 s62, s4, s11
    s_mul_i32 s62, s62, 81920
    s_add_u32 s4, s4, 1
    s_add_u32 m0, s6, 122880
    s_nop 0
    buffer_load_dwordx4 v48, s[28:31], s62 offen offset:0 lds
    buffer_load_dwordx4 v49, s[28:31], s62 offen offset:1024 lds
    buffer_load_dwordx4 v50, s[28:31], s62 offen offset:2048 lds
    s_cmp_ge_u32 s4, 12
    s_cselect_b32 s12, 12, 0
    s_sub_u32 s4, s4, s12
    s_add_u32 s12, s4, s11
    s_mul_i32 s12, s12, 81920
    s_add_u32 s4, s4, 1
    s_add_u32 m0, s6, 110592
    s_nop 0
    buffer_load_dwordx4 v48, s[28:31], s12 offen offset:0 lds
    buffer_load_dwordx4 v49, s[28:31], s12 offen offset:1024 lds
    buffer_load_dwordx4 v50, s[28:31], s12 offen offset:2048 lds
    s_waitcnt lgkmcnt(0)
    s_barrier
    s_waitcnt vmcnt(0)
    s_barrier
    s_cmp_ge_u32 s4, 12
    s_cselect_b32 s62, 12, 0
    s_sub_u32 s4, s4, s62
    s_add_u32 s62, s4, s11
    s_mul_i32 s62, s62, 81920
    s_add_u32 s4, s4, 1
    s_add_u32 m0, s6, 98304
    s_nop 0
    buffer_load_dwordx4 v48, s[28:31], s62 offen offset:0 lds
    buffer_load_dwordx4 v49, s[28:31], s62 offen offset:1024 lds
    buffer_load_dwordx4 v50, s[28:31], s62 offen offset:2048 lds
    s_cmp_ge_u32 s4, 12
    s_cselect_b32 s12, 12, 0
    s_sub_u32 s4, s4, s12
    s_add_u32 s12, s4, s11
    s_mul_i32 s12, s12, 81920
    s_add_u32 s4, s4, 1
    s_add_u32 m0, s6, 86016
    s_nop 0
    buffer_load_dwordx4 v48, s[28:31], s12 offen offset:0 lds
    buffer_load_dwordx4 v49, s[28:31], s12 offen offset:1024 lds
    buffer_load_dwordx4 v50, s[28:31], s12 offen offset:2048 lds
    s_cmp_ge_u32 s4, 12
    s_cselect_b32 s62, 12, 0
    s_sub_u32 s4, s4, s62
    s_add_u32 s62, s4, s11
    s_mul_i32 s62, s62, 81920
    s_add_u32 s4, s4, 1
    s_add_u32 m0, s6, 73728
    s_nop 0
    buffer_load_dwordx4 v48, s[28:31], s62 offen offset:0 lds
    buffer_load_dwordx4 v49, s[28:31], s62 offen offset:1024 lds
    buffer_load_dwordx4 v50, s[28:31], s62 offen offset:2048 lds
    s_cmp_ge_u32 s4, 12
    s_cselect_b32 s12, 12, 0
    s_sub_u32 s4, s4, s12
    s_add_u32 s12, s4, s11
    s_mul_i32 s12, s12, 81920
    s_add_u32 s4, s4, 1
    s_add_u32 m0, s6, 61440
    s_nop 0
    buffer_load_dwordx4 v48, s[28:31], s12 offen offset:0 lds
    buffer_load_dwordx4 v49, s[28:31], s12 offen offset:1024 lds
    buffer_load_dwordx4 v50, s[28:31], s12 offen offset:2048 lds
    s_barrier
    s_cmp_ge_u32 s4, 12
    s_cselect_b32 s62, 12, 0
    s_sub_u32 s4, s4, s62
    s_add_u32 s62, s4, s11
    s_mul_i32 s62, s62, 81920
    s_add_u32 s4, s4, 1
    s_add_u32 m0, s6, 147456
    s_nop 0
    buffer_load_dwordx4 v48, s[28:31], s62 offen offset:0 lds
    buffer_load_dwordx4 v49, s[28:31], s62 offen offset:1024 lds
    buffer_load_dwordx4 v50, s[28:31], s62 offen offset:2048 lds
    s_cmp_ge_u32 s4, 12
    s_cselect_b32 s12, 12, 0
    s_sub_u32 s4, s4, s12
    s_add_u32 s12, s4, s11
    s_mul_i32 s12, s12, 81920
    s_add_u32 s4, s4, 1
    s_add_u32 m0, s6, 135168
    s_nop 0
    buffer_load_dwordx4 v48, s[28:31], s12 offen offset:0 lds
    buffer_load_dwordx4 v49, s[28:31], s12 offen offset:1024 lds
    buffer_load_dwordx4 v50, s[28:31], s12 offen offset:2048 lds
    buffer_load_dword v54, v52, s[36:39], 0 offen offset:0 sc0 sc1
    s_cmp_ge_u32 s4, 12
    s_cselect_b32 s62, 12, 0
    s_sub_u32 s4, s4, s62
    s_add_u32 s62, s4, s11
    s_mul_i32 s62, s62, 81920
    s_add_u32 s4, s4, 1
    s_add_u32 m0, s6, 122880
    s_nop 0
    buffer_load_dwordx4 v48, s[28:31], s62 offen offset:0 lds
    buffer_load_dwordx4 v49, s[28:31], s62 offen offset:1024 lds
    buffer_load_dwordx4 v50, s[28:31], s62 offen offset:2048 lds
    s_cmp_ge_u32 s4, 12
    s_cselect_b32 s12, 12, 0
    s_sub_u32 s4, s4, s12
    s_add_u32 s12, s4, s11
    s_mul_i32 s12, s12, 81920
    s_add_u32 s4, s4, 1
    s_add_u32 m0, s6, 110592
    s_nop 0
    buffer_load_dwordx4 v48, s[28:31], s12 offen offset:0 lds
    buffer_load_dwordx4 v49, s[28:31], s12 offen offset:1024 lds
    buffer_load_dwordx4 v50, s[28:31], s12 offen offset:2048 lds
    s_waitcnt vmcnt(6)
    v_cmp_gt_u32 vcc, 4, v54
    s_nop 4
    s_cbranch_vccz L_sd_43
    s_mov_b32 s61, 20000
L_sp_42:
    buffer_load_dword v54, v52, s[36:39], 0 offen offset:0 sc0 sc1
    s_waitcnt vmcnt(0)
    v_cmp_gt_u32 vcc, 4, v54
    s_nop 4
    s_cbranch_vccz L_sd_43
    s_sub_u32 s61, s61, 1
    s_cbranch_scc0 L_sp_42
L_sd_43:
    s_mov_b32 s5, s78
    s_mul_i32 s8, s56, 196608
    s_mul_i32 s63, s17, 98304
    s_add_u32 s8, s8, s63
    s_add_u32 s8, s8, 0
    s_cmp_ge_u32 s5, 12
    s_cselect_b32 s63, 12, 0
    s_sub_u32 s5, s5, s63
    s_lshl_b32 s63, s5, 13
    s_add_u32 s63, s63, s8
    s_add_u32 s5, s5, 1
    s_add_u32 m0, s7, 53248
    s_nop 0
    buffer_load_dwordx4 v51, s[36:39], s63 offen offset:0 sc0 sc1 lds
    buffer_load_dwordx4 v51, s[36:39], s63 offen offset:1024 sc0 sc1 lds
    s_cmp_ge_u32 s5, 12
    s_cselect_b32 s13, 12, 0
    s_sub_u32 s5, s5, s13
    s_lshl_b32 s13, s5, 13
    s_add_u32 s13, s13, s8
    s_add_u32 s5, s5, 1
    s_add_u32 m0, s7, 45056
    s_nop 0
    buffer_load_dwordx4 v51, s[36:39], s13 offen offset:0 sc0 sc1 lds
    buffer_load_dwordx4 v51, s[36:39], s13 offen offset:1024 sc0 sc1 lds
    s_cmp_ge_u32 s5, 12
    s_cselect_b32 s63, 12, 0
    s_sub_u32 s5, s5, s63
    s_lshl_b32 s63, s5, 13
    s_add_u32 s63, s63, s8
    s_add_u32 s5, s5, 1
    s_add_u32 m0, s7, 36864
    s_nop 0
    buffer_load_dwordx4 v51, s[36:39], s63 offen offset:0 sc0 sc1 lds
    buffer_load_dwordx4 v51, s[36:39], s63 offen offset:1024 sc0 sc1 lds
    s_waitcnt vmcnt(4)
    s_barrier
    s_cmp_ge_u32 s5, 12
    s_cselect_b32 s13, 12, 0
    s_sub_u32 s5, s5, s13
    s_lshl_b32 s13, s5, 13
    s_add_u32 s13, s13, s8
    s_add_u32 s5, s5, 1
    s_add_u32 m0, s7, 28672
    s_nop 0
    buffer_load_dwordx4 v51, s[36:39], s13 offen offset:0 sc0 sc1 lds
    buffer_load_dwordx4 v51, s[36:39], s13 offen offset:1024 sc0 sc1 lds
    s_cmp_ge_u32 s5, 12
    s_cselect_b32 s63, 12, 0
    s_sub_u32 s5, s5, s63
    s_lshl_b32 s63, s5, 13
    s_add_u32 s63, s63, s8
    s_add_u32 s5, s5, 1
    s_add_u32 m0, s7, 20480
    s_nop 0
    buffer_load_dwordx4 v51, s[36:39], s63 offen offset:0 sc0 sc1 lds
    buffer_load_dwordx4 v51, s[36:39], s63 offen offset:1024 sc0 sc1 lds
    s_waitcnt vmcnt(6)
    s_barrier
    s_cmp_ge_u32 s5, 12
    s_cselect_b32 s13, 12, 0
    s_sub_u32 s5, s5, s13
    s_lshl_b32 s13, s5, 13
    s_add_u32 s13, s13, s8
    s_add_u32 s5, s5, 1
    s_add_u32 m0, s7, 12288
    s_nop 0
    buffer_load_dwordx4 v51, s[36:39], s13 offen offset:0 sc0 sc1 lds
    buffer_load_dwordx4 v51, s[36:39], s13 offen offset:1024 sc0 sc1 lds
    s_cmp_ge_u32 s5, 12
    s_cselect_b32 s63, 12, 0
    s_sub_u32 s5, s5, s63
    s_lshl_b32 s63, s5, 13
    s_add_u32 s63, s63, s8
    s_add_u32 s5, s5, 1
    s_add_u32 m0, s7, 53248
    s_waitcnt vmcnt(6)
    s_barrier
    buffer_load_dwordx4 v51, s[36:39], s63 offen offset:0 sc0 sc1 lds
    s_cmp_ge_u32 s5, 12
    s_cselect_b32 s13, 12, 0
    s_sub_u32 s5, s5, s13
    s_lshl_b32 s13, s5, 13
    s_add_u32 s13, s13, s8
    s_add_u32 s5, s5, 1
    buffer_load_dwordx4 v51, s[36:39], s63 offen offset:1024 sc0 sc1 lds
    s_add_u32 m0, s7, 45056
    s_waitcnt vmcnt(6)
    s_barrier
    buffer_load_dwordx4 v51, s[36:39], s13 offen offset:0 sc0 sc1 lds
    s_cmp_ge_u32 s5, 12
    s_cselect_b32 s63, 12, 0
    s_sub_u32 s5, s5, s63
    s_lshl_b32 s63, s5, 13
    s_add_u32 s63, s63, s8
    s_add_u32 s5, s5, 1
    buffer_load_dwordx4 v51, s[36:39], s13 offen offset:1024 sc0 sc1 lds
    s_add_u32 m0, s7, 36864
    s_waitcnt vmcnt(6)
    s_barrier
    buffer_load_dwordx4 v51, s[36:39], s63 offen offset:0 sc0 sc1 lds
    s_cmp_ge_u32 s5, 12
    s_cselect_b32 s13, 12, 0
    s_sub_u32 s5, s5, s13
    s_lshl_b32 s13, s5, 13
    s_add_u32 s13, s13, s8
    s_add_u32 s5, s5, 1
    buffer_load_dwordx4 v51, s[36:39], s63 offen offset:1024 sc0 sc1 lds
    s_add_u32 m0, s7, 28672
    s_waitcnt vmcnt(6)
    s_barrier
    buffer_load_dwordx4 v51, s[36:39], s13 offen offset:0 sc0 sc1 lds
    s_cmp_ge_u32 s5, 12
    s_cselect_b32 s63, 12, 0
    s_sub_u32 s5, s5, s63
    s_lshl_b32 s63, s5, 13
    s_add_u32 s63, s63, s8
    s_add_u32 s5, s5, 1
    buffer_load_dwordx4 v51, s[36:39], s13 offen offset:1024 sc0 sc1 lds
    s_mov_b32 s4, s78
    s_mul_i32 s11, s16, 12
    s_cmp_ge_u32 s4, 12
    s_cselect_b32 s62, 12, 0
    s_sub_u32 s4, s4, s62
    s_add_u32 s62, s4, s11
    s_mul_i32 s62, s62, 81920
    s_add_u32 s4, s4, 1
    s_add_u32 m0, s7, 20480
    s_waitcnt vmcnt(6)
    s_barrier
    buffer_load_dword v54, v53, s[36:39], 0 offen offset:0 sc0 sc1
    buffer_load_dwordx4 v51, s[36:39], s63 offen offset:0 sc0 sc1 lds
    s_cmp_ge_u32 s5, 12
    s_cselect_b32 s13, 12, 0
    s_sub_u32 s5, s5, s13
    s_lshl_b32 s13, s5, 13
    s_add_u32 s13, s13, s8
    s_add_u32 s5, s5, 1
    buffer_load_dwordx4 v51, s[36:39], s63 offen offset:1024 sc0 sc1 lds
    s_add_u32 m0, s6, 98304
    s_nop 0
    buffer_load_dwordx4 v48, s[28:31], s62 offen offset:0 lds
    s_cmp_ge_u32 s4, 12
    s_cselect_b32 s12, 12, 0
    s_sub_u32 s4, s4, s12
    s_add_u32 s12, s4, s11
    s_mul_i32 s12, s12, 81920
    s_add_u32 s4, s4, 1
    buffer_load_dwordx4 v49, s[28:31], s62 offen offset:1024 lds
    buffer_load_dwordx4 v50, s[28:31], s62 offen offset:2048 lds
    s_add_u32 m0, s7, 12288
    s_waitcnt vmcnt(10)
    s_barrier
    buffer_load_dwordx4 v51, s[36:39], s13 offen offset:0 sc0 sc1 lds
    s_mov_b32 s5, s78
    s_mul_i32 s8, s56, 196608
    s_mul_i32 s63, s16, 98304
    s_add_u32 s8, s8, s63
    s_add_u32 s8, s8, 0
    s_cmp_ge_u32 s5, 12
    s_cselect_b32 s63, 12, 0
    s_sub_u32 s5, s5, s63
    s_lshl_b32 s63, s5, 13
    s_add_u32 s63, s63, s8
    s_add_u32 s5, s5, 1
    buffer_load_dwordx4 v51, s[36:39], s13 offen offset:1024 sc0 sc1 lds
    s_add_u32 m0, s6, 86016
    s_nop 0
    buffer_load_dwordx4 v48, s[28:31], s12 offen offset:0 lds
    s_cmp_ge_u32 s4, 12
    s_cselect_b32 s62, 12, 0
    s_sub_u32 s4, s4, s62
    s_add_u32 s62, s4, s11
    s_mul_i32 s62, s62, 81920
    s_add_u32 s4, s4, 1
    buffer_load_dwordx4 v49, s[28:31], s12 offen offset:1024 lds
    buffer_load_dwordx4 v50, s[28:31], s12 offen offset:2048 lds
    s_add_u32 m0, s7, 53248
    s_waitcnt vmcnt(13)
    s_barrier
    s_waitcnt vmcnt(10)
    v_cmp_gt_u32 vcc, 4, v54
    s_nop 4
    s_cbranch_vccz L_sd_45
    s_mov_b32 s61, 20000
L_sp_44:
    buffer_load_dword v54, v53, s[36:39], 0 offen offset:0 sc0 sc1
    s_waitcnt vmcnt(0)
    v_cmp_gt_u32 vcc, 4, v54
    s_nop 4
    s_cbranch_vccz L_sd_45
    s_sub_u32 s61, s61, 1
    s_cbranch_scc0 L_sp_44
L_sd_45:
    buffer_load_dwordx4 v51, s[36:39], s63 offen offset:0 sc0 sc1 lds
    s_cmp_ge_u32 s5, 12
    s_cselect_b32 s13, 12, 0
    s_sub_u32 s5, s5, s13
    s_lshl_b32 s13, s5, 13
    s_add_u32 s13, s13, s8
    s_add_u32 s5, s5, 1
    buffer_load_dwordx4 v51, s[36:39], s63 offen offset:1024 sc0 sc1 lds
    s_add_u32 m0, s6, 73728
    s_nop 0
    buffer_load_dwordx4 v48, s[28:31], s62 offen offset:0 lds
    s_cmp_ge_u32 s4, 12
    s_cselect_b32 s12, 12, 0
    s_sub_u32 s4, s4, s12
    s_add_u32 s12, s4, s11
    s_mul_i32 s12, s12, 81920
    s_add_u32 s4, s4, 1
    buffer_load_dwordx4 v49, s[28:31], s62 offen offset:1024 lds
    buffer_load_dwordx4 v50, s[28:31], s62 offen offset:2048 lds
    s_add_u32 m0, s7, 45056
    s_barrier
    buffer_load_dwordx4 v51, s[36:39], s13 offen offset:0 sc0 sc1 lds
    s_cmp_ge_u32 s5, 12
    s_cselect_b32 s63, 12, 0
    s_sub_u32 s5, s5, s63
    s_lshl_b32 s63, s5, 13
    s_add_u32 s63, s63, s8
    s_add_u32 s5, s5, 1
    buffer_load_dwordx4 v51, s[36:39], s13 offen offset:1024 sc0 sc1 lds
    s_add_u32 m0, s6, 61440
    s_nop 0
    buffer_load_dwordx4 v48, s[28:31], s12 offen offset:0 lds
    s_cmp_ge_u32 s4, 12
    s_cselect_b32 s62, 12, 0
    s_sub_u32 s4, s4, s62
    s_add_u32 s62, s4, s11
    s_mul_i32 s62, s62, 81920
    s_add_u32 s4, s4, 1
    buffer_load_dwordx4 v49, s[28:31], s12 offen offset:1024 lds
    buffer_load_dwordx4 v50, s[28:31], s12 offen offset:2048 lds
    s_add_u32 m0, s7, 36864
    s_waitcnt vmcnt(18)
    s_barrier
    buffer_load_dwordx4 v51, s[36:39], s63 offen offset:0 sc0 sc1 lds
    s_cmp_ge_u32 s5, 12
    s_cselect_b32 s13, 12, 0
    s_sub_u32 s5, s5, s13
    s_lshl_b32 s13, s5, 13
    s_add_u32 s13, s13, s8
    s_add_u32 s5, s5, 1
    buffer_load_dwordx4 v51, s[36:39], s63 offen offset:1024 sc0 sc1 lds
    s_add_u32 m0, s6, 147456
    s_nop 0
    buffer_load_dwordx4 v48, s[28:31], s62 offen offset:0 lds
    s_cmp_ge_u32 s4, 12
    s_cselect_b32 s12, 12, 0
    s_sub_u32 s4, s4, s12
    s_add_u32 s12, s4, s11
    s_mul_i32 s12, s12, 81920
    s_add_u32 s4, s4, 1
    buffer_load_dwordx4 v49, s[28:31], s62 offen offset:1024 lds
    buffer_load_dwordx4 v50, s[28:31], s62 offen offset:2048 lds
    s_add_u32 m0, s7, 28672
    s_waitcnt vmcnt(18)
    s_barrier
    buffer_load_dwordx4 v51, s[36:39], s13 offen offset:0 sc0 sc1 lds
    s_cmp_ge_u32 s5, 12
    s_cselect_b32 s63, 12, 0
    s_sub_u32 s5, s5, s63
    s_lshl_b32 s63, s5, 13
    s_add_u32 s63, s63, s8
    s_add_u32 s5, s5, 1
    buffer_load_dwordx4 v51, s[36:39], s13 offen offset:1024 sc0 sc1 lds
    s_add_u32 m0, s6, 135168
    s_nop 0
    buffer_load_dwordx4 v48, s[28:31], s12 offen offset:0 lds
    s_cmp_ge_u32 s4, 12
    s_cselect_b32 s62, 12, 0
    s_sub_u32 s4, s4, s62
    s_add_u32 s62, s4, s11
    s_mul_i32 s62, s62, 81920
    s_add_u32 s4, s4, 1
    buffer_load_dwordx4 v49, s[28:31], s12 offen offset:1024 lds
    buffer_load_dwordx4 v50, s[28:31], s12 offen offset:2048 lds
    s_add_u32 m0, s7, 20480
    s_waitcnt vmcnt(18)
    s_barrier
    buffer_load_dwordx4 v51, s[36:39], s63 offen offset:0 sc0 sc1 lds
    s_cmp_ge_u32 s5, 12
    s_cselect_b32 s13, 12, 0
    s_sub_u32 s5, s5, s13
    s_lshl_b32 s13, s5, 13
    s_add_u32 s13, s13, s8
    s_add_u32 s5, s5, 1
    buffer_load_dwordx4 v51, s[36:39], s63 offen offset:1024 sc0 sc1 lds
    s_add_u32 m0, s6, 122880
    s_nop 0
    buffer_load_dwordx4 v48, s[28:31], s62 offen offset:0 lds
    s_cmp_ge_u32 s4, 12
    s_cselect_b32 s12, 12, 0
    s_sub_u32 s4, s4, s12
    s_add_u32 s12, s4, s11
    s_mul_i32 s12, s12, 81920
    s_add_u32 s4, s4, 1
    buffer_load_dwordx4 v49, s[28:31], s62 offen offset:1024 lds
    buffer_load_dwordx4 v50, s[28:31], s62 offen offset:2048 lds
    s_add_u32 m0, s7, 12288
    s_waitcnt vmcnt(18)
    s_barrier
    buffer_load_dwordx4 v51, s[36:39], s13 offen offset:0 sc0 sc1 lds
    s_cmp_ge_u32 s5, 12
    s_cselect_b32 s63, 12, 0
    s_sub_u32 s5, s5, s63
    s_lshl_b32 s63, s5, 13
    s_add_u32 s63, s63, s8
    s_add_u32 s5, s5, 1
    buffer_load_dwordx4 v51, s[36:39], s13 offen offset:1024 sc0 sc1 lds
    s_add_u32 m0, s6, 110592
    s_nop 0
    buffer_load_dwordx4 v48, s[28:31], s12 offen offset:0 lds
    s_cmp_ge_u32 s4, 12
    s_cselect_b32 s62, 12, 0
    s_sub_u32 s4, s4, s62
    s_add_u32 s62, s4, s11
    s_mul_i32 s62, s62, 81920
    s_add_u32 s4, s4, 1
    buffer_load_dwordx4 v49, s[28:31], s12 offen offset:1024 lds
    buffer_load_dwordx4 v50, s[28:31], s12 offen offset:2048 lds
    s_add_u32 m0, s7, 53248
    s_waitcnt vmcnt(18)
    s_barrier
    buffer_load_dwordx4 v51, s[36:39], s63 offen offset:0 sc0 sc1 lds
    s_cmp_ge_u32 s5, 12
    s_cselect_b32 s13, 12, 0
    s_sub_u32 s5, s5, s13
    s_lshl_b32 s13, s5, 13
    s_add_u32 s13, s13, s8
    s_add_u32 s5, s5, 1
    buffer_load_dwordx4 v51, s[36:39], s63 offen offset:1024 sc0 sc1 lds
    s_add_u32 m0, s6, 98304
    s_nop 0
    buffer_load_dwordx4 v48, s[28:31], s62 offen offset:0 lds
    s_cmp_ge_u32 s4, 12
    s_cselect_b32 s12, 12, 0
    s_sub_u32 s4, s4, s12
    s_add_u32 s12, s4, s11
    s_mul_i32 s12, s12, 81920
    s_add_u32 s4, s4, 1
    buffer_load_dwordx4 v49, s[28:31], s62 offen offset:1024 lds
    buffer_load_dwordx4 v50, s[28:31], s62 offen offset:2048 lds
    s_add_u32 m0, s7, 45056
    s_waitcnt vmcnt(18)
    s_barrier
    buffer_load_dwordx4 v51, s[36:39], s13 offen offset:0 sc0 sc1 lds
    s_cmp_ge_u32 s5, 12
    s_cselect_b32 s63, 12, 0
    s_sub_u32 s5, s5, s63
    s_lshl_b32 s63, s5, 13
    s_add_u32 s63, s63, s8
    s_add_u32 s5, s5, 1
    buffer_load_dwordx4 v51, s[36:39], s13 offen offset:1024 sc0 sc1 lds
    s_add_u32 m0, s6, 86016
    s_nop 0
    buffer_load_dwordx4 v48, s[28:31], s12 offen offset:0 lds
    s_cmp_ge_u32 s4, 12
    s_cselect_b32 s62, 12, 0
    s_sub_u32 s4, s4, s62
    s_add_u32 s62, s4, s11
    s_mul_i32 s62, s62, 81920
    s_add_u32 s4, s4, 1
    buffer_load_dwordx4 v49, s[28:31], s12 offen offset:1024 lds
    buffer_load_dwordx4 v50, s[28:31], s12 offen offset:2048 lds
    s_add_u32 m0, s7, 36864
    s_waitcnt vmcnt(18)
    s_barrier
    buffer_load_dwordx4 v51, s[36:39], s63 offen offset:0 sc0 sc1 lds
    s_cmp_ge_u32 s5, 12
    s_cselect_b32 s13, 12, 0
    s_sub_u32 s5, s5, s13
    s_lshl_b32 s13, s5, 13
    s_add_u32 s13, s13, s8
    s_add_u32 s5, s5, 1
    buffer_load_dwordx4 v51, s[36:39], s63 offen offset:1024 sc0 sc1 lds
    s_add_u32 m0, s6, 73728
    s_nop 0
    buffer_load_dwordx4 v48, s[28:31], s62 offen offset:0 lds
    s_cmp_ge_u32 s4, 12
    s_cselect_b32 s12, 12, 0
    s_sub_u32 s4, s4, s12
    s_add_u32 s12, s4, s11
    s_mul_i32 s12, s12, 81920
    s_add_u32 s4, s4, 1
    buffer_load_dwordx4 v49, s[28:31], s62 offen offset:1024 lds
    buffer_load_dwordx4 v50, s[28:31], s62 offen offset:2048 lds
    s_add_u32 m0, s7, 28672
    s_waitcnt vmcnt(18)
    s_barrier
    buffer_load_dwordx4 v51, s[36:39], s13 offen offset:0 sc0 sc1 lds
    s_cmp_ge_u32 s5, 12
    s_cselect_b32 s63, 12, 0
    s_sub_u32 s5, s5, s63
    s_lshl_b32 s63, s5, 13
    s_add_u32 s63, s63, s8
    s_add_u32 s5, s5, 1
    buffer_load_dwordx4 v51, s[36:39], s13 offen offset:1024 sc0 sc1 lds
    s_add_u32 m0, s6, 61440
    s_nop 0
    buffer_load_dwordx4 v48, s[28:31], s12 offen offset:0 lds
    s_mov_b32 s4, s79
    s_mul_i32 s11, s17, 5
    s_cmp_ge_u32 s4, 5
    s_cselect_b32 s62, 5, 0
    s_sub_u32 s4, s4, s62
    s_add_u32 s62, s4, s11
    s_mul_i32 s62, s62, 81920
    s_add_u32 s4, s4, 1
    buffer_load_dwordx4 v49, s[28:31], s12 offen offset:1024 lds
    buffer_load_dwordx4 v50, s[28:31], s12 offen offset:2048 lds
    s_add_u32 m0, s7, 20480
    s_waitcnt vmcnt(18)
    s_barrier
    buffer_load_dword v54, v52, s[36:39], 0 offen offset:256 sc0 sc1
    buffer_load_dwordx4 v51, s[36:39], s63 offen offset:0 sc0 sc1 lds
    s_cmp_ge_u32 s5, 12
    s_cselect_b32 s13, 12, 0
    s_sub_u32 s5, s5, s13
    s_lshl_b32 s13, s5, 13
    s_add_u32 s13, s13, s8
    s_add_u32 s5, s5, 1
    buffer_load_dwordx4 v51, s[36:39], s63 offen offset:1024 sc0 sc1 lds
    s_add_u32 m0, s6, 147456
    s_nop 0
    buffer_load_dwordx4 v48, s[32:35], s62 offen offset:0 lds
    s_cmp_ge_u32 s4, 5
    s_cselect_b32 s12, 5, 0
    s_sub_u32 s4, s4, s12
    s_add_u32 s12, s4, s11
    s_mul_i32 s12, s12, 81920
    s_add_u32 s4, s4, 1
    buffer_load_dwordx4 v49, s[32:35], s62 offen offset:1024 lds
    buffer_load_dwordx4 v50, s[32:35], s62 offen offset:2048 lds
    s_add_u32 m0, s7, 12288
    s_waitcnt vmcnt(19)
    s_barrier
    buffer_load_dwordx4 v51, s[36:39], s13 offen offset:0 sc0 sc1 lds
    s_mov_b32 s5, s79
    s_mul_i32 s8, s56, 81920
    s_mul_i32 s63, s17, 40960
    s_add_u32 s8, s8, s63
    s_add_u32 s8, s8, 6291456
    s_cmp_ge_u32 s5, 5
    s_cselect_b32 s63, 5, 0
    s_sub_u32 s5, s5, s63
    s_lshl_b32 s63, s5, 13
    s_add_u32 s63, s63, s8
    s_add_u32 s5, s5, 1
    buffer_load_dwordx4 v51, s[36:39], s13 offen offset:1024 sc0 sc1 lds
    s_add_u32 m0, s6, 135168
    s_nop 0
    buffer_load_dwordx4 v48, s[32:35], s12 offen offset:0 lds
    s_cmp_ge_u32 s4, 5
    s_cselect_b32 s62, 5, 0
    s_sub_u32 s4, s4, s62
    s_add_u32 s62, s4, s11
    s_mul_i32 s62, s62, 81920
    s_add_u32 s4, s4, 1
    buffer_load_dwordx4 v49, s[32:35], s12 offen offset:1024 lds
    buffer_load_dwordx4 v50, s[32:35], s12 offen offset:2048 lds
    s_add_u32 m0, s7, 53248
    s_waitcnt vmcnt(19)
    s_barrier
    s_waitcnt vmcnt(10)
    v_cmp_gt_u32 vcc, 4, v54
    s_nop 4
    s_cbranch_vccz L_sd_47
    s_mov_b32 s61, 20000
L_sp_46:
    buffer_load_dword v54, v52, s[36:39], 0 offen offset:256 sc0 sc1
    s_waitcnt vmcnt(0)
    v_cmp_gt_u32 vcc, 4, v54
    s_nop 4
    s_cbranch_vccz L_sd_47
    s_sub_u32 s61, s61, 1
    s_cbranch_scc0 L_sp_46
L_sd_47:
    buffer_load_dwordx4 v51, s[36:39], s63 offen offset:0 sc0 sc1 lds
    s_cmp_ge_u32 s5, 5
    s_cselect_b32 s13, 5, 0
    s_sub_u32 s5, s5, s13
    s_lshl_b32 s13, s5, 13
    s_add_u32 s13, s13, s8
    s_add_u32 s5, s5, 1
    buffer_load_dwordx4 v51, s[36:39], s63 offen offset:1024 sc0 sc1 lds
    s_add_u32 m0, s6, 122880
    s_nop 0
    buffer_load_dwordx4 v48, s[32:35], s62 offen offset:0 lds
    s_cmp_ge_u32 s4, 5
    s_cselect_b32 s12, 5, 0
    s_sub_u32 s4, s4, s12
    s_add_u32 s12, s4, s11
    s_mul_i32 s12, s12, 81920
    s_add_u32 s4, s4, 1
    buffer_load_dwordx4 v49, s[32:35], s62 offen offset:1024 lds
    buffer_load_dwordx4 v50, s[32:35], s62 offen offset:2048 lds
    s_add_u32 m0, s7, 45056
    s_barrier
    buffer_load_dwordx4 v51, s[36:39], s13 offen offset:0 sc0 sc1 lds
    s_cmp_ge_u32 s5, 5
    s_cselect_b32 s63, 5, 0
    s_sub_u32 s5, s5, s63
    s_lshl_b32 s63, s5, 13
    s_add_u32 s63, s63, s8
    s_add_u32 s5, s5, 1
    buffer_load_dwordx4 v51, s[36:39], s13 offen offset:1024 sc0 sc1 lds
    s_add_u32 m0, s6, 110592
    s_nop 0
    buffer_load_dwordx4 v48, s[32:35], s12 offen offset:0 lds
    s_cmp_ge_u32 s4, 5
    s_cselect_b32 s62, 5, 0
    s_sub_u32 s4, s4, s62
    s_add_u32 s62, s4, s11
    s_mul_i32 s62, s62, 81920
    s_add_u32 s4, s4, 1
    buffer_load_dwordx4 v49, s[32:35], s12 offen offset:1024 lds
    buffer_load_dwordx4 v50, s[32:35], s12 offen offset:2048 lds
    s_add_u32 m0, s7, 36864
    s_waitcnt vmcnt(18)
    s_barrier
    buffer_load_dwordx4 v51, s[36:39], s63 offen offset:0 sc0 sc1 lds
    s_cmp_ge_u32 s5, 5
    s_cselect_b32 s13, 5, 0
    s_sub_u32 s5, s5, s13
    s_lshl_b32 s13, s5, 13
    s_add_u32 s13, s13, s8
    s_add_u32 s5, s5, 1
    buffer_load_dwordx4 v51, s[36:39], s63 offen offset:1024 sc0 sc1 lds
    s_add_u32 m0, s6, 98304
    s_nop 0
    buffer_load_dwordx4 v48, s[32:35], s62 offen offset:0 lds
    s_mov_b32 s4, s79
    s_mul_i32 s11, s16, 5
    s_cmp_ge_u32 s4, 5
    s_cselect_b32 s12, 5, 0
    s_sub_u32 s4, s4, s12
    s_add_u32 s12, s4, s11
    s_mul_i32 s12, s12, 81920
    s_add_u32 s4, s4, 1
    buffer_load_dwordx4 v49, s[32:35], s62 offen offset:1024 lds
    buffer_load_dwordx4 v50, s[32:35], s62 offen offset:2048 lds
    s_add_u32 m0, s7, 28672
    s_waitcnt vmcnt(18)
    s_barrier
    buffer_load_dword v54, v53, s[36:39], 0 offen offset:256 sc0 sc1
    buffer_load_dwordx4 v51, s[36:39], s13 offen offset:0 sc0 sc1 lds
    s_cmp_ge_u32 s5, 5
    s_cselect_b32 s63, 5, 0
    s_sub_u32 s5, s5, s63
    s_lshl_b32 s63, s5, 13
    s_add_u32 s63, s63, s8
    s_add_u32 s5, s5, 1
    buffer_load_dwordx4 v51, s[36:39], s13 offen offset:1024 sc0 sc1 lds
    s_add_u32 m0, s6, 86016
    s_nop 0
    buffer_load_dwordx4 v48, s[32:35], s12 offen offset:0 lds
    s_cmp_ge_u32 s4, 5
    s_cselect_b32 s62, 5, 0
    s_sub_u32 s4, s4, s62
    s_add_u32 s62, s4, s11
    s_mul_i32 s62, s62, 81920
    s_add_u32 s4, s4, 1
    buffer_load_dwordx4 v49, s[32:35], s12 offen offset:1024 lds
    buffer_load_dwordx4 v50, s[32:35], s12 offen offset:2048 lds
    s_add_u32 m0, s7, 20480
    s_waitcnt vmcnt(19)
    s_barrier
    buffer_load_dwordx4 v51, s[36:39], s63 offen offset:0 sc0 sc1 lds
    s_mov_b32 s5, s79
    s_mul_i32 s8, s56, 81920
    s_mul_i32 s13, s16, 40960
    s_add_u32 s8, s8, s13
    s_add_u32 s8, s8, 6291456
    s_cmp_ge_u32 s5, 5
    s_cselect_b32 s13, 5, 0
    s_sub_u32 s5, s5, s13
    s_lshl_b32 s13, s5, 13
    s_add_u32 s13, s13, s8
    s_add_u32 s5, s5, 1
    buffer_load_dwordx4 v51, s[36:39], s63 offen offset:1024 sc0 sc1 lds
    s_add_u32 m0, s6, 73728
    s_nop 0
    buffer_load_dwordx4 v48, s[32:35], s62 offen offset:0 lds
    s_cmp_ge_u32 s4, 5
    s_cselect_b32 s12, 5, 0
    s_sub_u32 s4, s4, s12
    s_add_u32 s12, s4, s11
    s_mul_i32 s12, s12, 81920
    s_add_u32 s4, s4, 1
    buffer_load_dwordx4 v49, s[32:35], s62 offen offset:1024 lds
    buffer_load_dwordx4 v50, s[32:35], s62 offen offset:2048 lds
    s_add_u32 m0, s7, 12288
    s_waitcnt vmcnt(19)
    s_barrier
    s_waitcnt vmcnt(10)
    v_cmp_gt_u32 vcc, 4, v54
    s_nop 4
    s_cbranch_vccz L_sd_49
    s_mov_b32 s61, 20000
L_sp_48:
    buffer_load_dword v54, v53, s[36:39], 0 offen offset:256 sc0 sc1
    s_waitcnt vmcnt(0)
    v_cmp_gt_u32 vcc, 4, v54
    s_nop 4
    s_cbranch_vccz L_sd_49
    s_sub_u32 s61, s61, 1
    s_cbranch_scc0 L_sp_48
L_sd_49:
    buffer_load_dwordx4 v51, s[36:39], s13 offen offset:0 sc0 sc1 lds
    s_cmp_ge_u32 s5, 5
    s_cselect_b32 s63, 5, 0
    s_sub_u32 s5, s5, s63
    s_lshl_b32 s63, s5, 13
    s_add_u32 s63, s63, s8
    s_add_u32 s5, s5, 1
    buffer_load_dwordx4 v51, s[36:39], s13 offen offset:1024 sc0 sc1 lds
    s_add_u32 m0, s6, 61440
    s_nop 0
    buffer_load_dwordx4 v48, s[32:35], s12 offen offset:0 lds
    s_cmp_ge_u32 s4, 5
    s_cselect_b32 s62, 5, 0
    s_sub_u32 s4, s4, s62
    s_add_u32 s62, s4, s11
    s_mul_i32 s62, s62, 81920
    s_add_u32 s4, s4, 1
    buffer_load_dwordx4 v49, s[32:35], s12 offen offset:1024 lds
    buffer_load_dwordx4 v50, s[32:35], s12 offen offset:2048 lds
    s_add_u32 m0, s7, 53248
    s_barrier
    buffer_load_dwordx4 v51, s[36:39], s63 offen offset:0 sc0 sc1 lds
    s_cmp_ge_u32 s5, 5
    s_cselect_b32 s13, 5, 0
    s_sub_u32 s5, s5, s13
    s_lshl_b32 s13, s5, 13
    s_add_u32 s13, s13, s8
    s_add_u32 s5, s5, 1
    buffer_load_dwordx4 v51, s[36:39], s63 offen offset:1024 sc0 sc1 lds
    s_add_u32 m0, s6, 147456
    s_nop 0
    buffer_load_dwordx4 v48, s[32:35], s62 offen offset:0 lds
    s_cmp_ge_u32 s4, 5
    s_cselect_b32 s12, 5, 0
    s_sub_u32 s4, s4, s12
    s_add_u32 s12, s4, s11
    s_mul_i32 s12, s12, 81920
    s_add_u32 s4, s4, 1
    buffer_load_dwordx4 v49, s[32:35], s62 offen offset:1024 lds
    buffer_load_dwordx4 v50, s[32:35], s62 offen offset:2048 lds
    s_add_u32 m0, s7, 45056
    s_waitcnt vmcnt(18)
    s_barrier
    buffer_load_dwordx4 v51, s[36:39], s13 offen offset:0 sc0 sc1 lds
    s_cmp_ge_u32 s5, 5
    s_cselect_b32 s63, 5, 0
    s_sub_u32 s5, s5, s63
    s_lshl_b32 s63, s5, 13
    s_add_u32 s63, s63, s8
    s_add_u32 s5, s5, 1
    buffer_load_dwordx4 v51, s[36:39], s13 offen offset:1024 sc0 sc1 lds
    s_add_u32 m0, s6, 135168
    s_nop 0
    buffer_load_dwordx4 v48, s[32:35], s12 offen offset:0 lds
    buffer_load_dwordx4 v49, s[32:35], s12 offen offset:1024 lds
    buffer_load_dwordx4 v50, s[32:35], s12 offen offset:2048 lds
    s_add_u32 m0, s7, 36864
    s_waitcnt vmcnt(18)
    s_barrier
    buffer_load_dwordx4 v51, s[36:39], s63 offen offset:0 sc0 sc1 lds
    s_cmp_ge_u32 s5, 5
    s_cselect_b32 s13, 5, 0
    s_sub_u32 s5, s5, s13
    s_lshl_b32 s13, s5, 13
    s_add_u32 s13, s13, s8
    s_add_u32 s5, s5, 1
    buffer_load_dwordx4 v51, s[36:39], s63 offen offset:1024 sc0 sc1 lds
    s_add_u32 m0, s7, 28672
    s_waitcnt vmcnt(15)
    s_barrier
    buffer_load_dwordx4 v51, s[36:39], s13 offen offset:0 sc0 sc1 lds
    buffer_load_dwordx4 v51, s[36:39], s13 offen offset:1024 sc0 sc1 lds
    s_waitcnt vmcnt(12)
    s_barrier
    s_waitcnt vmcnt(7)
    s_barrier
    s_waitcnt vmcnt(2)
    s_barrier
    s_waitcnt vmcnt(0)
    s_barrier
    s_endpgm
L_QC_a:
    s_and_b32 s63, s55, 1
    s_lshl1_add_u32 s56, s54, s63
    s_lshr_b32 s57, s55, 1
    s_and_b32 s63, s57, 1
    s_lshr_b32 s61, s2, 7
    s_and_b32 s60, s56, 7
    s_lshl1_add_u32 s63, s61, s63
    s_mul_i32 s61, s60, 3
    s_lshr_b32 s61, s61, 1
    s_mul_i32 s78, s63, 3
    s_add_u32 s78, s78, s61
    s_mul_i32 s60, s60, 5
    s_lshr_b32 s60, s60, 3
    s_add_u32 s79, s60, s63
    s_waitcnt lgkmcnt(0)
    s_mov_b32 s20, s4
    s_mov_b32 s21, s5
    s_mov_b32 s22, 2621440
    s_mov_b32 s23, 0x20000
    s_mov_b32 s36, s10
    s_mov_b32 s37, s11
    s_mov_b32 s38, 33554432
    s_mov_b32 s39, 0x20000
    s_mov_b32 s40, s18
    s_mov_b32 s41, s19
    s_mov_b32 s42, 256
    s_mov_b32 s43, 0x20000
    s_mov_b32 s48, s16
    s_mov_b32 s49, s17
    s_mov_b32 s50, 2621440
    s_mov_b32 s51, 0x20000
    s_cmp_ge_u32 s53, 2
    s_cbranch_scc1 L_nl_51
    s_lshl4_add_u32 s60, s54, s55
    s_add_u32 s60, s60, 0
    s_lshl1_add_u32 s60, s60, s53
    s_lshl_b32 s60, s60, 2
    v_lshrrev_b32 v80, 4, v0
    v_add_u32 v80, s60, v80
    v_mul_u32_u24 v81, 1280, v80
    v_and_b32 v82, 15, v0
    v_lshl_add_u32 v81, v82, 4, v81
    buffer_load_dwordx4 v[60:63], v81, s[20:23], 0 offen offset:0
    buffer_load_dwordx4 v[64:67], v81, s[20:23], 0 offen offset:256
    buffer_load_dwordx4 v[68:71], v81, s[20:23], 0 offen offset:512
    buffer_load_dwordx4 v[72:75], v81, s[20:23], 0 offen offset:768
    buffer_load_dwordx4 v[76:79], v81, s[20:23], 0 offen offset:1024
L_nl_51:
    s_getpc_b64 s[32:33]
L_pc_52:
    s_lshr_b32 s60, s2, 3
    s_lshl2_add_u32 s60, s60, s53
    s_mul_i32 s60, s60, 448
    s_min_u32 s60, s60, L_end_a-L_helper_a-448
    s_sub_u32 s32, s32, L_pc_52-L_helper_a
    s_subb_u32 s33, s33, 0
    s_add_u32 s32, s32, s60
    s_addc_u32 s33, s33, 0
    s_load_dword s101, s[32:33], 0
    s_load_dword s101, s[32:33], 64
    s_load_dword s101, s[32:33], 128
    s_load_dword s101, s[32:33], 192
    s_load_dword s101, s[32:33], 256
    s_load_dword s101, s[32:33], 320
    s_load_dword s101, s[32:33], 384
    s_xor_b32 s60, s53, 3
    s_or_b32 s60, s2, s60
    s_cmp_lg_u32 s60, 0
    s_cbranch_scc1 L_nf_53
    v_lshlrev_b32 v2, 7, v0
    v_add_u32 v2, 16777216, v2
    v_mov_b32 v3, 0
    s_movk_i32 s60, 0x2000
    buffer_store_dword v3, v2, s[36:39], 0 offen sc0 sc1
    buffer_store_dword v3, v2, s[36:39], s60 offen sc0 sc1
    s_waitcnt vmcnt(0)
    v_mov_b32 v2, 1
    s_mov_b64 exec, 1
    buffer_store_dword v2, v3, s[40:43], 0 offen sc0 sc1
    s_mov_b64 exec, -1
L_nf_53:
    v_lshrrev_b32 v6, 4, v0
    v_and_b32 v7, 15, v0
    v_cmp_le_u32 s[70:71], 1, v6
    v_cmp_le_u32 s[72:73], 2, v6
    v_cmp_le_u32 s[74:75], 3, v6
    s_or_b32 s63, s54, s53
    s_cmp_eq_u32 s63, 0
    s_cselect_b64 s[66:67], 0, -1
    v_mov_b32 v40, 0xf149f2ca
    v_mov_b32 v41, 0
    v_mov_b32 v42, 0xffff
    v_mov_b32 v43, 0xffff0000
    v_mov_b32 v20, 0
    v_mov_b32 v21, 0
    v_mov_b32 v22, 0
    v_mov_b32 v23, 0
    v_mov_b32 v24, 0
    v_mov_b32 v25, 0
    v_lshl_add_u32 v44, v6, 2, 0
    v_sub_u32 v45, v7, v44
    v_and_b32 v46, 0x80000001, v45
    v_cmp_eq_u32 vcc, 0, v46
    s_nop 1
    v_cndmask_b32 v8, v40, v41, vcc
    v_cndmask_b32 v47, v41, v42, vcc
    v_or_b32 v20, v20, v47
    v_cmp_eq_u32 vcc, 0x80000000, v46
    s_nop 1
    v_cndmask_b32 v16, v40, v41, vcc
    v_cndmask_b32 v47, v41, v42, vcc
    v_or_b32 v24, v24, v47
    s_and_b64 vcc, vcc, s[66:67]
    v_cndmask_b32 v12, v40, v41, vcc
    v_cndmask_b32 v47, v41, v42, vcc
    v_or_b32 v22, v22, v47
    v_lshl_add_u32 v44, v6, 2, 1
    v_sub_u32 v45, v7, v44
    v_and_b32 v46, 0x80000001, v45
    v_cmp_eq_u32 vcc, 0, v46
    s_nop 1
    v_cndmask_b32 v9, v40, v41, vcc
    v_cndmask_b32 v47, v41, v43, vcc
    v_or_b32 v20, v20, v47
    v_cmp_eq_u32 vcc, 0x80000000, v46
    s_nop 1
    v_cndmask_b32 v17, v40, v41, vcc
    v_cndmask_b32 v47, v41, v43, vcc
    v_or_b32 v24, v24, v47
    s_and_b64 vcc, vcc, s[66:67]
    v_cndmask_b32 v13, v40, v41, vcc
    v_cndmask_b32 v47, v41, v43, vcc
    v_or_b32 v22, v22, v47
    v_lshl_add_u32 v44, v6, 2, 2
    v_sub_u32 v45, v7, v44
    v_and_b32 v46, 0x80000001, v45
    v_cmp_eq_u32 vcc, 0, v46
    s_nop 1
    v_cndmask_b32 v10, v40, v41, vcc
    v_cndmask_b32 v47, v41, v42, vcc
    v_or_b32 v21, v21, v47
    v_cmp_eq_u32 vcc, 0x80000000, v46
    s_nop 1
    v_cndmask_b32 v18, v40, v41, vcc
    v_cndmask_b32 v47, v41, v42, vcc
    v_or_b32 v25, v25, v47
    s_and_b64 vcc, vcc, s[66:67]
    v_cndmask_b32 v14, v40, v41, vcc
    v_cndmask_b32 v47, v41, v42, vcc
    v_or_b32 v23, v23, v47
    v_lshl_add_u32 v44, v6, 2, 3
    v_sub_u32 v45, v7, v44
    v_and_b32 v46, 0x80000001, v45
    v_cmp_eq_u32 vcc, 0, v46
    s_nop 1
    v_cndmask_b32 v11, v40, v41, vcc
    v_cndmask_b32 v47, v41, v43, vcc
    v_or_b32 v21, v21, v47
    v_cmp_eq_u32 vcc, 0x80000000, v46
    s_nop 1
    v_cndmask_b32 v19, v40, v41, vcc
    v_cndmask_b32 v47, v41, v43, vcc
    v_or_b32 v25, v25, v47
    s_and_b64 vcc, vcc, s[66:67]
    v_cndmask_b32 v15, v40, v41, vcc
    v_cndmask_b32 v47, v41, v43, vcc
    v_or_b32 v23, v23, v47
    v_mov_b32 v28, 0x3f803f80
    s_lshl_b32 s60, s53, 7
    s_add_u32 s60, s60, 160832
    s_mov_b32 s61, 160768
    s_mov_b32 s62, 161920
    v_lshl_add_u32 v29, v7, 2, s60
    v_lshl_add_u32 v30, v7, 2, s61
    v_lshl_add_u32 v31, v6, 4, s60
    v_lshl_add_u32 v32, v6, 4, s61
    v_lshl_add_u32 v33, v6, 4, s62
    v_lshl_add_u32 v34, v7, 2, s62
    s_mul_i32 s60, s53, 5120
    s_add_u32 s60, s60, 15360
    v_lshl_add_u32 v26, v0, 4, s60
    v_lshl_add_u32 v35, v0, 3, s60
    v_lshlrev_b32 v27, 3, v0
    s_lshr_b32 s60, s53, 1
    s_lshl1_add_u32 s60, s54, s60
    s_mul_i32 s60, s60, 81920
    s_and_b32 s61, s53, 1
    s_lshl_b32 s61, s61, 12
    s_add_u32 s60, s60, s61
    s_add_u32 s60, s60, 6291456
    s_mul_i32 s61, s55, 5
    s_add_u32 s62, s61, 0
    s_lshr_b32 s63, s62, 2
    s_lshl_b32 s63, s63, 13
    s_and_b32 s62, s62, 3
    s_lshl_b32 s62, s62, 9
    s_add_u32 s8, s60, s63
    s_add_u32 s8, s8, s62
    s_add_u32 s62, s61, 1
    s_lshr_b32 s63, s62, 2
    s_lshl_b32 s63, s63, 13
    s_and_b32 s62, s62, 3
    s_lshl_b32 s62, s62, 9
    s_add_u32 s9, s60, s63
    s_add_u32 s9, s9, s62
    s_add_u32 s62, s61, 2
    s_lshr_b32 s63, s62, 2
    s_lshl_b32 s63, s63, 13
    s_and_b32 s62, s62, 3
    s_lshl_b32 s62, s62, 9
    s_add_u32 s12, s60, s63
    s_add_u32 s12, s12, s62
    s_add_u32 s62, s61, 3
    s_lshr_b32 s63, s62, 2
    s_lshl_b32 s63, s63, 13
    s_and_b32 s62, s62, 3
    s_lshl_b32 s62, s62, 9
    s_add_u32 s13, s60, s63
    s_add_u32 s13, s13, s62
    s_add_u32 s62, s61, 4
    s_lshr_b32 s63, s62, 2
    s_lshl_b32 s63, s63, 13
    s_and_b32 s62, s62, 3
    s_lshl_b32 s62, s62, 9
    s_add_u32 s14, s60, s63
    s_add_u32 s14, s14, s62
    v_bfe_u32 v6, v0, 2, 3
    v_lshrrev_b32 v7, 5, v0
    v_lshl_add_u32 v6, v7, 4, v6
    v_mul_u32_u24 v6, 480, v6
    v_and_b32 v7, 3, v0
    v_lshl_add_u32 v1, v7, 3, v6
    s_lshl_b32 s60, s53, 12
    s_add_u32 s60, s60, 32768
    v_and_b32 v6, 15, v0
    v_lshrrev_b32 v3, 1, v6
    v_lshrrev_b32 v2, 4, v0
    v_xor_b32 v2, v2, v3
    v_lshlrev_b32 v2, 4, v2
    v_lshl_add_u32 v2, v6, 7, v2
    v_add_u32 v2, s60, v2
    v_xor_b32 v3, 64, v2
    s_mov_b32 s60, 30720
    v_and_b32 v6, 15, v0
    v_lshrrev_b32 v5, 1, v6
    v_lshrrev_b32 v4, 4, v0
    v_xor_b32 v4, v4, v5
    v_lshlrev_b32 v4, 4, v4
    v_lshl_add_u32 v4, v6, 7, v4
    v_add_u32 v4, s60, v4
    v_xor_b32 v5, 64, v4
    v_mov_b32 v120, 0
    v_mov_b32 v121, 0
    v_mov_b32 v122, 0
    v_mov_b32 v123, 0
    v_mov_b32 v124, 0
    v_mov_b32 v125, 0
    v_mov_b32 v126, 0
    v_mov_b32 v127, 0
    v_mov_b32 v128, 0
    v_mov_b32 v129, 0
    v_mov_b32 v130, 0
    v_mov_b32 v131, 0
    v_mov_b32 v132, 0
    v_mov_b32 v133, 0
    v_mov_b32 v134, 0
    v_mov_b32 v135, 0
    v_mov_b32 v136, 0
    v_mov_b32 v137, 0
    v_mov_b32 v138, 0
    v_mov_b32 v139, 0
    v_mov_b32 v140, 0
    v_mov_b32 v141, 0
    v_mov_b32 v142, 0
    v_mov_b32 v143, 0
    v_mov_b32 v144, 0
    v_mov_b32 v145, 0
    v_mov_b32 v146, 0
    v_mov_b32 v147, 0
    v_mov_b32 v148, 0
    v_mov_b32 v149, 0
    v_mov_b32 v150, 0
    v_mov_b32 v151, 0
    v_mov_b32 v152, 0
    v_mov_b32 v153, 0
    v_mov_b32 v154, 0
    v_mov_b32 v155, 0
    v_mov_b32 v156, 0
    v_mov_b32 v157, 0
    v_mov_b32 v158, 0
    v_mov_b32 v159, 0
    v_mov_b32 v160, 0
    v_mov_b32 v161, 0
    v_mov_b32 v162, 0
    v_mov_b32 v163, 0
    v_mov_b32 v164, 0
    v_mov_b32 v165, 0
    v_mov_b32 v166, 0
    v_mov_b32 v167, 0
    v_mov_b32 v168, 0
    v_mov_b32 v169, 0
    v_mov_b32 v170, 0
    v_mov_b32 v171, 0
    v_mov_b32 v172, 0
    v_mov_b32 v173, 0
    v_mov_b32 v174, 0
    v_mov_b32 v175, 0
    v_mov_b32 v176, 0
    v_mov_b32 v177, 0
    v_mov_b32 v178, 0
    v_mov_b32 v179, 0
    v_mov_b32 v180, 0
    v_mov_b32 v181, 0
    v_mov_b32 v182, 0
    v_mov_b32 v183, 0
    v_mov_b32 v184, 0
    v_mov_b32 v185, 0
    v_mov_b32 v186, 0
    v_mov_b32 v187, 0
    v_mov_b32 v188, 0
    v_mov_b32 v189, 0
    v_mov_b32 v190, 0
    v_mov_b32 v191, 0
    v_mov_b32 v192, 0
    v_mov_b32 v193, 0
    v_mov_b32 v194, 0
    v_mov_b32 v195, 0
    v_mov_b32 v196, 0
    v_mov_b32 v197, 0
    v_mov_b32 v198, 0
    v_mov_b32 v199, 0
    v_mov_b32 v200, 0
    v_mov_b32 v201, 0
    v_mov_b32 v202, 0
    v_mov_b32 v203, 0
    v_mov_b32 v204, 0
    v_mov_b32 v205, 0
    v_mov_b32 v206, 0
    v_mov_b32 v207, 0
    v_mov_b32 v208, 0
    v_mov_b32 v209, 0
    v_mov_b32 v210, 0
    v_mov_b32 v211, 0
    v_mov_b32 v212, 0
    v_mov_b32 v213, 0
    v_mov_b32 v214, 0
    v_mov_b32 v215, 0
    v_mov_b32 v216, 0
    v_mov_b32 v217, 0
    v_mov_b32 v218, 0
    v_mov_b32 v219, 0
    v_mov_b32 v220, 0
    v_mov_b32 v221, 0
    v_mov_b32 v222, 0
    v_mov_b32 v223, 0
    v_mov_b32 v224, 0
    v_mov_b32 v225, 0
    v_mov_b32 v226, 0
    v_mov_b32 v227, 0
    v_mov_b32 v228, 0
    v_mov_b32 v229, 0
    v_mov_b32 v230, 0
    v_mov_b32 v231, 0
    v_mov_b32 v232, 0
    v_mov_b32 v233, 0
    v_mov_b32 v234, 0
    v_mov_b32 v235, 0
    v_mov_b32 v236, 0
    v_mov_b32 v237, 0
    v_mov_b32 v238, 0
    v_mov_b32 v239, 0
    v_mov_b32 v240, 0
    v_mov_b32 v241, 0
    v_mov_b32 v242, 0
    v_mov_b32 v243, 0
    v_mov_b32 v244, 0
    v_mov_b32 v245, 0
    v_mov_b32 v246, 0
    v_mov_b32 v247, 0
    v_mov_b32 v248, 0
    v_mov_b32 v249, 0
    v_mov_b32 v250, 0
    v_mov_b32 v251, 0
    v_mov_b32 v252, 0
    v_mov_b32 v253, 0
    v_mov_b32 v254, 0
    v_mov_b32 v255, 0
    v_lshlrev_b32 v6, 2, v0
    v_add_u32 v6, 163072, v6
    v_mov_b32 v7, 0
    ds_write_b32 v6, v7
    s_cmp_ge_u32 s53, 2
    s_cbranch_scc1 L_ns_50
    v_mov_b32 v82, 0
    v_mov_b32 v83, 0
    v_mov_b32 v81, 0x3f803f80
    v_lshlrev_b32 v80, 3, v80
    v_add_u32 v80, 18874368, v80
    s_waitcnt vmcnt(4)
    v_dot2c_f32_bf16 v82, v60, v81
    v_dot2c_f32_bf16 v83, v60, v60
    v_dot2c_f32_bf16 v82, v61, v81
    v_dot2c_f32_bf16 v83, v61, v61
    v_dot2c_f32_bf16 v82, v62, v81
    v_dot2c_f32_bf16 v83, v62, v62
    v_dot2c_f32_bf16 v82, v63, v81
    v_dot2c_f32_bf16 v83, v63, v63
    s_waitcnt vmcnt(3)
    v_dot2c_f32_bf16 v82, v64, v81
    v_dot2c_f32_bf16 v83, v64, v64
    v_dot2c_f32_bf16 v82, v65, v81
    v_dot2c_f32_bf16 v83, v65, v65
    v_dot2c_f32_bf16 v82, v66, v81
    v_dot2c_f32_bf16 v83, v66, v66
    v_dot2c_f32_bf16 v82, v67, v81
    v_dot2c_f32_bf16 v83, v67, v67
    s_waitcnt vmcnt(2)
    v_dot2c_f32_bf16 v82, v68, v81
    v_dot2c_f32_bf16 v83, v68, v68
    v_dot2c_f32_bf16 v82, v69, v81
    v_dot2c_f32_bf16 v83, v69, v69
    v_dot2c_f32_bf16 v82, v70, v81
    v_dot2c_f32_bf16 v83, v70, v70
    v_dot2c_f32_bf16 v82, v71, v81
    v_dot2c_f32_bf16 v83, v71, v71
    s_waitcnt vmcnt(1)
    v_dot2c_f32_bf16 v82, v72, v81
    v_dot2c_f32_bf16 v83, v72, v72
    v_dot2c_f32_bf16 v82, v73, v81
    v_dot2c_f32_bf16 v83, v73, v73
    v_dot2c_f32_bf16 v82, v74, v81
    v_dot2c_f32_bf16 v83, v74, v74
    v_dot2c_f32_bf16 v82, v75, v81
    v_dot2c_f32_bf16 v83, v75, v75
    s_waitcnt vmcnt(0)
    v_dot2c_f32_bf16 v82, v76, v81
    v_dot2c_f32_bf16 v83, v76, v76
    v_dot2c_f32_bf16 v82, v77, v81
    v_dot2c_f32_bf16 v83, v77, v77
    v_dot2c_f32_bf16 v82, v78, v81
    v_dot2c_f32_bf16 v83, v78, v78
    v_dot2c_f32_bf16 v82, v79, v81
    v_dot2c_f32_bf16 v83, v79, v79
    s_nop 1
    v_add_f32_dpp v82, v82, v82 row_ror:8 row_mask:0xf bank_mask:0xf
    v_add_f32_dpp v83, v83, v83 row_ror:8 row_mask:0xf bank_mask:0xf
    s_nop 0
    v_add_f32_dpp v82, v82, v82 row_ror:4 row_mask:0xf bank_mask:0xf
    v_add_f32_dpp v83, v83, v83 row_ror:4 row_mask:0xf bank_mask:0xf
    s_nop 0
    v_add_f32_dpp v82, v82, v82 row_ror:2 row_mask:0xf bank_mask:0xf
    v_add_f32_dpp v83, v83, v83 row_ror:2 row_mask:0xf bank_mask:0xf
    s_nop 0
    v_add_f32_dpp v82, v82, v82 row_ror:1 row_mask:0xf bank_mask:0xf
    v_add_f32_dpp v83, v83, v83 row_ror:1 row_mask:0xf bank_mask:0xf
    s_mov_b32 s61, 0x3acccccd
    s_mov_b32 s62, 0x3727c5ac
    v_mul_f32 v82, s61, v82
    v_mul_f32 v60, v82, v82
    v_fma_f32 v83, v83, s61, -v60
    v_max_f32 v83, 0, v83
    v_add_f32 v83, s62, v83
    v_rsq_f32 v83, v83
    s_mov_b32 exec_lo, 0x10001
    s_mov_b32 exec_hi, 0x10001
    buffer_store_dwordx2 v[82:83], v80, s[36:39], 0 offen sc0 sc1
    s_mov_b64 exec, -1
L_ns_50:
    s_mov_b32 s64, 49152
    s_mov_b32 s65, -98304
    s_mov_b32 s80, 0
    s_waitcnt lgkmcnt(0)
    s_barrier
    s_cmp_eq_u32 s53, 1
    s_cbranch_scc1 L_qw_55
    s_cmp_eq_u32 s53, 2
    s_cbranch_scc1 L_qw_56
    s_cmp_eq_u32 s53, 3
    s_cbranch_scc1 L_qw_57
L_qw_54:
    s_add_u32 s80, s80, 1
    s_cmp_eq_u32 s80, 3
    s_cselect_b32 s80, 0, s80
    s_cselect_b32 s60, s65, s64
    ds_read_b128 v[36:39], v2 offset:0
    ds_read_b64_tr_b16 v[60:61], v1 offset:15360
    ds_read_b64_tr_b16 v[62:63], v1 offset:19200
    ds_read_b128 v[40:43], v2 offset:2048
    v_add_u32 v2, s60, v2
    ds_read_b64_tr_b16 v[64:65], v1 offset:15392
    ds_read_b64_tr_b16 v[66:67], v1 offset:19232
    ds_read_b64_tr_b16 v[68:69], v1 offset:15424
    ds_read_b64_tr_b16 v[70:71], v1 offset:19264
    ds_read_b64_tr_b16 v[72:73], v1 offset:15456
    ds_read_b64_tr_b16 v[74:75], v1 offset:19296
    ds_read_b64_tr_b16 v[76:77], v1 offset:15488
    ds_read_b64_tr_b16 v[78:79], v1 offset:19328
    ds_read_b64_tr_b16 v[80:81], v1 offset:15520
    ds_read_b64_tr_b16 v[82:83], v1 offset:19360
    ds_read_b128 v[44:47], v4 offset:0
    v_add_u32 v4, s60, v4
    ds_read_b64_tr_b16 v[84:85], v1 offset:15552
    ds_read_b64_tr_b16 v[86:87], v1 offset:19392
    ds_read_b64_tr_b16 v[88:89], v1 offset:15584
    ds_read_b64_tr_b16 v[90:91], v1 offset:19424
    ds_read_b64_tr_b16 v[92:93], v1 offset:15616
    ds_read_b64_tr_b16 v[94:95], v1 offset:19456
    ds_read_b64_tr_b16 v[96:97], v1 offset:15648
    ds_read_b64_tr_b16 v[98:99], v1 offset:19488
    ds_read_b64_tr_b16 v[100:101], v1 offset:15680
    ds_read_b64_tr_b16 v[102:103], v1 offset:19520
    ds_read_b64_tr_b16 v[104:105], v1 offset:15712
    ds_read_b64_tr_b16 v[106:107], v1 offset:19552
    ds_read_b64_tr_b16 v[108:109], v1 offset:15744
    ds_read_b64_tr_b16 v[110:111], v1 offset:19584
    ds_read_b64_tr_b16 v[112:113], v1 offset:15776
    ds_read_b64_tr_b16 v[114:115], v1 offset:19616
    ds_read_b64_tr_b16 v[116:117], v1 offset:15808
    s_waitcnt lgkmcnt(0)
    s_mov_b32 s59, 9
    s_branch L_ml_59
.p2align 5
    s_nop 0
    s_nop 0
    s_nop 0
L_ml_59:
    v_mfma_f32_16x16x32_bf16 v[120:123], v[60:63], v[36:39], v[120:123]
    ds_read_b64_tr_b16 v[118:119], v1 offset:19648
    v_mfma_f32_16x16x32_bf16 v[140:143], v[60:63], v[40:43], v[140:143]
    ds_read_b128 v[48:51], v3 offset:0
    ds_read_b64_tr_b16 v[60:61], v1 offset:0
    v_mfma_f32_16x16x32_bf16 v[124:127], v[64:67], v[36:39], v[124:127]
    ds_read_b64_tr_b16 v[62:63], v1 offset:3840
    v_mfma_f32_16x16x32_bf16 v[144:147], v[64:67], v[40:43], v[144:147]
    ds_read_b128 v[52:55], v3 offset:2048
    v_mfma_f32_16x16x32_bf16 v[128:131], v[68:71], v[36:39], v[128:131]
    v_add_u32 v3, s60, v3
    v_mfma_f32_16x16x32_bf16 v[148:151], v[68:71], v[40:43], v[148:151]
    ds_read_b64_tr_b16 v[64:65], v1 offset:32
    ds_read_b64_tr_b16 v[66:67], v1 offset:3872
    v_mfma_f32_16x16x32_bf16 v[132:135], v[72:75], v[36:39], v[132:135]
    ds_read_b64_tr_b16 v[68:69], v1 offset:64
    v_mfma_f32_16x16x32_bf16 v[152:155], v[72:75], v[40:43], v[152:155]
    ds_read_b64_tr_b16 v[70:71], v1 offset:3904
    v_mfma_f32_16x16x32_bf16 v[136:139], v[76:79], v[36:39], v[136:139]
    ds_read_b64_tr_b16 v[72:73], v1 offset:96
    v_mfma_f32_16x16x32_bf16 v[156:159], v[76:79], v[40:43], v[156:159]
    ds_read_b64_tr_b16 v[74:75], v1 offset:3936
    s_waitcnt lgkmcnt(10)
    v_mfma_f32_16x16x32_bf16 v[160:163], v[80:83], v[36:39], v[160:163]
    ds_read_b64_tr_b16 v[76:77], v1 offset:128
    v_mfma_f32_16x16x32_bf16 v[180:183], v[80:83], v[40:43], v[180:183]
    ds_read_b64_tr_b16 v[78:79], v1 offset:3968
    v_mfma_f32_16x16x32_bf16 v[240:243], v[80:83], v[44:47], v[240:243]
    ds_read_b64_tr_b16 v[80:81], v1 offset:160
    v_mfma_f32_16x16x32_bf16 v[164:167], v[84:87], v[36:39], v[164:167]
    ds_read_b64_tr_b16 v[82:83], v1 offset:4000
    v_mfma_f32_16x16x32_bf16 v[184:187], v[84:87], v[40:43], v[184:187]
    ds_read_b128 v[56:59], v5 offset:0
    v_mfma_f32_16x16x32_bf16 v[168:171], v[88:91], v[36:39], v[168:171]
    v_add_u32 v5, s60, v5
    v_mfma_f32_16x16x32_bf16 v[188:191], v[88:91], v[40:43], v[188:191]
    ds_read_b64_tr_b16 v[84:85], v1 offset:192
    ds_read_b64_tr_b16 v[86:87], v1 offset:4032
    v_mfma_f32_16x16x32_bf16 v[172:175], v[92:95], v[36:39], v[172:175]
    ds_read_b64_tr_b16 v[88:89], v1 offset:224
    v_mfma_f32_16x16x32_bf16 v[192:195], v[92:95], v[40:43], v[192:195]
    ds_read_b64_tr_b16 v[90:91], v1 offset:4064
    v_mfma_f32_16x16x32_bf16 v[176:179], v[96:99], v[36:39], v[176:179]
    ds_read_b64_tr_b16 v[92:93], v1 offset:256
    v_mfma_f32_16x16x32_bf16 v[196:199], v[96:99], v[40:43], v[196:199]
    ds_read_b64_tr_b16 v[94:95], v1 offset:4096
    v_mfma_f32_16x16x32_bf16 v[244:247], v[96:99], v[44:47], v[244:247]
    ds_read_b64_tr_b16 v[96:97], v1 offset:288
    v_mfma_f32_16x16x32_bf16 v[200:203], v[36:39], v[100:103], v[200:203]
    ds_read_b64_tr_b16 v[98:99], v1 offset:4128
    v_mfma_f32_16x16x32_bf16 v[204:207], v[40:43], v[100:103], v[204:207]
    ds_read_b64_tr_b16 v[100:101], v1 offset:320
    v_mfma_f32_16x16x32_bf16 v[208:211], v[36:39], v[104:107], v[208:211]
    ds_read_b64_tr_b16 v[102:103], v1 offset:4160
    v_mfma_f32_16x16x32_bf16 v[212:215], v[40:43], v[104:107], v[212:215]
    ds_read_b64_tr_b16 v[104:105], v1 offset:352
    v_mfma_f32_16x16x32_bf16 v[216:219], v[36:39], v[108:111], v[216:219]
    ds_read_b64_tr_b16 v[106:107], v1 offset:4192
    v_mfma_f32_16x16x32_bf16 v[220:223], v[40:43], v[108:111], v[220:223]
    ds_read_b64_tr_b16 v[108:109], v1 offset:384
    v_mfma_f32_16x16x32_bf16 v[224:227], v[36:39], v[112:115], v[224:227]
    ds_read_b64_tr_b16 v[110:111], v1 offset:4224
    v_mfma_f32_16x16x32_bf16 v[228:231], v[40:43], v[112:115], v[228:231]
    v_mfma_f32_16x16x32_bf16 v[248:251], v[44:47], v[112:115], v[248:251]
    s_sub_u32 s59, s59, 1
    v_mfma_f32_16x16x32_bf16 v[232:235], v[36:39], v[116:119], v[232:235]
    ds_read_b64_tr_b16 v[112:113], v1 offset:416
    v_mfma_f32_16x16x32_bf16 v[236:239], v[40:43], v[116:119], v[236:239]
    s_waitcnt vmcnt(0) lgkmcnt(7)
    s_barrier
    s_cbranch_scc1 L_tl_60
    v_mfma_f32_16x16x32_bf16 v[120:123], v[60:63], v[48:51], v[120:123]
    ds_read_b64_tr_b16 v[114:115], v1 offset:4256
    ds_read_b64_tr_b16 v[116:117], v1 offset:448
    v_mfma_f32_16x16x32_bf16 v[140:143], v[60:63], v[52:55], v[140:143]
    ds_read_b64_tr_b16 v[118:119], v1 offset:4288
    v_add_u32 v1, s60, v1
    v_mfma_f32_16x16x32_bf16 v[124:127], v[64:67], v[48:51], v[124:127]
    s_add_u32 s80, s80, 1
    ds_read_b128 v[36:39], v2 offset:0
    v_mfma_f32_16x16x32_bf16 v[144:147], v[64:67], v[52:55], v[144:147]
    s_cmp_eq_u32 s80, 3
    ds_read_b64_tr_b16 v[60:61], v1 offset:15360
    v_mfma_f32_16x16x32_bf16 v[128:131], v[68:71], v[48:51], v[128:131]
    s_cselect_b32 s80, 0, s80
    ds_read_b64_tr_b16 v[62:63], v1 offset:19200
    v_mfma_f32_16x16x32_bf16 v[148:151], v[68:71], v[52:55], v[148:151]
    s_cselect_b32 s60, s65, s64
    ds_read_b128 v[40:43], v2 offset:2048
    v_mfma_f32_16x16x32_bf16 v[132:135], v[72:75], v[48:51], v[132:135]
    v_add_u32 v2, s60, v2
    ds_read_b64_tr_b16 v[64:65], v1 offset:15392
    v_mfma_f32_16x16x32_bf16 v[152:155], v[72:75], v[52:55], v[152:155]
    ds_read_b64_tr_b16 v[66:67], v1 offset:19232
    ds_read_b64_tr_b16 v[68:69], v1 offset:15424
    v_mfma_f32_16x16x32_bf16 v[136:139], v[76:79], v[48:51], v[136:139]
    ds_read_b64_tr_b16 v[70:71], v1 offset:19264
    v_mfma_f32_16x16x32_bf16 v[156:159], v[76:79], v[52:55], v[156:159]
    ds_read_b64_tr_b16 v[72:73], v1 offset:15456
    ds_read_b64_tr_b16 v[74:75], v1 offset:19296
    v_mfma_f32_16x16x32_bf16 v[160:163], v[80:83], v[48:51], v[160:163]
    ds_read_b64_tr_b16 v[76:77], v1 offset:15488
    v_mfma_f32_16x16x32_bf16 v[180:183], v[80:83], v[52:55], v[180:183]
    ds_read_b64_tr_b16 v[78:79], v1 offset:19328
    v_mfma_f32_16x16x32_bf16 v[240:243], v[80:83], v[56:59], v[240:243]
    ds_read_b64_tr_b16 v[80:81], v1 offset:15520
    v_mfma_f32_16x16x32_bf16 v[164:167], v[84:87], v[48:51], v[164:167]
    ds_read_b64_tr_b16 v[82:83], v1 offset:19360
    v_mfma_f32_16x16x32_bf16 v[184:187], v[84:87], v[52:55], v[184:187]
    ds_read_b128 v[44:47], v4 offset:0
    v_mfma_f32_16x16x32_bf16 v[168:171], v[88:91], v[48:51], v[168:171]
    v_add_u32 v4, s60, v4
    v_mfma_f32_16x16x32_bf16 v[188:191], v[88:91], v[52:55], v[188:191]
    ds_read_b64_tr_b16 v[84:85], v1 offset:15552
    ds_read_b64_tr_b16 v[86:87], v1 offset:19392
    v_mfma_f32_16x16x32_bf16 v[172:175], v[92:95], v[48:51], v[172:175]
    ds_read_b64_tr_b16 v[88:89], v1 offset:15584
    v_mfma_f32_16x16x32_bf16 v[192:195], v[92:95], v[52:55], v[192:195]
    ds_read_b64_tr_b16 v[90:91], v1 offset:19424
    v_mfma_f32_16x16x32_bf16 v[176:179], v[96:99], v[48:51], v[176:179]
    ds_read_b64_tr_b16 v[92:93], v1 offset:15616
    v_mfma_f32_16x16x32_bf16 v[196:199], v[96:99], v[52:55], v[196:199]
    ds_read_b64_tr_b16 v[94:95], v1 offset:19456
    v_mfma_f32_16x16x32_bf16 v[244:247], v[96:99], v[56:59], v[244:247]
    ds_read_b64_tr_b16 v[96:97], v1 offset:15648
    s_waitcnt lgkmcnt(9)
    v_mfma_f32_16x16x32_bf16 v[200:203], v[48:51], v[100:103], v[200:203]
    ds_read_b64_tr_b16 v[98:99], v1 offset:19488
    v_mfma_f32_16x16x32_bf16 v[204:207], v[52:55], v[100:103], v[204:207]
    ds_read_b64_tr_b16 v[100:101], v1 offset:15680
    v_mfma_f32_16x16x32_bf16 v[208:211], v[48:51], v[104:107], v[208:211]
    ds_read_b64_tr_b16 v[102:103], v1 offset:19520
    v_mfma_f32_16x16x32_bf16 v[212:215], v[52:55], v[104:107], v[212:215]
    ds_read_b64_tr_b16 v[104:105], v1 offset:15712
    v_mfma_f32_16x16x32_bf16 v[216:219], v[48:51], v[108:111], v[216:219]
    ds_read_b64_tr_b16 v[106:107], v1 offset:19552
    v_mfma_f32_16x16x32_bf16 v[220:223], v[52:55], v[108:111], v[220:223]
    ds_read_b64_tr_b16 v[108:109], v1 offset:15744
    v_mfma_f32_16x16x32_bf16 v[224:227], v[48:51], v[112:115], v[224:227]
    ds_read_b64_tr_b16 v[110:111], v1 offset:19584
    v_mfma_f32_16x16x32_bf16 v[228:231], v[52:55], v[112:115], v[228:231]
    v_mfma_f32_16x16x32_bf16 v[248:251], v[56:59], v[112:115], v[248:251]
    ds_read_b64_tr_b16 v[112:113], v1 offset:15776
    v_mfma_f32_16x16x32_bf16 v[232:235], v[48:51], v[116:119], v[232:235]
    ds_read_b64_tr_b16 v[114:115], v1 offset:19616
    v_mfma_f32_16x16x32_bf16 v[236:239], v[52:55], v[116:119], v[236:239]
    ds_read_b64_tr_b16 v[116:117], v1 offset:15808
    s_branch L_ml_59
L_tl_60:
    v_mfma_f32_16x16x32_bf16 v[120:123], v[60:63], v[48:51], v[120:123]
    ds_read_b64_tr_b16 v[114:115], v1 offset:4256
    ds_read_b64_tr_b16 v[116:117], v1 offset:448
    v_mfma_f32_16x16x32_bf16 v[140:143], v[60:63], v[52:55], v[140:143]
    ds_read_b64_tr_b16 v[118:119], v1 offset:4288
    ds_read2_b32 v[36:37], v29 offset0:0 offset1:144
    v_mfma_f32_16x16x32_bf16 v[124:127], v[64:67], v[48:51], v[124:127]
    ds_read2_b32 v[38:39], v29 offset0:16 offset1:160
    ds_read2_b32 v[40:41], v30 offset0:0 offset1:144
    v_mfma_f32_16x16x32_bf16 v[144:147], v[64:67], v[52:55], v[144:147]
    ds_read_b32 v42, v34 offset:640
    ds_read_b32 v43, v34 offset:704
    v_mfma_f32_16x16x32_bf16 v[128:131], v[68:71], v[48:51], v[128:131]
    ds_read_b32 v44, v34 offset:768
    ds_read_b32 v45, v34 offset:832
    v_mfma_f32_16x16x32_bf16 v[148:151], v[68:71], v[52:55], v[148:151]
    ds_read_b32 v46, v34 offset:896
    ds_read_b128 v[60:63], v33 offset:320
    v_mfma_f32_16x16x32_bf16 v[132:135], v[72:75], v[48:51], v[132:135]
    ds_read_b128 v[64:67], v33 offset:384
    ds_read_b128 v[68:71], v33 offset:448
    v_mfma_f32_16x16x32_bf16 v[152:155], v[72:75], v[52:55], v[152:155]
    ds_read_b128 v[72:75], v33 offset:512
    v_mfma_f32_16x16x32_bf16 v[136:139], v[76:79], v[48:51], v[136:139]
    v_mfma_f32_16x16x32_bf16 v[156:159], v[76:79], v[52:55], v[156:159]
    ds_read_b128 v[76:79], v33 offset:576
    v_mfma_f32_16x16x32_bf16 v[160:163], v[80:83], v[48:51], v[160:163]
    v_mfma_f32_16x16x32_bf16 v[180:183], v[80:83], v[52:55], v[180:183]
    v_mfma_f32_16x16x32_bf16 v[240:243], v[80:83], v[56:59], v[240:243]
    ds_read_b128 v[80:83], v33 offset:0
    v_mfma_f32_16x16x32_bf16 v[164:167], v[84:87], v[48:51], v[164:167]
    v_mfma_f32_16x16x32_bf16 v[184:187], v[84:87], v[52:55], v[184:187]
    ds_read_b128 v[84:87], v33 offset:64
    v_mfma_f32_16x16x32_bf16 v[168:171], v[88:91], v[48:51], v[168:171]
    v_mfma_f32_16x16x32_bf16 v[188:191], v[88:91], v[52:55], v[188:191]
    ds_read_b128 v[88:91], v33 offset:128
    v_mfma_f32_16x16x32_bf16 v[172:175], v[92:95], v[48:51], v[172:175]
    v_mfma_f32_16x16x32_bf16 v[192:195], v[92:95], v[52:55], v[192:195]
    ds_read_b128 v[92:95], v33 offset:192
    v_mfma_f32_16x16x32_bf16 v[176:179], v[96:99], v[48:51], v[176:179]
    v_mfma_f32_16x16x32_bf16 v[196:199], v[96:99], v[52:55], v[196:199]
    v_mfma_f32_16x16x32_bf16 v[244:247], v[96:99], v[56:59], v[244:247]
    ds_read_b128 v[96:99], v33 offset:256
    s_waitcnt lgkmcnt(14)
    v_mfma_f32_16x16x32_bf16 v[200:203], v[48:51], v[100:103], v[200:203]
    v_mfma_f32_16x16x32_bf16 v[204:207], v[52:55], v[100:103], v[204:207]
    ds_read_b128 v[100:103], v31 offset:0
    v_mfma_f32_16x16x32_bf16 v[208:211], v[48:51], v[104:107], v[208:211]
    v_mfma_f32_16x16x32_bf16 v[212:215], v[52:55], v[104:107], v[212:215]
    ds_read_b128 v[104:107], v31 offset:64
    v_mfma_f32_16x16x32_bf16 v[216:219], v[48:51], v[108:111], v[216:219]
    v_mfma_f32_16x16x32_bf16 v[220:223], v[52:55], v[108:111], v[220:223]
    ds_read_b128 v[108:111], v31 offset:576
    v_mfma_f32_16x16x32_bf16 v[224:227], v[48:51], v[112:115], v[224:227]
    v_mfma_f32_16x16x32_bf16 v[228:231], v[52:55], v[112:115], v[228:231]
    v_mfma_f32_16x16x32_bf16 v[248:251], v[56:59], v[112:115], v[248:251]
    ds_read_b128 v[112:115], v31 offset:640
    v_mfma_f32_16x16x32_bf16 v[232:235], v[48:51], v[116:119], v[232:235]
    v_mfma_f32_16x16x32_bf16 v[236:239], v[52:55], v[116:119], v[236:239]
    ds_read_b128 v[48:51], v32 offset:0
    ds_read_b128 v[52:55], v32 offset:576
    s_branch L_e1_58
L_qw_55:
    s_add_u32 s80, s80, 1
    s_cmp_eq_u32 s80, 3
    s_cselect_b32 s80, 0, s80
    s_cselect_b32 s60, s65, s64
    ds_read_b128 v[36:39], v2 offset:0
    ds_read_b64_tr_b16 v[60:61], v1 offset:15360
    ds_read_b64_tr_b16 v[62:63], v1 offset:19200
    ds_read_b128 v[40:43], v2 offset:2048
    v_add_u32 v2, s60, v2
    ds_read_b64_tr_b16 v[64:65], v1 offset:15392
    ds_read_b64_tr_b16 v[66:67], v1 offset:19232
    ds_read_b64_tr_b16 v[68:69], v1 offset:15424
    ds_read_b64_tr_b16 v[70:71], v1 offset:19264
    ds_read_b64_tr_b16 v[72:73], v1 offset:15456
    ds_read_b64_tr_b16 v[74:75], v1 offset:19296
    ds_read_b64_tr_b16 v[76:77], v1 offset:15488
    ds_read_b64_tr_b16 v[78:79], v1 offset:19328
    ds_read_b64_tr_b16 v[80:81], v1 offset:15520
    ds_read_b64_tr_b16 v[82:83], v1 offset:19360
    ds_read_b64_tr_b16 v[84:85], v1 offset:15552
    ds_read_b64_tr_b16 v[86:87], v1 offset:19392
    ds_read_b128 v[44:47], v4 offset:0
    v_add_u32 v4, s60, v4
    ds_read_b64_tr_b16 v[88:89], v1 offset:15584
    ds_read_b64_tr_b16 v[90:91], v1 offset:19424
    ds_read_b64_tr_b16 v[92:93], v1 offset:15616
    ds_read_b64_tr_b16 v[94:95], v1 offset:19456
    ds_read_b64_tr_b16 v[96:97], v1 offset:15648
    ds_read_b64_tr_b16 v[98:99], v1 offset:19488
    ds_read_b64_tr_b16 v[100:101], v1 offset:15680
    ds_read_b64_tr_b16 v[102:103], v1 offset:19520
    ds_read_b64_tr_b16 v[104:105], v1 offset:15712
    ds_read_b64_tr_b16 v[106:107], v1 offset:19552
    ds_read_b64_tr_b16 v[108:109], v1 offset:15744
    ds_read_b64_tr_b16 v[110:111], v1 offset:19584
    ds_read_b64_tr_b16 v[112:113], v1 offset:15776
    ds_read_b64_tr_b16 v[114:115], v1 offset:19616
    ds_read_b64_tr_b16 v[116:117], v1 offset:15808
    s_waitcnt lgkmcnt(0)
    s_mov_b32 s59, 9
    s_branch L_ml_61
.p2align 5
    s_nop 0
    s_nop 0
    s_nop 0
L_ml_61:
    v_mfma_f32_16x16x32_bf16 v[120:123], v[60:63], v[36:39], v[120:123]
    ds_read_b64_tr_b16 v[118:119], v1 offset:19648
    v_mfma_f32_16x16x32_bf16 v[140:143], v[60:63], v[40:43], v[140:143]
    ds_read_b128 v[48:51], v3 offset:0
    ds_read_b64_tr_b16 v[60:61], v1 offset:0
    v_mfma_f32_16x16x32_bf16 v[124:127], v[64:67], v[36:39], v[124:127]
    ds_read_b64_tr_b16 v[62:63], v1 offset:3840
    v_mfma_f32_16x16x32_bf16 v[144:147], v[64:67], v[40:43], v[144:147]
    ds_read_b128 v[52:55], v3 offset:2048
    v_mfma_f32_16x16x32_bf16 v[128:131], v[68:71], v[36:39], v[128:131]
    v_add_u32 v3, s60, v3
    v_mfma_f32_16x16x32_bf16 v[148:151], v[68:71], v[40:43], v[148:151]
    ds_read_b64_tr_b16 v[64:65], v1 offset:32
    ds_read_b64_tr_b16 v[66:67], v1 offset:3872
    v_mfma_f32_16x16x32_bf16 v[132:135], v[72:75], v[36:39], v[132:135]
    ds_read_b64_tr_b16 v[68:69], v1 offset:64
    v_mfma_f32_16x16x32_bf16 v[152:155], v[72:75], v[40:43], v[152:155]
    ds_read_b64_tr_b16 v[70:71], v1 offset:3904
    v_mfma_f32_16x16x32_bf16 v[136:139], v[76:79], v[36:39], v[136:139]
    ds_read_b64_tr_b16 v[72:73], v1 offset:96
    v_mfma_f32_16x16x32_bf16 v[156:159], v[76:79], v[40:43], v[156:159]
    ds_read_b64_tr_b16 v[74:75], v1 offset:3936
    s_waitcnt lgkmcnt(10)
    v_mfma_f32_16x16x32_bf16 v[160:163], v[80:83], v[36:39], v[160:163]
    ds_read_b64_tr_b16 v[76:77], v1 offset:128
    v_mfma_f32_16x16x32_bf16 v[180:183], v[80:83], v[40:43], v[180:183]
    ds_read_b64_tr_b16 v[78:79], v1 offset:3968
    v_mfma_f32_16x16x32_bf16 v[164:167], v[84:87], v[36:39], v[164:167]
    ds_read_b64_tr_b16 v[80:81], v1 offset:160
    v_mfma_f32_16x16x32_bf16 v[184:187], v[84:87], v[40:43], v[184:187]
    ds_read_b64_tr_b16 v[82:83], v1 offset:4000
    v_mfma_f32_16x16x32_bf16 v[240:243], v[84:87], v[44:47], v[240:243]
    ds_read_b64_tr_b16 v[84:85], v1 offset:192
    v_mfma_f32_16x16x32_bf16 v[168:171], v[88:91], v[36:39], v[168:171]
    ds_read_b64_tr_b16 v[86:87], v1 offset:4032
    v_mfma_f32_16x16x32_bf16 v[188:191], v[88:91], v[40:43], v[188:191]
    ds_read_b128 v[56:59], v5 offset:0
    v_mfma_f32_16x16x32_bf16 v[172:175], v[92:95], v[36:39], v[172:175]
    v_add_u32 v5, s60, v5
    v_mfma_f32_16x16x32_bf16 v[192:195], v[92:95], v[40:43], v[192:195]
    ds_read_b64_tr_b16 v[88:89], v1 offset:224
    ds_read_b64_tr_b16 v[90:91], v1 offset:4064
    v_mfma_f32_16x16x32_bf16 v[176:179], v[96:99], v[36:39], v[176:179]
    ds_read_b64_tr_b16 v[92:93], v1 offset:256
    v_mfma_f32_16x16x32_bf16 v[196:199], v[96:99], v[40:43], v[196:199]
    ds_read_b64_tr_b16 v[94:95], v1 offset:4096
    v_mfma_f32_16x16x32_bf16 v[200:203], v[36:39], v[100:103], v[200:203]
    ds_read_b64_tr_b16 v[96:97], v1 offset:288
    v_mfma_f32_16x16x32_bf16 v[204:207], v[40:43], v[100:103], v[204:207]
    ds_read_b64_tr_b16 v[98:99], v1 offset:4128
    v_mfma_f32_16x16x32_bf16 v[244:247], v[44:47], v[100:103], v[244:247]
    ds_read_b64_tr_b16 v[100:101], v1 offset:320
    v_mfma_f32_16x16x32_bf16 v[208:211], v[36:39], v[104:107], v[208:211]
    ds_read_b64_tr_b16 v[102:103], v1 offset:4160
    v_mfma_f32_16x16x32_bf16 v[212:215], v[40:43], v[104:107], v[212:215]
    ds_read_b64_tr_b16 v[104:105], v1 offset:352
    v_mfma_f32_16x16x32_bf16 v[216:219], v[36:39], v[108:111], v[216:219]
    ds_read_b64_tr_b16 v[106:107], v1 offset:4192
    v_mfma_f32_16x16x32_bf16 v[220:223], v[40:43], v[108:111], v[220:223]
    ds_read_b64_tr_b16 v[108:109], v1 offset:384
    v_mfma_f32_16x16x32_bf16 v[224:227], v[36:39], v[112:115], v[224:227]
    ds_read_b64_tr_b16 v[110:111], v1 offset:4224
    v_mfma_f32_16x16x32_bf16 v[228:231], v[40:43], v[112:115], v[228:231]
    ds_read_b64_tr_b16 v[112:113], v1 offset:416
    v_mfma_f32_16x16x32_bf16 v[232:235], v[36:39], v[116:119], v[232:235]
    s_sub_u32 s59, s59, 1
    v_mfma_f32_16x16x32_bf16 v[236:239], v[40:43], v[116:119], v[236:239]
    ds_read_b64_tr_b16 v[114:115], v1 offset:4256
    v_mfma_f32_16x16x32_bf16 v[248:251], v[44:47], v[116:119], v[248:251]
    s_waitcnt vmcnt(0) lgkmcnt(8)
    s_barrier
    s_cbranch_scc1 L_tl_62
    v_mfma_f32_16x16x32_bf16 v[120:123], v[60:63], v[48:51], v[120:123]
    ds_read_b64_tr_b16 v[116:117], v1 offset:448
    v_mfma_f32_16x16x32_bf16 v[140:143], v[60:63], v[52:55], v[140:143]
    ds_read_b64_tr_b16 v[118:119], v1 offset:4288
    v_add_u32 v1, s60, v1
    v_mfma_f32_16x16x32_bf16 v[124:127], v[64:67], v[48:51], v[124:127]
    s_add_u32 s80, s80, 1
    ds_read_b128 v[36:39], v2 offset:0
    v_mfma_f32_16x16x32_bf16 v[144:147], v[64:67], v[52:55], v[144:147]
    s_cmp_eq_u32 s80, 3
    ds_read_b64_tr_b16 v[60:61], v1 offset:15360
    v_mfma_f32_16x16x32_bf16 v[128:131], v[68:71], v[48:51], v[128:131]
    s_cselect_b32 s80, 0, s80
    ds_read_b64_tr_b16 v[62:63], v1 offset:19200
    v_mfma_f32_16x16x32_bf16 v[148:151], v[68:71], v[52:55], v[148:151]
    s_cselect_b32 s60, s65, s64
    ds_read_b128 v[40:43], v2 offset:2048
    v_mfma_f32_16x16x32_bf16 v[132:135], v[72:75], v[48:51], v[132:135]
    v_add_u32 v2, s60, v2
    ds_read_b64_tr_b16 v[64:65], v1 offset:15392
    v_mfma_f32_16x16x32_bf16 v[152:155], v[72:75], v[52:55], v[152:155]
    ds_read_b64_tr_b16 v[66:67], v1 offset:19232
    ds_read_b64_tr_b16 v[68:69], v1 offset:15424
    v_mfma_f32_16x16x32_bf16 v[136:139], v[76:79], v[48:51], v[136:139]
    ds_read_b64_tr_b16 v[70:71], v1 offset:19264
    v_mfma_f32_16x16x32_bf16 v[156:159], v[76:79], v[52:55], v[156:159]
    ds_read_b64_tr_b16 v[72:73], v1 offset:15456
    ds_read_b64_tr_b16 v[74:75], v1 offset:19296
    v_mfma_f32_16x16x32_bf16 v[160:163], v[80:83], v[48:51], v[160:163]
    ds_read_b64_tr_b16 v[76:77], v1 offset:15488
    v_mfma_f32_16x16x32_bf16 v[180:183], v[80:83], v[52:55], v[180:183]
    ds_read_b64_tr_b16 v[78:79], v1 offset:19328
    v_mfma_f32_16x16x32_bf16 v[164:167], v[84:87], v[48:51], v[164:167]
    ds_read_b64_tr_b16 v[80:81], v1 offset:15520
    v_mfma_f32_16x16x32_bf16 v[184:187], v[84:87], v[52:55], v[184:187]
    ds_read_b64_tr_b16 v[82:83], v1 offset:19360
    v_mfma_f32_16x16x32_bf16 v[240:243], v[84:87], v[56:59], v[240:243]
    ds_read_b64_tr_b16 v[84:85], v1 offset:15552
    v_mfma_f32_16x16x32_bf16 v[168:171], v[88:91], v[48:51], v[168:171]
    ds_read_b64_tr_b16 v[86:87], v1 offset:19392
    v_mfma_f32_16x16x32_bf16 v[188:191], v[88:91], v[52:55], v[188:191]
    ds_read_b128 v[44:47], v4 offset:0
    v_mfma_f32_16x16x32_bf16 v[172:175], v[92:95], v[48:51], v[172:175]
    v_add_u32 v4, s60, v4
    v_mfma_f32_16x16x32_bf16 v[192:195], v[92:95], v[52:55], v[192:195]
    ds_read_b64_tr_b16 v[88:89], v1 offset:15584
    ds_read_b64_tr_b16 v[90:91], v1 offset:19424
    v_mfma_f32_16x16x32_bf16 v[176:179], v[96:99], v[48:51], v[176:179]
    ds_read_b64_tr_b16 v[92:93], v1 offset:15616
    v_mfma_f32_16x16x32_bf16 v[196:199], v[96:99], v[52:55], v[196:199]
    ds_read_b64_tr_b16 v[94:95], v1 offset:19456
    s_waitcnt lgkmcnt(9)
    v_mfma_f32_16x16x32_bf16 v[200:203], v[48:51], v[100:103], v[200:203]
    ds_read_b64_tr_b16 v[96:97], v1 offset:15648
    v_mfma_f32_16x16x32_bf16 v[204:207], v[52:55], v[100:103], v[204:207]
    ds_read_b64_tr_b16 v[98:99], v1 offset:19488
    v_mfma_f32_16x16x32_bf16 v[244:247], v[56:59], v[100:103], v[244:247]
    ds_read_b64_tr_b16 v[100:101], v1 offset:15680
    v_mfma_f32_16x16x32_bf16 v[208:211], v[48:51], v[104:107], v[208:211]
    ds_read_b64_tr_b16 v[102:103], v1 offset:19520
    v_mfma_f32_16x16x32_bf16 v[212:215], v[52:55], v[104:107], v[212:215]
    ds_read_b64_tr_b16 v[104:105], v1 offset:15712
    v_mfma_f32_16x16x32_bf16 v[216:219], v[48:51], v[108:111], v[216:219]
    ds_read_b64_tr_b16 v[106:107], v1 offset:19552
    v_mfma_f32_16x16x32_bf16 v[220:223], v[52:55], v[108:111], v[220:223]
    ds_read_b64_tr_b16 v[108:109], v1 offset:15744
    v_mfma_f32_16x16x32_bf16 v[224:227], v[48:51], v[112:115], v[224:227]
    ds_read_b64_tr_b16 v[110:111], v1 offset:19584
    v_mfma_f32_16x16x32_bf16 v[228:231], v[52:55], v[112:115], v[228:231]
    ds_read_b64_tr_b16 v[112:113], v1 offset:15776
    v_mfma_f32_16x16x32_bf16 v[232:235], v[48:51], v[116:119], v[232:235]
    ds_read_b64_tr_b16 v[114:115], v1 offset:19616
    v_mfma_f32_16x16x32_bf16 v[236:239], v[52:55], v[116:119], v[236:239]
    v_mfma_f32_16x16x32_bf16 v[248:251], v[56:59], v[116:119], v[248:251]
    ds_read_b64_tr_b16 v[116:117], v1 offset:15808
    s_branch L_ml_61
L_tl_62:
    v_mfma_f32_16x16x32_bf16 v[120:123], v[60:63], v[48:51], v[120:123]
    ds_read_b64_tr_b16 v[116:117], v1 offset:448
    ds_read_b64_tr_b16 v[118:119], v1 offset:4288
    v_mfma_f32_16x16x32_bf16 v[140:143], v[60:63], v[52:55], v[140:143]
    ds_read2_b32 v[36:37], v29 offset0:0 offset1:144
    ds_read2_b32 v[38:39], v29 offset0:16 offset1:160
    v_mfma_f32_16x16x32_bf16 v[124:127], v[64:67], v[48:51], v[124:127]
    ds_read2_b32 v[40:41], v30 offset0:0 offset1:144
    ds_read_b32 v42, v34 offset:640
    v_mfma_f32_16x16x32_bf16 v[144:147], v[64:67], v[52:55], v[144:147]
    ds_read_b32 v43, v34 offset:704
    ds_read_b32 v44, v34 offset:768
    v_mfma_f32_16x16x32_bf16 v[128:131], v[68:71], v[48:51], v[128:131]
    ds_read_b32 v45, v34 offset:832
    ds_read_b32 v46, v34 offset:896
    v_mfma_f32_16x16x32_bf16 v[148:151], v[68:71], v[52:55], v[148:151]
    ds_read_b128 v[60:63], v33 offset:320
    ds_read_b128 v[64:67], v33 offset:384
    v_mfma_f32_16x16x32_bf16 v[132:135], v[72:75], v[48:51], v[132:135]
    ds_read_b128 v[68:71], v33 offset:448
    v_mfma_f32_16x16x32_bf16 v[152:155], v[72:75], v[52:55], v[152:155]
    ds_read_b128 v[72:75], v33 offset:512
    v_mfma_f32_16x16x32_bf16 v[136:139], v[76:79], v[48:51], v[136:139]
    v_mfma_f32_16x16x32_bf16 v[156:159], v[76:79], v[52:55], v[156:159]
    ds_read_b128 v[76:79], v33 offset:576
    v_mfma_f32_16x16x32_bf16 v[160:163], v[80:83], v[48:51], v[160:163]
    v_mfma_f32_16x16x32_bf16 v[180:183], v[80:83], v[52:55], v[180:183]
    ds_read_b128 v[80:83], v33 offset:0
    v_mfma_f32_16x16x32_bf16 v[164:167], v[84:87], v[48:51], v[164:167]
    v_mfma_f32_16x16x32_bf16 v[184:187], v[84:87], v[52:55], v[184:187]
    v_mfma_f32_16x16x32_bf16 v[240:243], v[84:87], v[56:59], v[240:243]
    ds_read_b128 v[84:87], v33 offset:64
    v_mfma_f32_16x16x32_bf16 v[168:171], v[88:91], v[48:51], v[168:171]
    v_mfma_f32_16x16x32_bf16 v[188:191], v[88:91], v[52:55], v[188:191]
    ds_read_b128 v[88:91], v33 offset:128
    v_mfma_f32_16x16x32_bf16 v[172:175], v[92:95], v[48:51], v[172:175]
    v_mfma_f32_16x16x32_bf16 v[192:195], v[92:95], v[52:55], v[192:195]
    ds_read_b128 v[92:95], v33 offset:192
    v_mfma_f32_16x16x32_bf16 v[176:179], v[96:99], v[48:51], v[176:179]
    v_mfma_f32_16x16x32_bf16 v[196:199], v[96:99], v[52:55], v[196:199]
    ds_read_b128 v[96:99], v33 offset:256
    s_waitcnt lgkmcnt(14)
    v_mfma_f32_16x16x32_bf16 v[200:203], v[48:51], v[100:103], v[200:203]
    v_mfma_f32_16x16x32_bf16 v[204:207], v[52:55], v[100:103], v[204:207]
    v_mfma_f32_16x16x32_bf16 v[244:247], v[56:59], v[100:103], v[244:247]
    ds_read_b128 v[100:103], v31 offset:0
    v_mfma_f32_16x16x32_bf16 v[208:211], v[48:51], v[104:107], v[208:211]
    v_mfma_f32_16x16x32_bf16 v[212:215], v[52:55], v[104:107], v[212:215]
    ds_read_b128 v[104:107], v31 offset:64
    v_mfma_f32_16x16x32_bf16 v[216:219], v[48:51], v[108:111], v[216:219]
    v_mfma_f32_16x16x32_bf16 v[220:223], v[52:55], v[108:111], v[220:223]
    ds_read_b128 v[108:111], v31 offset:576
    v_mfma_f32_16x16x32_bf16 v[224:227], v[48:51], v[112:115], v[224:227]
    v_mfma_f32_16x16x32_bf16 v[228:231], v[52:55], v[112:115], v[228:231]
    ds_read_b128 v[112:115], v31 offset:640
    v_mfma_f32_16x16x32_bf16 v[232:235], v[48:51], v[116:119], v[232:235]
    v_mfma_f32_16x16x32_bf16 v[236:239], v[52:55], v[116:119], v[236:239]
    v_mfma_f32_16x16x32_bf16 v[248:251], v[56:59], v[116:119], v[248:251]
    ds_read_b128 v[48:51], v32 offset:0
    ds_read_b128 v[52:55], v32 offset:576
    s_branch L_e1_58
L_qw_56:
    s_add_u32 s80, s80, 1
    s_cmp_eq_u32 s80, 3
    s_cselect_b32 s80, 0, s80
    s_cselect_b32 s60, s65, s64
    ds_read_b128 v[36:39], v2 offset:0
    ds_read_b64_tr_b16 v[60:61], v1 offset:15360
    ds_read_b64_tr_b16 v[62:63], v1 offset:19200
    ds_read_b128 v[40:43], v2 offset:2048
    v_add_u32 v2, s60, v2
    ds_read_b64_tr_b16 v[64:65], v1 offset:15392
    ds_read_b64_tr_b16 v[66:67], v1 offset:19232
    ds_read_b64_tr_b16 v[68:69], v1 offset:15424
    ds_read_b64_tr_b16 v[70:71], v1 offset:19264
    ds_read_b64_tr_b16 v[72:73], v1 offset:15456
    ds_read_b64_tr_b16 v[74:75], v1 offset:19296
    ds_read_b64_tr_b16 v[76:77], v1 offset:15488
    ds_read_b64_tr_b16 v[78:79], v1 offset:19328
    ds_read_b64_tr_b16 v[80:81], v1 offset:15520
    ds_read_b64_tr_b16 v[82:83], v1 offset:19360
    ds_read_b64_tr_b16 v[84:85], v1 offset:15552
    ds_read_b64_tr_b16 v[86:87], v1 offset:19392
    ds_read_b64_tr_b16 v[88:89], v1 offset:15584
    ds_read_b64_tr_b16 v[90:91], v1 offset:19424
    ds_read_b128 v[44:47], v4 offset:0
    v_add_u32 v4, s60, v4
    ds_read_b64_tr_b16 v[92:93], v1 offset:15616
    ds_read_b64_tr_b16 v[94:95], v1 offset:19456
    ds_read_b64_tr_b16 v[96:97], v1 offset:15648
    ds_read_b64_tr_b16 v[98:99], v1 offset:19488
    ds_read_b64_tr_b16 v[100:101], v1 offset:15680
    ds_read_b64_tr_b16 v[102:103], v1 offset:19520
    ds_read_b64_tr_b16 v[104:105], v1 offset:15712
    ds_read_b64_tr_b16 v[106:107], v1 offset:19552
    ds_read_b64_tr_b16 v[108:109], v1 offset:15744
    ds_read_b64_tr_b16 v[110:111], v1 offset:19584
    ds_read_b64_tr_b16 v[112:113], v1 offset:15776
    ds_read_b64_tr_b16 v[114:115], v1 offset:19616
    ds_read_b64_tr_b16 v[116:117], v1 offset:15808
    s_waitcnt lgkmcnt(0)
    s_mov_b32 s59, 9
    s_branch L_ml_63
.p2align 5
    s_nop 0
    s_nop 0
    s_nop 0
L_ml_63:
    v_mfma_f32_16x16x32_bf16 v[120:123], v[60:63], v[36:39], v[120:123]
    ds_read_b64_tr_b16 v[118:119], v1 offset:19648
    v_mfma_f32_16x16x32_bf16 v[140:143], v[60:63], v[40:43], v[140:143]
    ds_read_b128 v[48:51], v3 offset:0
    ds_read_b64_tr_b16 v[60:61], v1 offset:0
    v_mfma_f32_16x16x32_bf16 v[124:127], v[64:67], v[36:39], v[124:127]
    ds_read_b64_tr_b16 v[62:63], v1 offset:3840
    v_mfma_f32_16x16x32_bf16 v[144:147], v[64:67], v[40:43], v[144:147]
    ds_read_b128 v[52:55], v3 offset:2048
    v_mfma_f32_16x16x32_bf16 v[128:131], v[68:71], v[36:39], v[128:131]
    v_add_u32 v3, s60, v3
    v_mfma_f32_16x16x32_bf16 v[148:151], v[68:71], v[40:43], v[148:151]
    ds_read_b64_tr_b16 v[64:65], v1 offset:32
    ds_read_b64_tr_b16 v[66:67], v1 offset:3872
    v_mfma_f32_16x16x32_bf16 v[132:135], v[72:75], v[36:39], v[132:135]
    ds_read_b64_tr_b16 v[68:69], v1 offset:64
    v_mfma_f32_16x16x32_bf16 v[152:155], v[72:75], v[40:43], v[152:155]
    ds_read_b64_tr_b16 v[70:71], v1 offset:3904
    s_waitcnt lgkmcnt(10)
    v_mfma_f32_16x16x32_bf16 v[136:139], v[76:79], v[36:39], v[136:139]
    ds_read_b64_tr_b16 v[72:73], v1 offset:96
    v_mfma_f32_16x16x32_bf16 v[156:159], v[76:79], v[40:43], v[156:159]
    ds_read_b64_tr_b16 v[74:75], v1 offset:3936
    v_mfma_f32_16x16x32_bf16 v[160:163], v[80:83], v[36:39], v[160:163]
    ds_read_b64_tr_b16 v[76:77], v1 offset:128
    v_mfma_f32_16x16x32_bf16 v[180:183], v[80:83], v[40:43], v[180:183]
    ds_read_b64_tr_b16 v[78:79], v1 offset:3968
    v_mfma_f32_16x16x32_bf16 v[164:167], v[84:87], v[36:39], v[164:167]
    ds_read_b64_tr_b16 v[80:81], v1 offset:160
    v_mfma_f32_16x16x32_bf16 v[184:187], v[84:87], v[40:43], v[184:187]
    ds_read_b64_tr_b16 v[82:83], v1 offset:4000
    v_mfma_f32_16x16x32_bf16 v[168:171], v[88:91], v[36:39], v[168:171]
    ds_read_b64_tr_b16 v[84:85], v1 offset:192
    v_mfma_f32_16x16x32_bf16 v[188:191], v[88:91], v[40:43], v[188:191]
    ds_read_b64_tr_b16 v[86:87], v1 offset:4032
    v_mfma_f32_16x16x32_bf16 v[240:243], v[88:91], v[44:47], v[240:243]
    ds_read_b64_tr_b16 v[88:89], v1 offset:224
    v_mfma_f32_16x16x32_bf16 v[172:175], v[92:95], v[36:39], v[172:175]
    ds_read_b64_tr_b16 v[90:91], v1 offset:4064
    v_mfma_f32_16x16x32_bf16 v[192:195], v[92:95], v[40:43], v[192:195]
    ds_read_b128 v[56:59], v5 offset:0
    v_mfma_f32_16x16x32_bf16 v[176:179], v[96:99], v[36:39], v[176:179]
    v_add_u32 v5, s60, v5
    v_mfma_f32_16x16x32_bf16 v[196:199], v[96:99], v[40:43], v[196:199]
    ds_read_b64_tr_b16 v[92:93], v1 offset:256
    ds_read_b64_tr_b16 v[94:95], v1 offset:4096
    v_mfma_f32_16x16x32_bf16 v[200:203], v[36:39], v[100:103], v[200:203]
    ds_read_b64_tr_b16 v[96:97], v1 offset:288
    v_mfma_f32_16x16x32_bf16 v[204:207], v[40:43], v[100:103], v[204:207]
    ds_read_b64_tr_b16 v[98:99], v1 offset:4128
    v_mfma_f32_16x16x32_bf16 v[208:211], v[36:39], v[104:107], v[208:211]
    ds_read_b64_tr_b16 v[100:101], v1 offset:320
    v_mfma_f32_16x16x32_bf16 v[212:215], v[40:43], v[104:107], v[212:215]
    ds_read_b64_tr_b16 v[102:103], v1 offset:4160
    v_mfma_f32_16x16x32_bf16 v[244:247], v[44:47], v[104:107], v[244:247]
    ds_read_b64_tr_b16 v[104:105], v1 offset:352
    v_mfma_f32_16x16x32_bf16 v[216:219], v[36:39], v[108:111], v[216:219]
    ds_read_b64_tr_b16 v[106:107], v1 offset:4192
    v_mfma_f32_16x16x32_bf16 v[220:223], v[40:43], v[108:111], v[220:223]
    ds_read_b64_tr_b16 v[108:109], v1 offset:384
    v_mfma_f32_16x16x32_bf16 v[224:227], v[36:39], v[112:115], v[224:227]
    ds_read_b64_tr_b16 v[110:111], v1 offset:4224
    v_mfma_f32_16x16x32_bf16 v[228:231], v[40:43], v[112:115], v[228:231]
    s_sub_u32 s59, s59, 1
    s_waitcnt lgkmcnt(8)
    v_mfma_f32_16x16x32_bf16 v[232:235], v[36:39], v[116:119], v[232:235]
    ds_read_b64_tr_b16 v[112:113], v1 offset:416
    v_mfma_f32_16x16x32_bf16 v[236:239], v[40:43], v[116:119], v[236:239]
    s_waitcnt vmcnt(0)
    s_barrier
    s_cbranch_scc1 L_tl_64
    v_mfma_f32_16x16x32_bf16 v[120:123], v[60:63], v[48:51], v[120:123]
    ds_read_b64_tr_b16 v[114:115], v1 offset:4256
    ds_read_b64_tr_b16 v[116:117], v1 offset:448
    v_mfma_f32_16x16x32_bf16 v[140:143], v[60:63], v[52:55], v[140:143]
    ds_read_b64_tr_b16 v[118:119], v1 offset:4288
    v_add_u32 v1, s60, v1
    v_mfma_f32_16x16x32_bf16 v[124:127], v[64:67], v[48:51], v[124:127]
    s_add_u32 s80, s80, 1
    ds_read_b128 v[36:39], v2 offset:0
    v_mfma_f32_16x16x32_bf16 v[144:147], v[64:67], v[52:55], v[144:147]
    s_cmp_eq_u32 s80, 3
    ds_read_b64_tr_b16 v[60:61], v1 offset:15360
    v_mfma_f32_16x16x32_bf16 v[128:131], v[68:71], v[48:51], v[128:131]
    s_cselect_b32 s80, 0, s80
    ds_read_b64_tr_b16 v[62:63], v1 offset:19200
    v_mfma_f32_16x16x32_bf16 v[148:151], v[68:71], v[52:55], v[148:151]
    s_cselect_b32 s60, s65, s64
    ds_read_b128 v[40:43], v2 offset:2048
    v_mfma_f32_16x16x32_bf16 v[132:135], v[72:75], v[48:51], v[132:135]
    v_add_u32 v2, s60, v2
    ds_read_b64_tr_b16 v[64:65], v1 offset:15392
    v_mfma_f32_16x16x32_bf16 v[152:155], v[72:75], v[52:55], v[152:155]
    ds_read_b64_tr_b16 v[66:67], v1 offset:19232
    ds_read_b64_tr_b16 v[68:69], v1 offset:15424
    v_mfma_f32_16x16x32_bf16 v[136:139], v[76:79], v[48:51], v[136:139]
    ds_read_b64_tr_b16 v[70:71], v1 offset:19264
    v_mfma_f32_16x16x32_bf16 v[156:159], v[76:79], v[52:55], v[156:159]
    ds_read_b64_tr_b16 v[72:73], v1 offset:15456
    ds_read_b64_tr_b16 v[74:75], v1 offset:19296
    v_mfma_f32_16x16x32_bf16 v[160:163], v[80:83], v[48:51], v[160:163]
    ds_read_b64_tr_b16 v[76:77], v1 offset:15488
    v_mfma_f32_16x16x32_bf16 v[180:183], v[80:83], v[52:55], v[180:183]
    ds_read_b64_tr_b16 v[78:79], v1 offset:19328
    v_mfma_f32_16x16x32_bf16 v[164:167], v[84:87], v[48:51], v[164:167]
    ds_read_b64_tr_b16 v[80:81], v1 offset:15520
    v_mfma_f32_16x16x32_bf16 v[184:187], v[84:87], v[52:55], v[184:187]
    ds_read_b64_tr_b16 v[82:83], v1 offset:19360
    v_mfma_f32_16x16x32_bf16 v[168:171], v[88:91], v[48:51], v[168:171]
    ds_read_b64_tr_b16 v[84:85], v1 offset:15552
    v_mfma_f32_16x16x32_bf16 v[188:191], v[88:91], v[52:55], v[188:191]
    ds_read_b64_tr_b16 v[86:87], v1 offset:19392
    v_mfma_f32_16x16x32_bf16 v[240:243], v[88:91], v[56:59], v[240:243]
    ds_read_b64_tr_b16 v[88:89], v1 offset:15584
    v_mfma_f32_16x16x32_bf16 v[172:175], v[92:95], v[48:51], v[172:175]
    ds_read_b64_tr_b16 v[90:91], v1 offset:19424
    v_mfma_f32_16x16x32_bf16 v[192:195], v[92:95], v[52:55], v[192:195]
    ds_read_b128 v[44:47], v4 offset:0
    s_waitcnt lgkmcnt(9)
    v_mfma_f32_16x16x32_bf16 v[176:179], v[96:99], v[48:51], v[176:179]
    v_add_u32 v4, s60, v4
    v_mfma_f32_16x16x32_bf16 v[196:199], v[96:99], v[52:55], v[196:199]
    ds_read_b64_tr_b16 v[92:93], v1 offset:15616
    ds_read_b64_tr_b16 v[94:95], v1 offset:19456
    v_mfma_f32_16x16x32_bf16 v[200:203], v[48:51], v[100:103], v[200:203]
    ds_read_b64_tr_b16 v[96:97], v1 offset:15648
    v_mfma_f32_16x16x32_bf16 v[204:207], v[52:55], v[100:103], v[204:207]
    ds_read_b64_tr_b16 v[98:99], v1 offset:19488
    v_mfma_f32_16x16x32_bf16 v[208:211], v[48:51], v[104:107], v[208:211]
    ds_read_b64_tr_b16 v[100:101], v1 offset:15680
    v_mfma_f32_16x16x32_bf16 v[212:215], v[52:55], v[104:107], v[212:215]
    ds_read_b64_tr_b16 v[102:103], v1 offset:19520
    v_mfma_f32_16x16x32_bf16 v[244:247], v[56:59], v[104:107], v[244:247]
    ds_read_b64_tr_b16 v[104:105], v1 offset:15712
    v_mfma_f32_16x16x32_bf16 v[216:219], v[48:51], v[108:111], v[216:219]
    ds_read_b64_tr_b16 v[106:107], v1 offset:19552
    v_mfma_f32_16x16x32_bf16 v[220:223], v[52:55], v[108:111], v[220:223]
    ds_read_b64_tr_b16 v[108:109], v1 offset:15744
    v_mfma_f32_16x16x32_bf16 v[224:227], v[48:51], v[112:115], v[224:227]
    ds_read_b64_tr_b16 v[110:111], v1 offset:19584
    v_mfma_f32_16x16x32_bf16 v[228:231], v[52:55], v[112:115], v[228:231]
    ds_read_b64_tr_b16 v[112:113], v1 offset:15776
    v_mfma_f32_16x16x32_bf16 v[232:235], v[48:51], v[116:119], v[232:235]
    ds_read_b64_tr_b16 v[114:115], v1 offset:19616
    v_mfma_f32_16x16x32_bf16 v[236:239], v[52:55], v[116:119], v[236:239]
    ds_read_b64_tr_b16 v[116:117], v1 offset:15808
    s_branch L_ml_63
L_tl_64:
    v_mfma_f32_16x16x32_bf16 v[120:123], v[60:63], v[48:51], v[120:123]
    ds_read_b64_tr_b16 v[114:115], v1 offset:4256
    ds_read_b64_tr_b16 v[116:117], v1 offset:448
    v_mfma_f32_16x16x32_bf16 v[140:143], v[60:63], v[52:55], v[140:143]
    ds_read_b64_tr_b16 v[118:119], v1 offset:4288
    ds_read2_b32 v[36:37], v29 offset0:0 offset1:144
    v_mfma_f32_16x16x32_bf16 v[124:127], v[64:67], v[48:51], v[124:127]
    ds_read2_b32 v[38:39], v29 offset0:16 offset1:160
    ds_read2_b32 v[40:41], v30 offset0:0 offset1:144
    v_mfma_f32_16x16x32_bf16 v[144:147], v[64:67], v[52:55], v[144:147]
    ds_read_b32 v42, v34 offset:640
    ds_read_b32 v43, v34 offset:704
    v_mfma_f32_16x16x32_bf16 v[128:131], v[68:71], v[48:51], v[128:131]
    ds_read_b32 v44, v34 offset:768
    ds_read_b32 v45, v34 offset:832
    v_mfma_f32_16x16x32_bf16 v[148:151], v[68:71], v[52:55], v[148:151]
    ds_read_b32 v46, v34 offset:896
    ds_read_b128 v[60:63], v33 offset:320
    v_mfma_f32_16x16x32_bf16 v[132:135], v[72:75], v[48:51], v[132:135]
    ds_read_b128 v[64:67], v33 offset:384
    ds_read_b128 v[68:71], v33 offset:448
    v_mfma_f32_16x16x32_bf16 v[152:155], v[72:75], v[52:55], v[152:155]
    ds_read_b128 v[72:75], v33 offset:512
    v_mfma_f32_16x16x32_bf16 v[136:139], v[76:79], v[48:51], v[136:139]
    v_mfma_f32_16x16x32_bf16 v[156:159], v[76:79], v[52:55], v[156:159]
    ds_read_b128 v[76:79], v33 offset:576
    v_mfma_f32_16x16x32_bf16 v[160:163], v[80:83], v[48:51], v[160:163]
    v_mfma_f32_16x16x32_bf16 v[180:183], v[80:83], v[52:55], v[180:183]
    ds_read_b128 v[80:83], v33 offset:0
    v_mfma_f32_16x16x32_bf16 v[164:167], v[84:87], v[48:51], v[164:167]
    v_mfma_f32_16x16x32_bf16 v[184:187], v[84:87], v[52:55], v[184:187]
    ds_read_b128 v[84:87], v33 offset:64
    v_mfma_f32_16x16x32_bf16 v[168:171], v[88:91], v[48:51], v[168:171]
    v_mfma_f32_16x16x32_bf16 v[188:191], v[88:91], v[52:55], v[188:191]
    v_mfma_f32_16x16x32_bf16 v[240:243], v[88:91], v[56:59], v[240:243]
    ds_read_b128 v[88:91], v33 offset:128
    v_mfma_f32_16x16x32_bf16 v[172:175], v[92:95], v[48:51], v[172:175]
    v_mfma_f32_16x16x32_bf16 v[192:195], v[92:95], v[52:55], v[192:195]
    ds_read_b128 v[92:95], v33 offset:192
    s_waitcnt lgkmcnt(14)
    v_mfma_f32_16x16x32_bf16 v[176:179], v[96:99], v[48:51], v[176:179]
    v_mfma_f32_16x16x32_bf16 v[196:199], v[96:99], v[52:55], v[196:199]
    ds_read_b128 v[96:99], v33 offset:256
    v_mfma_f32_16x16x32_bf16 v[200:203], v[48:51], v[100:103], v[200:203]
    v_mfma_f32_16x16x32_bf16 v[204:207], v[52:55], v[100:103], v[204:207]
    ds_read_b128 v[100:103], v31 offset:0
    v_mfma_f32_16x16x32_bf16 v[208:211], v[48:51], v[104:107], v[208:211]
    v_mfma_f32_16x16x32_bf16 v[212:215], v[52:55], v[104:107], v[212:215]
    v_mfma_f32_16x16x32_bf16 v[244:247], v[56:59], v[104:107], v[244:247]
    ds_read_b128 v[104:107], v31 offset:64
    v_mfma_f32_16x16x32_bf16 v[216:219], v[48:51], v[108:111], v[216:219]
    v_mfma_f32_16x16x32_bf16 v[220:223], v[52:55], v[108:111], v[220:223]
    ds_read_b128 v[108:111], v31 offset:576
    v_mfma_f32_16x16x32_bf16 v[224:227], v[48:51], v[112:115], v[224:227]
    v_mfma_f32_16x16x32_bf16 v[228:231], v[52:55], v[112:115], v[228:231]
    ds_read_b128 v[112:115], v31 offset:640
    v_mfma_f32_16x16x32_bf16 v[232:235], v[48:51], v[116:119], v[232:235]
    v_mfma_f32_16x16x32_bf16 v[236:239], v[52:55], v[116:119], v[236:239]
    ds_read_b128 v[48:51], v32 offset:0
    ds_read_b128 v[52:55], v32 offset:576
    s_branch L_e1_58
L_qw_57:
    s_add_u32 s80, s80, 1
    s_cmp_eq_u32 s80, 3
    s_cselect_b32 s80, 0, s80
    s_cselect_b32 s60, s65, s64
    ds_read_b128 v[36:39], v2 offset:0
    ds_read_b64_tr_b16 v[60:61], v1 offset:15360
    ds_read_b64_tr_b16 v[62:63], v1 offset:19200
    ds_read_b128 v[40:43], v2 offset:2048
    v_add_u32 v2, s60, v2
    ds_read_b64_tr_b16 v[64:65], v1 offset:15392
    ds_read_b64_tr_b16 v[66:67], v1 offset:19232
    ds_read_b64_tr_b16 v[68:69], v1 offset:15424
    ds_read_b64_tr_b16 v[70:71], v1 offset:19264
    ds_read_b64_tr_b16 v[72:73], v1 offset:15456
    ds_read_b64_tr_b16 v[74:75], v1 offset:19296
    ds_read_b64_tr_b16 v[76:77], v1 offset:15488
    ds_read_b64_tr_b16 v[78:79], v1 offset:19328
    ds_read_b64_tr_b16 v[80:81], v1 offset:15520
    ds_read_b64_tr_b16 v[82:83], v1 offset:19360
    ds_read_b64_tr_b16 v[84:85], v1 offset:15552
    ds_read_b64_tr_b16 v[86:87], v1 offset:19392
    ds_read_b64_tr_b16 v[88:89], v1 offset:15584
    ds_read_b64_tr_b16 v[90:91], v1 offset:19424
    ds_read_b64_tr_b16 v[92:93], v1 offset:15616
    ds_read_b64_tr_b16 v[94:95], v1 offset:19456
    ds_read_b128 v[44:47], v4 offset:0
    v_add_u32 v4, s60, v4
    ds_read_b64_tr_b16 v[96:97], v1 offset:15648
    ds_read_b64_tr_b16 v[98:99], v1 offset:19488
    ds_read_b64_tr_b16 v[100:101], v1 offset:15680
    ds_read_b64_tr_b16 v[102:103], v1 offset:19520
    ds_read_b64_tr_b16 v[104:105], v1 offset:15712
    ds_read_b64_tr_b16 v[106:107], v1 offset:19552
    ds_read_b64_tr_b16 v[108:109], v1 offset:15744
    ds_read_b64_tr_b16 v[110:111], v1 offset:19584
    ds_read_b64_tr_b16 v[112:113], v1 offset:15776
    ds_read_b64_tr_b16 v[114:115], v1 offset:19616
    ds_read_b64_tr_b16 v[116:117], v1 offset:15808
    s_waitcnt lgkmcnt(0)
    s_mov_b32 s59, 9
    s_branch L_ml_65
.p2align 5
    s_nop 0
    s_nop 0
    s_nop 0
L_ml_65:
    v_mfma_f32_16x16x32_bf16 v[120:123], v[60:63], v[36:39], v[120:123]
    ds_read_b64_tr_b16 v[118:119], v1 offset:19648
    v_mfma_f32_16x16x32_bf16 v[140:143], v[60:63], v[40:43], v[140:143]
    ds_read_b128 v[48:51], v3 offset:0
    ds_read_b64_tr_b16 v[60:61], v1 offset:0
    v_mfma_f32_16x16x32_bf16 v[124:127], v[64:67], v[36:39], v[124:127]
    ds_read_b64_tr_b16 v[62:63], v1 offset:3840
    v_mfma_f32_16x16x32_bf16 v[144:147], v[64:67], v[40:43], v[144:147]
    ds_read_b128 v[52:55], v3 offset:2048
    v_mfma_f32_16x16x32_bf16 v[128:131], v[68:71], v[36:39], v[128:131]
    v_add_u32 v3, s60, v3
    v_mfma_f32_16x16x32_bf16 v[148:151], v[68:71], v[40:43], v[148:151]
    ds_read_b64_tr_b16 v[64:65], v1 offset:32
    ds_read_b64_tr_b16 v[66:67], v1 offset:3872
    v_mfma_f32_16x16x32_bf16 v[132:135], v[72:75], v[36:39], v[132:135]
    ds_read_b64_tr_b16 v[68:69], v1 offset:64
    v_mfma_f32_16x16x32_bf16 v[152:155], v[72:75], v[40:43], v[152:155]
    ds_read_b64_tr_b16 v[70:71], v1 offset:3904
    s_waitcnt lgkmcnt(10)
    v_mfma_f32_16x16x32_bf16 v[136:139], v[76:79], v[36:39], v[136:139]
    ds_read_b64_tr_b16 v[72:73], v1 offset:96
    v_mfma_f32_16x16x32_bf16 v[156:159], v[76:79], v[40:43], v[156:159]
    ds_read_b64_tr_b16 v[74:75], v1 offset:3936
    v_mfma_f32_16x16x32_bf16 v[160:163], v[80:83], v[36:39], v[160:163]
    ds_read_b64_tr_b16 v[76:77], v1 offset:128
    v_mfma_f32_16x16x32_bf16 v[180:183], v[80:83], v[40:43], v[180:183]
    ds_read_b64_tr_b16 v[78:79], v1 offset:3968
    v_mfma_f32_16x16x32_bf16 v[164:167], v[84:87], v[36:39], v[164:167]
    ds_read_b64_tr_b16 v[80:81], v1 offset:160
    v_mfma_f32_16x16x32_bf16 v[184:187], v[84:87], v[40:43], v[184:187]
    ds_read_b64_tr_b16 v[82:83], v1 offset:4000
    v_mfma_f32_16x16x32_bf16 v[168:171], v[88:91], v[36:39], v[168:171]
    ds_read_b64_tr_b16 v[84:85], v1 offset:192
    v_mfma_f32_16x16x32_bf16 v[188:191], v[88:91], v[40:43], v[188:191]
    ds_read_b64_tr_b16 v[86:87], v1 offset:4032
    v_mfma_f32_16x16x32_bf16 v[172:175], v[92:95], v[36:39], v[172:175]
    ds_read_b64_tr_b16 v[88:89], v1 offset:224
    v_mfma_f32_16x16x32_bf16 v[192:195], v[92:95], v[40:43], v[192:195]
    ds_read_b64_tr_b16 v[90:91], v1 offset:4064
    v_mfma_f32_16x16x32_bf16 v[240:243], v[92:95], v[44:47], v[240:243]
    ds_read_b64_tr_b16 v[92:93], v1 offset:256
    v_mfma_f32_16x16x32_bf16 v[176:179], v[96:99], v[36:39], v[176:179]
    ds_read_b64_tr_b16 v[94:95], v1 offset:4096
    v_mfma_f32_16x16x32_bf16 v[196:199], v[96:99], v[40:43], v[196:199]
    ds_read_b128 v[56:59], v5 offset:0
    v_mfma_f32_16x16x32_bf16 v[200:203], v[36:39], v[100:103], v[200:203]
    v_add_u32 v5, s60, v5
    v_mfma_f32_16x16x32_bf16 v[204:207], v[40:43], v[100:103], v[204:207]
    ds_read_b64_tr_b16 v[96:97], v1 offset:288
    ds_read_b64_tr_b16 v[98:99], v1 offset:4128
    v_mfma_f32_16x16x32_bf16 v[208:211], v[36:39], v[104:107], v[208:211]
    ds_read_b64_tr_b16 v[100:101], v1 offset:320
    v_mfma_f32_16x16x32_bf16 v[212:215], v[40:43], v[104:107], v[212:215]
    ds_read_b64_tr_b16 v[102:103], v1 offset:4160
    v_mfma_f32_16x16x32_bf16 v[216:219], v[36:39], v[108:111], v[216:219]
    ds_read_b64_tr_b16 v[104:105], v1 offset:352
    v_mfma_f32_16x16x32_bf16 v[220:223], v[40:43], v[108:111], v[220:223]
    ds_read_b64_tr_b16 v[106:107], v1 offset:4192
    v_mfma_f32_16x16x32_bf16 v[244:247], v[44:47], v[108:111], v[244:247]
    ds_read_b64_tr_b16 v[108:109], v1 offset:384
    v_mfma_f32_16x16x32_bf16 v[224:227], v[36:39], v[112:115], v[224:227]
    ds_read_b64_tr_b16 v[110:111], v1 offset:4224
    v_mfma_f32_16x16x32_bf16 v[228:231], v[40:43], v[112:115], v[228:231]
    s_sub_u32 s59, s59, 1
    s_waitcnt lgkmcnt(8)
    v_mfma_f32_16x16x32_bf16 v[232:235], v[36:39], v[116:119], v[232:235]
    ds_read_b64_tr_b16 v[112:113], v1 offset:416
    v_mfma_f32_16x16x32_bf16 v[236:239], v[40:43], v[116:119], v[236:239]
    s_waitcnt vmcnt(0)
    s_barrier
    s_cbranch_scc1 L_tl_66
    v_mfma_f32_16x16x32_bf16 v[120:123], v[60:63], v[48:51], v[120:123]
    ds_read_b64_tr_b16 v[114:115], v1 offset:4256
    ds_read_b64_tr_b16 v[116:117], v1 offset:448
    v_mfma_f32_16x16x32_bf16 v[140:143], v[60:63], v[52:55], v[140:143]
    ds_read_b64_tr_b16 v[118:119], v1 offset:4288
    v_add_u32 v1, s60, v1
    v_mfma_f32_16x16x32_bf16 v[124:127], v[64:67], v[48:51], v[124:127]
    s_add_u32 s80, s80, 1
    ds_read_b128 v[36:39], v2 offset:0
    v_mfma_f32_16x16x32_bf16 v[144:147], v[64:67], v[52:55], v[144:147]
    s_cmp_eq_u32 s80, 3
    ds_read_b64_tr_b16 v[60:61], v1 offset:15360
    v_mfma_f32_16x16x32_bf16 v[128:131], v[68:71], v[48:51], v[128:131]
    s_cselect_b32 s80, 0, s80
    ds_read_b64_tr_b16 v[62:63], v1 offset:19200
    v_mfma_f32_16x16x32_bf16 v[148:151], v[68:71], v[52:55], v[148:151]
    s_cselect_b32 s60, s65, s64
    ds_read_b128 v[40:43], v2 offset:2048
    v_mfma_f32_16x16x32_bf16 v[132:135], v[72:75], v[48:51], v[132:135]
    v_add_u32 v2, s60, v2
    ds_read_b64_tr_b16 v[64:65], v1 offset:15392
    v_mfma_f32_16x16x32_bf16 v[152:155], v[72:75], v[52:55], v[152:155]
    ds_read_b64_tr_b16 v[66:67], v1 offset:19232
    ds_read_b64_tr_b16 v[68:69], v1 offset:15424
    v_mfma_f32_16x16x32_bf16 v[136:139], v[76:79], v[48:51], v[136:139]
    ds_read_b64_tr_b16 v[70:71], v1 offset:19264
    v_mfma_f32_16x16x32_bf16 v[156:159], v[76:79], v[52:55], v[156:159]
    ds_read_b64_tr_b16 v[72:73], v1 offset:15456
    ds_read_b64_tr_b16 v[74:75], v1 offset:19296
    v_mfma_f32_16x16x32_bf16 v[160:163], v[80:83], v[48:51], v[160:163]
    ds_read_b64_tr_b16 v[76:77], v1 offset:15488
    v_mfma_f32_16x16x32_bf16 v[180:183], v[80:83], v[52:55], v[180:183]
    ds_read_b64_tr_b16 v[78:79], v1 offset:19328
    v_mfma_f32_16x16x32_bf16 v[164:167], v[84:87], v[48:51], v[164:167]
    ds_read_b64_tr_b16 v[80:81], v1 offset:15520
    v_mfma_f32_16x16x32_bf16 v[184:187], v[84:87], v[52:55], v[184:187]
    ds_read_b64_tr_b16 v[82:83], v1 offset:19360
    v_mfma_f32_16x16x32_bf16 v[168:171], v[88:91], v[48:51], v[168:171]
    ds_read_b64_tr_b16 v[84:85], v1 offset:15552
    v_mfma_f32_16x16x32_bf16 v[188:191], v[88:91], v[52:55], v[188:191]
    ds_read_b64_tr_b16 v[86:87], v1 offset:19392
    v_mfma_f32_16x16x32_bf16 v[172:175], v[92:95], v[48:51], v[172:175]
    ds_read_b64_tr_b16 v[88:89], v1 offset:15584
    v_mfma_f32_16x16x32_bf16 v[192:195], v[92:95], v[52:55], v[192:195]
    ds_read_b64_tr_b16 v[90:91], v1 offset:19424
    v_mfma_f32_16x16x32_bf16 v[240:243], v[92:95], v[56:59], v[240:243]
    ds_read_b64_tr_b16 v[92:93], v1 offset:15616
    s_waitcnt lgkmcnt(9)
    v_mfma_f32_16x16x32_bf16 v[176:179], v[96:99], v[48:51], v[176:179]
    ds_read_b64_tr_b16 v[94:95], v1 offset:19456
    v_mfma_f32_16x16x32_bf16 v[196:199], v[96:99], v[52:55], v[196:199]
    ds_read_b128 v[44:47], v4 offset:0
    v_mfma_f32_16x16x32_bf16 v[200:203], v[48:51], v[100:103], v[200:203]
    v_add_u32 v4, s60, v4
    v_mfma_f32_16x16x32_bf16 v[204:207], v[52:55], v[100:103], v[204:207]
    ds_read_b64_tr_b16 v[96:97], v1 offset:15648
    ds_read_b64_tr_b16 v[98:99], v1 offset:19488
    v_mfma_f32_16x16x32_bf16 v[208:211], v[48:51], v[104:107], v[208:211]
    ds_read_b64_tr_b16 v[100:101], v1 offset:15680
    v_mfma_f32_16x16x32_bf16 v[212:215], v[52:55], v[104:107], v[212:215]
    ds_read_b64_tr_b16 v[102:103], v1 offset:19520
    v_mfma_f32_16x16x32_bf16 v[216:219], v[48:51], v[108:111], v[216:219]
    ds_read_b64_tr_b16 v[104:105], v1 offset:15712
    v_mfma_f32_16x16x32_bf16 v[220:223], v[52:55], v[108:111], v[220:223]
    ds_read_b64_tr_b16 v[106:107], v1 offset:19552
    v_mfma_f32_16x16x32_bf16 v[244:247], v[56:59], v[108:111], v[244:247]
    ds_read_b64_tr_b16 v[108:109], v1 offset:15744
    v_mfma_f32_16x16x32_bf16 v[224:227], v[48:51], v[112:115], v[224:227]
    ds_read_b64_tr_b16 v[110:111], v1 offset:19584
    v_mfma_f32_16x16x32_bf16 v[228:231], v[52:55], v[112:115], v[228:231]
    ds_read_b64_tr_b16 v[112:113], v1 offset:15776
    v_mfma_f32_16x16x32_bf16 v[232:235], v[48:51], v[116:119], v[232:235]
    ds_read_b64_tr_b16 v[114:115], v1 offset:19616
    v_mfma_f32_16x16x32_bf16 v[236:239], v[52:55], v[116:119], v[236:239]
    ds_read_b64_tr_b16 v[116:117], v1 offset:15808
    s_branch L_ml_65
L_tl_66:
    v_mfma_f32_16x16x32_bf16 v[120:123], v[60:63], v[48:51], v[120:123]
    ds_read_b64_tr_b16 v[114:115], v1 offset:4256
    ds_read_b64_tr_b16 v[116:117], v1 offset:448
    v_mfma_f32_16x16x32_bf16 v[140:143], v[60:63], v[52:55], v[140:143]
    ds_read_b64_tr_b16 v[118:119], v1 offset:4288
    ds_read2_b32 v[36:37], v29 offset0:0 offset1:144
    v_mfma_f32_16x16x32_bf16 v[124:127], v[64:67], v[48:51], v[124:127]
    ds_read2_b32 v[38:39], v29 offset0:16 offset1:160
    ds_read2_b32 v[40:41], v30 offset0:0 offset1:144
    v_mfma_f32_16x16x32_bf16 v[144:147], v[64:67], v[52:55], v[144:147]
    ds_read_b32 v42, v34 offset:640
    ds_read_b32 v43, v34 offset:704
    v_mfma_f32_16x16x32_bf16 v[128:131], v[68:71], v[48:51], v[128:131]
    ds_read_b32 v44, v34 offset:768
    ds_read_b32 v45, v34 offset:832
    v_mfma_f32_16x16x32_bf16 v[148:151], v[68:71], v[52:55], v[148:151]
    ds_read_b32 v46, v34 offset:896
    ds_read_b128 v[60:63], v33 offset:320
    v_mfma_f32_16x16x32_bf16 v[132:135], v[72:75], v[48:51], v[132:135]
    ds_read_b128 v[64:67], v33 offset:384
    ds_read_b128 v[68:71], v33 offset:448
    v_mfma_f32_16x16x32_bf16 v[152:155], v[72:75], v[52:55], v[152:155]
    ds_read_b128 v[72:75], v33 offset:512
    v_mfma_f32_16x16x32_bf16 v[136:139], v[76:79], v[48:51], v[136:139]
    v_mfma_f32_16x16x32_bf16 v[156:159], v[76:79], v[52:55], v[156:159]
    ds_read_b128 v[76:79], v33 offset:576
    v_mfma_f32_16x16x32_bf16 v[160:163], v[80:83], v[48:51], v[160:163]
    v_mfma_f32_16x16x32_bf16 v[180:183], v[80:83], v[52:55], v[180:183]
    ds_read_b128 v[80:83], v33 offset:0
    v_mfma_f32_16x16x32_bf16 v[164:167], v[84:87], v[48:51], v[164:167]
    v_mfma_f32_16x16x32_bf16 v[184:187], v[84:87], v[52:55], v[184:187]
    ds_read_b128 v[84:87], v33 offset:64
    v_mfma_f32_16x16x32_bf16 v[168:171], v[88:91], v[48:51], v[168:171]
    v_mfma_f32_16x16x32_bf16 v[188:191], v[88:91], v[52:55], v[188:191]
    ds_read_b128 v[88:91], v33 offset:128
    v_mfma_f32_16x16x32_bf16 v[172:175], v[92:95], v[48:51], v[172:175]
    v_mfma_f32_16x16x32_bf16 v[192:195], v[92:95], v[52:55], v[192:195]
    v_mfma_f32_16x16x32_bf16 v[240:243], v[92:95], v[56:59], v[240:243]
    ds_read_b128 v[92:95], v33 offset:192
    s_waitcnt lgkmcnt(14)
    v_mfma_f32_16x16x32_bf16 v[176:179], v[96:99], v[48:51], v[176:179]
    v_mfma_f32_16x16x32_bf16 v[196:199], v[96:99], v[52:55], v[196:199]
    ds_read_b128 v[96:99], v33 offset:256
    v_mfma_f32_16x16x32_bf16 v[200:203], v[48:51], v[100:103], v[200:203]
    v_mfma_f32_16x16x32_bf16 v[204:207], v[52:55], v[100:103], v[204:207]
    ds_read_b128 v[100:103], v31 offset:0
    v_mfma_f32_16x16x32_bf16 v[208:211], v[48:51], v[104:107], v[208:211]
    v_mfma_f32_16x16x32_bf16 v[212:215], v[52:55], v[104:107], v[212:215]
    ds_read_b128 v[104:107], v31 offset:64
    v_mfma_f32_16x16x32_bf16 v[216:219], v[48:51], v[108:111], v[216:219]
    v_mfma_f32_16x16x32_bf16 v[220:223], v[52:55], v[108:111], v[220:223]
    v_mfma_f32_16x16x32_bf16 v[244:247], v[56:59], v[108:111], v[244:247]
    ds_read_b128 v[108:111], v31 offset:576
    v_mfma_f32_16x16x32_bf16 v[224:227], v[48:51], v[112:115], v[224:227]
    v_mfma_f32_16x16x32_bf16 v[228:231], v[52:55], v[112:115], v[228:231]
    ds_read_b128 v[112:115], v31 offset:640
    v_mfma_f32_16x16x32_bf16 v[232:235], v[48:51], v[116:119], v[232:235]
    v_mfma_f32_16x16x32_bf16 v[236:239], v[52:55], v[116:119], v[236:239]
    ds_read_b128 v[48:51], v32 offset:0
    ds_read_b128 v[52:55], v32 offset:576
L_e1_58:
    v_lshlrev_b32 v7, 3, v0
    v_add_u32 v6, 15360, v7
    v_add_u32 v7, v6, v7
    s_waitcnt lgkmcnt(6)
    v_pk_fma_f32 v[160:161], v[60:61], v[36:37], v[160:161] op_sel_hi:[1,0,1] neg_lo:[0,1,0] neg_hi:[0,1,0]
    v_pk_fma_f32 v[162:163], v[62:63], v[36:37], v[162:163] op_sel_hi:[1,0,1] neg_lo:[0,1,0] neg_hi:[0,1,0]
    v_pk_mul_f32 v[160:161], v[160:161], v[36:37] op_sel:[0,1] op_sel_hi:[1,1]
    v_pk_mul_f32 v[162:163], v[162:163], v[36:37] op_sel:[0,1] op_sel_hi:[1,1]
    v_cvt_pk_bf16_f32 v160, v160, v161
    v_cvt_pk_bf16_f32 v161, v162, v163
    v_pk_fma_f32 v[164:165], v[64:65], v[36:37], v[164:165] op_sel_hi:[1,0,1] neg_lo:[0,1,0] neg_hi:[0,1,0]
    v_pk_fma_f32 v[166:167], v[66:67], v[36:37], v[166:167] op_sel_hi:[1,0,1] neg_lo:[0,1,0] neg_hi:[0,1,0]
    v_pk_mul_f32 v[164:165], v[164:165], v[36:37] op_sel:[0,1] op_sel_hi:[1,1]
    v_pk_mul_f32 v[166:167], v[166:167], v[36:37] op_sel:[0,1] op_sel_hi:[1,1]
    v_cvt_pk_bf16_f32 v162, v164, v165
    v_cvt_pk_bf16_f32 v163, v166, v167
    v_pk_fma_f32 v[168:169], v[68:69], v[36:37], v[168:169] op_sel_hi:[1,0,1] neg_lo:[0,1,0] neg_hi:[0,1,0]
    v_pk_fma_f32 v[170:171], v[70:71], v[36:37], v[170:171] op_sel_hi:[1,0,1] neg_lo:[0,1,0] neg_hi:[0,1,0]
    v_pk_mul_f32 v[168:169], v[168:169], v[36:37] op_sel:[0,1] op_sel_hi:[1,1]
    v_pk_mul_f32 v[170:171], v[170:171], v[36:37] op_sel:[0,1] op_sel_hi:[1,1]
    v_cvt_pk_bf16_f32 v164, v168, v169
    v_cvt_pk_bf16_f32 v165, v170, v171
    v_pk_fma_f32 v[172:173], v[72:73], v[36:37], v[172:173] op_sel_hi:[1,0,1] neg_lo:[0,1,0] neg_hi:[0,1,0]
    v_pk_fma_f32 v[174:175], v[74:75], v[36:37], v[174:175] op_sel_hi:[1,0,1] neg_lo:[0,1,0] neg_hi:[0,1,0]
    v_pk_mul_f32 v[172:173], v[172:173], v[36:37] op_sel:[0,1] op_sel_hi:[1,1]
    v_pk_mul_f32 v[174:175], v[174:175], v[36:37] op_sel:[0,1] op_sel_hi:[1,1]
    v_cvt_pk_bf16_f32 v166, v172, v173
    v_cvt_pk_bf16_f32 v167, v174, v175
    v_pk_fma_f32 v[176:177], v[76:77], v[36:37], v[176:177] op_sel_hi:[1,0,1] neg_lo:[0,1,0] neg_hi:[0,1,0]
    v_pk_fma_f32 v[178:179], v[78:79], v[36:37], v[178:179] op_sel_hi:[1,0,1] neg_lo:[0,1,0] neg_hi:[0,1,0]
    v_pk_mul_f32 v[176:177], v[176:177], v[36:37] op_sel:[0,1] op_sel_hi:[1,1]
    v_pk_mul_f32 v[178:179], v[178:179], v[36:37] op_sel:[0,1] op_sel_hi:[1,1]
    v_cvt_pk_bf16_f32 v168, v176, v177
    v_cvt_pk_bf16_f32 v169, v178, v179
    v_pk_fma_f32 v[180:181], v[60:61], v[38:39], v[180:181] op_sel_hi:[1,0,1] neg_lo:[0,1,0] neg_hi:[0,1,0]
    v_pk_fma_f32 v[182:183], v[62:63], v[38:39], v[182:183] op_sel_hi:[1,0,1] neg_lo:[0,1,0] neg_hi:[0,1,0]
    v_pk_mul_f32 v[180:181], v[180:181], v[38:39] op_sel:[0,1] op_sel_hi:[1,1]
    v_pk_mul_f32 v[182:183], v[182:183], v[38:39] op_sel:[0,1] op_sel_hi:[1,1]
    v_cvt_pk_bf16_f32 v170, v180, v181
    v_cvt_pk_bf16_f32 v171, v182, v183
    v_pk_fma_f32 v[184:185], v[64:65], v[38:39], v[184:185] op_sel_hi:[1,0,1] neg_lo:[0,1,0] neg_hi:[0,1,0]
    v_pk_fma_f32 v[186:187], v[66:67], v[38:39], v[186:187] op_sel_hi:[1,0,1] neg_lo:[0,1,0] neg_hi:[0,1,0]
    v_pk_mul_f32 v[184:185], v[184:185], v[38:39] op_sel:[0,1] op_sel_hi:[1,1]
    v_pk_mul_f32 v[186:187], v[186:187], v[38:39] op_sel:[0,1] op_sel_hi:[1,1]
    v_cvt_pk_bf16_f32 v172, v184, v185
    v_cvt_pk_bf16_f32 v173, v186, v187
    v_pk_fma_f32 v[188:189], v[68:69], v[38:39], v[188:189] op_sel_hi:[1,0,1] neg_lo:[0,1,0] neg_hi:[0,1,0]
    v_pk_fma_f32 v[190:191], v[70:71], v[38:39], v[190:191] op_sel_hi:[1,0,1] neg_lo:[0,1,0] neg_hi:[0,1,0]
    v_pk_mul_f32 v[188:189], v[188:189], v[38:39] op_sel:[0,1] op_sel_hi:[1,1]
    v_pk_mul_f32 v[190:191], v[190:191], v[38:39] op_sel:[0,1] op_sel_hi:[1,1]
    v_cvt_pk_bf16_f32 v174, v188, v189
    v_cvt_pk_bf16_f32 v175, v190, v191
    v_pk_fma_f32 v[192:193], v[72:73], v[38:39], v[192:193] op_sel_hi:[1,0,1] neg_lo:[0,1,0] neg_hi:[0,1,0]
    v_pk_fma_f32 v[194:195], v[74:75], v[38:39], v[194:195] op_sel_hi:[1,0,1] neg_lo:[0,1,0] neg_hi:[0,1,0]
    v_pk_mul_f32 v[192:193], v[192:193], v[38:39] op_sel:[0,1] op_sel_hi:[1,1]
    v_pk_mul_f32 v[194:195], v[194:195], v[38:39] op_sel:[0,1] op_sel_hi:[1,1]
    v_cvt_pk_bf16_f32 v176, v192, v193
    v_cvt_pk_bf16_f32 v177, v194, v195
    v_pk_fma_f32 v[196:197], v[76:77], v[38:39], v[196:197] op_sel_hi:[1,0,1] neg_lo:[0,1,0] neg_hi:[0,1,0]
    v_pk_fma_f32 v[198:199], v[78:79], v[38:39], v[198:199] op_sel_hi:[1,0,1] neg_lo:[0,1,0] neg_hi:[0,1,0]
    v_pk_mul_f32 v[196:197], v[196:197], v[38:39] op_sel:[0,1] op_sel_hi:[1,1]
    v_pk_mul_f32 v[198:199], v[198:199], v[38:39] op_sel:[0,1] op_sel_hi:[1,1]
    v_cvt_pk_bf16_f32 v178, v196, v197
    v_cvt_pk_bf16_f32 v179, v198, v199
    s_waitcnt lgkmcnt(0)
    s_cmp_eq_u32 s53, 1
    s_cbranch_scc1 L_hw_68
    s_cmp_eq_u32 s53, 2
    s_cbranch_scc1 L_hw_69
    s_cmp_eq_u32 s53, 3
    s_cbranch_scc1 L_hw_70
L_hw_67:
    v_pk_fma_f32 v[240:241], v[60:61], v[40:41], v[240:241] op_sel_hi:[1,0,1] neg_lo:[0,1,0] neg_hi:[0,1,0]
    ds_write_b128 v26, v[170:173] offset:5120
    v_pk_fma_f32 v[242:243], v[62:63], v[40:41], v[242:243] op_sel_hi:[1,0,1] neg_lo:[0,1,0] neg_hi:[0,1,0]
    v_pk_mul_f32 v[240:241], v[240:241], v[40:41] op_sel:[0,1] op_sel_hi:[1,1]
    v_pk_mul_f32 v[242:243], v[242:243], v[40:41] op_sel:[0,1] op_sel_hi:[1,1]
    v_cvt_pk_bf16_f32 v240, v240, v241
    v_cvt_pk_bf16_f32 v241, v242, v243
    v_pk_fma_f32 v[244:245], v[76:77], v[40:41], v[244:245] op_sel_hi:[1,0,1] neg_lo:[0,1,0] neg_hi:[0,1,0]
    v_pk_fma_f32 v[246:247], v[78:79], v[40:41], v[246:247] op_sel_hi:[1,0,1] neg_lo:[0,1,0] neg_hi:[0,1,0]
    v_pk_mul_f32 v[244:245], v[244:245], v[40:41] op_sel:[0,1] op_sel_hi:[1,1]
    v_pk_mul_f32 v[246:247], v[246:247], v[40:41] op_sel:[0,1] op_sel_hi:[1,1]
    v_cvt_pk_bf16_f32 v244, v244, v245
    v_cvt_pk_bf16_f32 v245, v246, v247
    v_pk_fma_f32 v[248:249], v[48:49], v[44:45], v[248:249] op_sel:[0,1,0] op_sel_hi:[1,1,1] neg_lo:[0,1,0] neg_hi:[0,1,0]
    v_pk_fma_f32 v[250:251], v[50:51], v[44:45], v[250:251] op_sel:[0,1,0] op_sel_hi:[1,1,1] neg_lo:[0,1,0] neg_hi:[0,1,0]
    v_pk_mul_f32 v[248:249], v[248:249], v[52:53]
    v_pk_mul_f32 v[250:251], v[250:251], v[54:55]
    v_cvt_pk_bf16_f32 v248, v248, v249
    v_cvt_pk_bf16_f32 v249, v250, v251
    v_pk_fma_f32 v[204:205], v[104:105], v[42:43], v[204:205] op_sel:[0,0,0] op_sel_hi:[1,0,1] neg_lo:[0,1,0] neg_hi:[0,1,0]
    ds_write_b128 v26, v[174:177] offset:6144
    v_pk_fma_f32 v[206:207], v[106:107], v[42:43], v[206:207] op_sel:[0,0,0] op_sel_hi:[1,0,1] neg_lo:[0,1,0] neg_hi:[0,1,0]
    v_pk_mul_f32 v[204:205], v[204:205], v[112:113]
    v_pk_mul_f32 v[206:207], v[206:207], v[114:115]
    v_cvt_pk_bf16_f32 v207, v206, v207
    v_cvt_pk_bf16_f32 v206, v204, v205
    v_pk_fma_f32 v[212:213], v[104:105], v[42:43], v[212:213] op_sel:[0,1,0] op_sel_hi:[1,1,1] neg_lo:[0,1,0] neg_hi:[0,1,0]
    ds_write_b64 v35, v[178:179] offset:7168
    v_pk_fma_f32 v[214:215], v[106:107], v[42:43], v[214:215] op_sel:[0,1,0] op_sel_hi:[1,1,1] neg_lo:[0,1,0] neg_hi:[0,1,0]
    v_pk_mul_f32 v[212:213], v[212:213], v[112:113]
    v_pk_mul_f32 v[214:215], v[214:215], v[114:115]
    v_cvt_pk_bf16_f32 v215, v214, v215
    v_cvt_pk_bf16_f32 v214, v212, v213
    v_pk_fma_f32 v[220:221], v[104:105], v[44:45], v[220:221] op_sel:[0,0,0] op_sel_hi:[1,0,1] neg_lo:[0,1,0] neg_hi:[0,1,0]
    ds_write_b64 v7, v[240:241] offset:0
    v_pk_fma_f32 v[222:223], v[106:107], v[44:45], v[222:223] op_sel:[0,0,0] op_sel_hi:[1,0,1] neg_lo:[0,1,0] neg_hi:[0,1,0]
    v_pk_mul_f32 v[220:221], v[220:221], v[112:113]
    v_pk_mul_f32 v[222:223], v[222:223], v[114:115]
    v_cvt_pk_bf16_f32 v223, v222, v223
    v_cvt_pk_bf16_f32 v222, v220, v221
    v_pk_fma_f32 v[228:229], v[104:105], v[44:45], v[228:229] op_sel:[0,1,0] op_sel_hi:[1,1,1] neg_lo:[0,1,0] neg_hi:[0,1,0]
    ds_write_b64 v6, v[244:245] offset:2048
    v_pk_fma_f32 v[230:231], v[106:107], v[44:45], v[230:231] op_sel:[0,1,0] op_sel_hi:[1,1,1] neg_lo:[0,1,0] neg_hi:[0,1,0]
    v_pk_mul_f32 v[228:229], v[228:229], v[112:113]
    v_pk_mul_f32 v[230:231], v[230:231], v[114:115]
    v_cvt_pk_bf16_f32 v231, v230, v231
    v_cvt_pk_bf16_f32 v230, v228, v229
    v_pk_fma_f32 v[236:237], v[104:105], v[46:47], v[236:237] op_sel:[0,0,0] op_sel_hi:[1,0,1] neg_lo:[0,1,0] neg_hi:[0,1,0]
    ds_write_b64 v6, v[248:249] offset:4096
    v_pk_fma_f32 v[238:239], v[106:107], v[46:47], v[238:239] op_sel:[0,0,0] op_sel_hi:[1,0,1] neg_lo:[0,1,0] neg_hi:[0,1,0]
    v_pk_mul_f32 v[236:237], v[236:237], v[112:113]
    v_pk_mul_f32 v[238:239], v[238:239], v[114:115]
    v_cvt_pk_bf16_f32 v239, v238, v239
    v_cvt_pk_bf16_f32 v238, v236, v237
    s_branch L_hw_71
L_hw_68:
    v_pk_fma_f32 v[240:241], v[64:65], v[40:41], v[240:241] op_sel_hi:[1,0,1] neg_lo:[0,1,0] neg_hi:[0,1,0]
    ds_write_b128 v26, v[170:173] offset:5120
    v_pk_fma_f32 v[242:243], v[66:67], v[40:41], v[242:243] op_sel_hi:[1,0,1] neg_lo:[0,1,0] neg_hi:[0,1,0]
    v_pk_mul_f32 v[240:241], v[240:241], v[40:41] op_sel:[0,1] op_sel_hi:[1,1]
    v_pk_mul_f32 v[242:243], v[242:243], v[40:41] op_sel:[0,1] op_sel_hi:[1,1]
    v_cvt_pk_bf16_f32 v240, v240, v241
    v_cvt_pk_bf16_f32 v241, v242, v243
    v_pk_fma_f32 v[244:245], v[48:49], v[42:43], v[244:245] op_sel:[0,0,0] op_sel_hi:[1,0,1] neg_lo:[0,1,0] neg_hi:[0,1,0]
    v_pk_fma_f32 v[246:247], v[50:51], v[42:43], v[246:247] op_sel:[0,0,0] op_sel_hi:[1,0,1] neg_lo:[0,1,0] neg_hi:[0,1,0]
    v_pk_mul_f32 v[244:245], v[244:245], v[52:53]
    v_pk_mul_f32 v[246:247], v[246:247], v[54:55]
    v_cvt_pk_bf16_f32 v244, v244, v245
    v_cvt_pk_bf16_f32 v245, v246, v247
    v_pk_fma_f32 v[248:249], v[48:49], v[46:47], v[248:249] op_sel:[0,0,0] op_sel_hi:[1,0,1] neg_lo:[0,1,0] neg_hi:[0,1,0]
    v_pk_fma_f32 v[250:251], v[50:51], v[46:47], v[250:251] op_sel:[0,0,0] op_sel_hi:[1,0,1] neg_lo:[0,1,0] neg_hi:[0,1,0]
    v_pk_mul_f32 v[248:249], v[248:249], v[52:53]
    v_pk_mul_f32 v[250:251], v[250:251], v[54:55]
    v_cvt_pk_bf16_f32 v248, v248, v249
    v_cvt_pk_bf16_f32 v249, v250, v251
    v_pk_fma_f32 v[204:205], v[104:105], v[42:43], v[204:205] op_sel:[0,0,0] op_sel_hi:[1,0,1] neg_lo:[0,1,0] neg_hi:[0,1,0]
    ds_write_b128 v26, v[174:177] offset:6144
    v_pk_fma_f32 v[206:207], v[106:107], v[42:43], v[206:207] op_sel:[0,0,0] op_sel_hi:[1,0,1] neg_lo:[0,1,0] neg_hi:[0,1,0]
    v_pk_mul_f32 v[204:205], v[204:205], v[112:113]
    v_pk_mul_f32 v[206:207], v[206:207], v[114:115]
    v_cvt_pk_bf16_f32 v207, v206, v207
    v_cvt_pk_bf16_f32 v206, v204, v205
    v_pk_fma_f32 v[212:213], v[104:105], v[42:43], v[212:213] op_sel:[0,1,0] op_sel_hi:[1,1,1] neg_lo:[0,1,0] neg_hi:[0,1,0]
    ds_write_b64 v35, v[178:179] offset:7168
    v_pk_fma_f32 v[214:215], v[106:107], v[42:43], v[214:215] op_sel:[0,1,0] op_sel_hi:[1,1,1] neg_lo:[0,1,0] neg_hi:[0,1,0]
    v_pk_mul_f32 v[212:213], v[212:213], v[112:113]
    v_pk_mul_f32 v[214:215], v[214:215], v[114:115]
    v_cvt_pk_bf16_f32 v215, v214, v215
    v_cvt_pk_bf16_f32 v214, v212, v213
    v_pk_fma_f32 v[220:221], v[104:105], v[44:45], v[220:221] op_sel:[0,0,0] op_sel_hi:[1,0,1] neg_lo:[0,1,0] neg_hi:[0,1,0]
    ds_write_b64 v7, v[240:241] offset:8
    v_pk_fma_f32 v[222:223], v[106:107], v[44:45], v[222:223] op_sel:[0,0,0] op_sel_hi:[1,0,1] neg_lo:[0,1,0] neg_hi:[0,1,0]
    v_pk_mul_f32 v[220:221], v[220:221], v[112:113]
    v_pk_mul_f32 v[222:223], v[222:223], v[114:115]
    v_cvt_pk_bf16_f32 v223, v222, v223
    v_cvt_pk_bf16_f32 v222, v220, v221
    v_pk_fma_f32 v[228:229], v[104:105], v[44:45], v[228:229] op_sel:[0,1,0] op_sel_hi:[1,1,1] neg_lo:[0,1,0] neg_hi:[0,1,0]
    ds_write_b64 v6, v[244:245] offset:2560
    v_pk_fma_f32 v[230:231], v[106:107], v[44:45], v[230:231] op_sel:[0,1,0] op_sel_hi:[1,1,1] neg_lo:[0,1,0] neg_hi:[0,1,0]
    v_pk_mul_f32 v[228:229], v[228:229], v[112:113]
    v_pk_mul_f32 v[230:231], v[230:231], v[114:115]
    v_cvt_pk_bf16_f32 v231, v230, v231
    v_cvt_pk_bf16_f32 v230, v228, v229
    v_pk_fma_f32 v[236:237], v[104:105], v[46:47], v[236:237] op_sel:[0,0,0] op_sel_hi:[1,0,1] neg_lo:[0,1,0] neg_hi:[0,1,0]
    ds_write_b64 v6, v[248:249] offset:4608
    v_pk_fma_f32 v[238:239], v[106:107], v[46:47], v[238:239] op_sel:[0,0,0] op_sel_hi:[1,0,1] neg_lo:[0,1,0] neg_hi:[0,1,0]
    v_pk_mul_f32 v[236:237], v[236:237], v[112:113]
    v_pk_mul_f32 v[238:239], v[238:239], v[114:115]
    v_cvt_pk_bf16_f32 v239, v238, v239
    v_cvt_pk_bf16_f32 v238, v236, v237
    s_branch L_hw_71
L_hw_69:
    v_pk_fma_f32 v[240:241], v[68:69], v[40:41], v[240:241] op_sel_hi:[1,0,1] neg_lo:[0,1,0] neg_hi:[0,1,0]
    ds_write_b128 v26, v[170:173] offset:5120
    v_pk_fma_f32 v[242:243], v[70:71], v[40:41], v[242:243] op_sel_hi:[1,0,1] neg_lo:[0,1,0] neg_hi:[0,1,0]
    v_pk_mul_f32 v[240:241], v[240:241], v[40:41] op_sel:[0,1] op_sel_hi:[1,1]
    v_pk_mul_f32 v[242:243], v[242:243], v[40:41] op_sel:[0,1] op_sel_hi:[1,1]
    v_cvt_pk_bf16_f32 v240, v240, v241
    v_cvt_pk_bf16_f32 v241, v242, v243
    v_pk_fma_f32 v[244:245], v[48:49], v[42:43], v[244:245] op_sel:[0,1,0] op_sel_hi:[1,1,1] neg_lo:[0,1,0] neg_hi:[0,1,0]
    v_pk_fma_f32 v[246:247], v[50:51], v[42:43], v[246:247] op_sel:[0,1,0] op_sel_hi:[1,1,1] neg_lo:[0,1,0] neg_hi:[0,1,0]
    v_pk_mul_f32 v[244:245], v[244:245], v[52:53]
    v_pk_mul_f32 v[246:247], v[246:247], v[54:55]
    v_cvt_pk_bf16_f32 v244, v244, v245
    v_cvt_pk_bf16_f32 v245, v246, v247
    v_pk_fma_f32 v[204:205], v[104:105], v[42:43], v[204:205] op_sel:[0,0,0] op_sel_hi:[1,0,1] neg_lo:[0,1,0] neg_hi:[0,1,0]
    ds_write_b128 v26, v[174:177] offset:6144
    v_pk_fma_f32 v[206:207], v[106:107], v[42:43], v[206:207] op_sel:[0,0,0] op_sel_hi:[1,0,1] neg_lo:[0,1,0] neg_hi:[0,1,0]
    v_pk_mul_f32 v[204:205], v[204:205], v[112:113]
    v_pk_mul_f32 v[206:207], v[206:207], v[114:115]
    v_cvt_pk_bf16_f32 v207, v206, v207
    v_cvt_pk_bf16_f32 v206, v204, v205
    v_pk_fma_f32 v[212:213], v[104:105], v[42:43], v[212:213] op_sel:[0,1,0] op_sel_hi:[1,1,1] neg_lo:[0,1,0] neg_hi:[0,1,0]
    ds_write_b64 v35, v[178:179] offset:7168
    v_pk_fma_f32 v[214:215], v[106:107], v[42:43], v[214:215] op_sel:[0,1,0] op_sel_hi:[1,1,1] neg_lo:[0,1,0] neg_hi:[0,1,0]
    v_pk_mul_f32 v[212:213], v[212:213], v[112:113]
    v_pk_mul_f32 v[214:215], v[214:215], v[114:115]
    v_cvt_pk_bf16_f32 v215, v214, v215
    v_cvt_pk_bf16_f32 v214, v212, v213
    v_pk_fma_f32 v[220:221], v[104:105], v[44:45], v[220:221] op_sel:[0,0,0] op_sel_hi:[1,0,1] neg_lo:[0,1,0] neg_hi:[0,1,0]
    ds_write_b64 v7, v[240:241] offset:1024
    v_pk_fma_f32 v[222:223], v[106:107], v[44:45], v[222:223] op_sel:[0,0,0] op_sel_hi:[1,0,1] neg_lo:[0,1,0] neg_hi:[0,1,0]
    v_pk_mul_f32 v[220:221], v[220:221], v[112:113]
    v_pk_mul_f32 v[222:223], v[222:223], v[114:115]
    v_cvt_pk_bf16_f32 v223, v222, v223
    v_cvt_pk_bf16_f32 v222, v220, v221
    v_pk_fma_f32 v[228:229], v[104:105], v[44:45], v[228:229] op_sel:[0,1,0] op_sel_hi:[1,1,1] neg_lo:[0,1,0] neg_hi:[0,1,0]
    ds_write_b64 v6, v[244:245] offset:3072
    v_pk_fma_f32 v[230:231], v[106:107], v[44:45], v[230:231] op_sel:[0,1,0] op_sel_hi:[1,1,1] neg_lo:[0,1,0] neg_hi:[0,1,0]
    v_pk_mul_f32 v[228:229], v[228:229], v[112:113]
    v_pk_mul_f32 v[230:231], v[230:231], v[114:115]
    v_cvt_pk_bf16_f32 v231, v230, v231
    v_cvt_pk_bf16_f32 v230, v228, v229
    v_pk_fma_f32 v[236:237], v[104:105], v[46:47], v[236:237] op_sel:[0,0,0] op_sel_hi:[1,0,1] neg_lo:[0,1,0] neg_hi:[0,1,0]
    v_pk_fma_f32 v[238:239], v[106:107], v[46:47], v[238:239] op_sel:[0,0,0] op_sel_hi:[1,0,1] neg_lo:[0,1,0] neg_hi:[0,1,0]
    v_pk_mul_f32 v[236:237], v[236:237], v[112:113]
    v_pk_mul_f32 v[238:239], v[238:239], v[114:115]
    v_cvt_pk_bf16_f32 v239, v238, v239
    v_cvt_pk_bf16_f32 v238, v236, v237
    s_branch L_hw_71
L_hw_70:
    v_pk_fma_f32 v[240:241], v[72:73], v[40:41], v[240:241] op_sel_hi:[1,0,1] neg_lo:[0,1,0] neg_hi:[0,1,0]
    v_pk_fma_f32 v[242:243], v[74:75], v[40:41], v[242:243] op_sel_hi:[1,0,1] neg_lo:[0,1,0] neg_hi:[0,1,0]
    v_pk_mul_f32 v[240:241], v[240:241], v[40:41] op_sel:[0,1] op_sel_hi:[1,1]
    v_pk_mul_f32 v[242:243], v[242:243], v[40:41] op_sel:[0,1] op_sel_hi:[1,1]
    v_cvt_pk_bf16_f32 v240, v240, v241
    v_cvt_pk_bf16_f32 v241, v242, v243
    v_pk_fma_f32 v[244:245], v[48:49], v[44:45], v[244:245] op_sel:[0,0,0] op_sel_hi:[1,0,1] neg_lo:[0,1,0] neg_hi:[0,1,0]
    v_pk_fma_f32 v[246:247], v[50:51], v[44:45], v[246:247] op_sel:[0,0,0] op_sel_hi:[1,0,1] neg_lo:[0,1,0] neg_hi:[0,1,0]
    v_pk_mul_f32 v[244:245], v[244:245], v[52:53]
    v_pk_mul_f32 v[246:247], v[246:247], v[54:55]
    v_cvt_pk_bf16_f32 v244, v244, v245
    v_cvt_pk_bf16_f32 v245, v246, v247
    v_pk_fma_f32 v[204:205], v[104:105], v[42:43], v[204:205] op_sel:[0,0,0] op_sel_hi:[1,0,1] neg_lo:[0,1,0] neg_hi:[0,1,0]
    ds_write_b64 v7, v[240:241] offset:1032
    v_pk_fma_f32 v[206:207], v[106:107], v[42:43], v[206:207] op_sel:[0,0,0] op_sel_hi:[1,0,1] neg_lo:[0,1,0] neg_hi:[0,1,0]
    v_pk_mul_f32 v[204:205], v[204:205], v[112:113]
    v_pk_mul_f32 v[206:207], v[206:207], v[114:115]
    v_cvt_pk_bf16_f32 v207, v206, v207
    v_cvt_pk_bf16_f32 v206, v204, v205
    v_pk_fma_f32 v[212:213], v[104:105], v[42:43], v[212:213] op_sel:[0,1,0] op_sel_hi:[1,1,1] neg_lo:[0,1,0] neg_hi:[0,1,0]
    ds_write_b64 v6, v[244:245] offset:3584
    v_pk_fma_f32 v[214:215], v[106:107], v[42:43], v[214:215] op_sel:[0,1,0] op_sel_hi:[1,1,1] neg_lo:[0,1,0] neg_hi:[0,1,0]
    v_pk_mul_f32 v[212:213], v[212:213], v[112:113]
    v_pk_mul_f32 v[214:215], v[214:215], v[114:115]
    v_cvt_pk_bf16_f32 v215, v214, v215
    v_cvt_pk_bf16_f32 v214, v212, v213
    v_pk_fma_f32 v[220:221], v[104:105], v[44:45], v[220:221] op_sel:[0,0,0] op_sel_hi:[1,0,1] neg_lo:[0,1,0] neg_hi:[0,1,0]
    v_pk_fma_f32 v[222:223], v[106:107], v[44:45], v[222:223] op_sel:[0,0,0] op_sel_hi:[1,0,1] neg_lo:[0,1,0] neg_hi:[0,1,0]
    v_pk_mul_f32 v[220:221], v[220:221], v[112:113]
    v_pk_mul_f32 v[222:223], v[222:223], v[114:115]
    v_cvt_pk_bf16_f32 v223, v222, v223
    v_cvt_pk_bf16_f32 v222, v220, v221
    v_pk_fma_f32 v[228:229], v[104:105], v[44:45], v[228:229] op_sel:[0,1,0] op_sel_hi:[1,1,1] neg_lo:[0,1,0] neg_hi:[0,1,0]
    v_pk_fma_f32 v[230:231], v[106:107], v[44:45], v[230:231] op_sel:[0,1,0] op_sel_hi:[1,1,1] neg_lo:[0,1,0] neg_hi:[0,1,0]
    v_pk_mul_f32 v[228:229], v[228:229], v[112:113]
    v_pk_mul_f32 v[230:231], v[230:231], v[114:115]
    v_cvt_pk_bf16_f32 v231, v230, v231
    v_cvt_pk_bf16_f32 v230, v228, v229
    v_pk_fma_f32 v[236:237], v[104:105], v[46:47], v[236:237] op_sel:[0,0,0] op_sel_hi:[1,0,1] neg_lo:[0,1,0] neg_hi:[0,1,0]
    v_pk_fma_f32 v[238:239], v[106:107], v[46:47], v[238:239] op_sel:[0,0,0] op_sel_hi:[1,0,1] neg_lo:[0,1,0] neg_hi:[0,1,0]
    v_pk_mul_f32 v[236:237], v[236:237], v[112:113]
    v_pk_mul_f32 v[238:239], v[238:239], v[114:115]
    v_cvt_pk_bf16_f32 v239, v238, v239
    v_cvt_pk_bf16_f32 v238, v236, v237
L_hw_71:
    v_pk_fma_f32 v[200:201], v[100:101], v[42:43], v[200:201] op_sel:[0,0,0] op_sel_hi:[1,0,1] neg_lo:[0,1,0] neg_hi:[0,1,0]
    ds_write_b64 v35, v[206:207] offset:7680
    v_pk_fma_f32 v[202:203], v[102:103], v[42:43], v[202:203] op_sel:[0,0,0] op_sel_hi:[1,0,1] neg_lo:[0,1,0] neg_hi:[0,1,0]
    v_pk_mul_f32 v[200:201], v[200:201], v[108:109]
    v_pk_mul_f32 v[202:203], v[202:203], v[110:111]
    v_cvt_pk_bf16_f32 v204, v200, v201
    v_cvt_pk_bf16_f32 v205, v202, v203
    v_pk_fma_f32 v[208:209], v[100:101], v[42:43], v[208:209] op_sel:[0,1,0] op_sel_hi:[1,1,1] neg_lo:[0,1,0] neg_hi:[0,1,0]
    ds_write_b64 v35, v[214:215] offset:8192
    v_pk_fma_f32 v[210:211], v[102:103], v[42:43], v[210:211] op_sel:[0,1,0] op_sel_hi:[1,1,1] neg_lo:[0,1,0] neg_hi:[0,1,0]
    v_pk_mul_f32 v[208:209], v[208:209], v[108:109]
    v_pk_mul_f32 v[210:211], v[210:211], v[110:111]
    v_cvt_pk_bf16_f32 v212, v208, v209
    v_cvt_pk_bf16_f32 v213, v210, v211
    v_pk_fma_f32 v[216:217], v[100:101], v[44:45], v[216:217] op_sel:[0,0,0] op_sel_hi:[1,0,1] neg_lo:[0,1,0] neg_hi:[0,1,0]
    ds_write_b64 v35, v[222:223] offset:8704
    v_pk_fma_f32 v[218:219], v[102:103], v[44:45], v[218:219] op_sel:[0,0,0] op_sel_hi:[1,0,1] neg_lo:[0,1,0] neg_hi:[0,1,0]
    v_pk_mul_f32 v[216:217], v[216:217], v[108:109]
    v_pk_mul_f32 v[218:219], v[218:219], v[110:111]
    v_cvt_pk_bf16_f32 v220, v216, v217
    v_cvt_pk_bf16_f32 v221, v218, v219
    v_pk_fma_f32 v[224:225], v[100:101], v[44:45], v[224:225] op_sel:[0,1,0] op_sel_hi:[1,1,1] neg_lo:[0,1,0] neg_hi:[0,1,0]
    ds_write_b64 v35, v[230:231] offset:9216
    v_pk_fma_f32 v[226:227], v[102:103], v[44:45], v[226:227] op_sel:[0,1,0] op_sel_hi:[1,1,1] neg_lo:[0,1,0] neg_hi:[0,1,0]
    v_pk_mul_f32 v[224:225], v[224:225], v[108:109]
    v_pk_mul_f32 v[226:227], v[226:227], v[110:111]
    v_cvt_pk_bf16_f32 v228, v224, v225
    v_cvt_pk_bf16_f32 v229, v226, v227
    v_pk_fma_f32 v[232:233], v[100:101], v[46:47], v[232:233] op_sel:[0,0,0] op_sel_hi:[1,0,1] neg_lo:[0,1,0] neg_hi:[0,1,0]
    ds_write_b64 v35, v[238:239] offset:9728
    v_pk_fma_f32 v[234:235], v[102:103], v[46:47], v[234:235] op_sel:[0,0,0] op_sel_hi:[1,0,1] neg_lo:[0,1,0] neg_hi:[0,1,0]
    v_pk_mul_f32 v[232:233], v[232:233], v[108:109]
    v_pk_mul_f32 v[234:235], v[234:235], v[110:111]
    v_cvt_pk_bf16_f32 v236, v232, v233
    v_cvt_pk_bf16_f32 v237, v234, v235
    s_mov_b32 s60, 0x3ea52b5c
    v_mul_f32 v37, s60, v37
    v_mul_f32 v39, s60, v39
    v_mov_b32 v1, 163088
    v_mov_b32 v2, 1
    v_mov_b32 v3, 4
    s_lshl_b32 s60, s53, 2
    v_add_u32 v4, s60, v1
    v_pk_fma_f32 v[140:141], v[80:81], v[38:39], v[140:141] op_sel_hi:[1,0,1] neg_lo:[0,1,0] neg_hi:[0,1,0]
    v_pk_fma_f32 v[142:143], v[82:83], v[38:39], v[142:143] op_sel_hi:[1,0,1] neg_lo:[0,1,0] neg_hi:[0,1,0]
    v_cvt_pk_bf16_f32 v58, v140, v141
    v_cvt_pk_bf16_f32 v59, v142, v143
    v_pk_fma_f32 v[144:145], v[84:85], v[38:39], v[144:145] op_sel_hi:[1,0,1] neg_lo:[0,1,0] neg_hi:[0,1,0]
    v_pk_fma_f32 v[146:147], v[86:87], v[38:39], v[146:147] op_sel_hi:[1,0,1] neg_lo:[0,1,0] neg_hi:[0,1,0]
    v_cvt_pk_bf16_f32 v144, v144, v145
    v_cvt_pk_bf16_f32 v145, v146, v147
    v_cndmask_b32 v62, 0, v144, s[70:71]
    v_cndmask_b32 v60, v144, 0, s[70:71]
    v_cndmask_b32 v63, 0, v145, s[70:71]
    v_cndmask_b32 v61, v145, 0, s[70:71]
    v_pk_fma_f32 v[148:149], v[88:89], v[38:39], v[148:149] op_sel_hi:[1,0,1] neg_lo:[0,1,0] neg_hi:[0,1,0]
    v_pk_fma_f32 v[150:151], v[90:91], v[38:39], v[150:151] op_sel_hi:[1,0,1] neg_lo:[0,1,0] neg_hi:[0,1,0]
    v_cvt_pk_bf16_f32 v148, v148, v149
    v_cvt_pk_bf16_f32 v149, v150, v151
    s_waitcnt lgkmcnt(0)
    s_mov_b64 exec, 1
    ds_add_u32 v1, v2
    ds_write_b32 v4, v3 offset:4
    s_mov_b64 exec, -1
    v_cndmask_b32 v66, 0, v148, s[72:73]
    v_cndmask_b32 v64, v148, 0, s[72:73]
    v_cndmask_b32 v67, 0, v149, s[72:73]
    v_cndmask_b32 v65, v149, 0, s[72:73]
    v_pk_fma_f32 v[152:153], v[92:93], v[38:39], v[152:153] op_sel_hi:[1,0,1] neg_lo:[0,1,0] neg_hi:[0,1,0]
    v_pk_fma_f32 v[154:155], v[94:95], v[38:39], v[154:155] op_sel_hi:[1,0,1] neg_lo:[0,1,0] neg_hi:[0,1,0]
    v_cvt_pk_bf16_f32 v152, v152, v153
    v_cvt_pk_bf16_f32 v153, v154, v155
    v_cndmask_b32 v70, 0, v152, s[74:75]
    v_cndmask_b32 v68, v152, 0, s[74:75]
    v_cndmask_b32 v71, 0, v153, s[74:75]
    v_cndmask_b32 v69, v153, 0, s[74:75]
    v_pk_fma_f32 v[156:157], v[96:97], v[38:39], v[156:157] op_sel_hi:[1,0,1] neg_lo:[0,1,0] neg_hi:[0,1,0]
    v_pk_fma_f32 v[158:159], v[98:99], v[38:39], v[158:159] op_sel_hi:[1,0,1] neg_lo:[0,1,0] neg_hi:[0,1,0]
    v_cvt_pk_bf16_f32 v72, v156, v157
    v_cvt_pk_bf16_f32 v73, v158, v159
    ds_read_b32 v5, v4
    v_pk_fma_f32 v[120:121], v[80:81], v[36:37], v[120:121] op_sel_hi:[1,0,1] neg_lo:[0,1,0] neg_hi:[0,1,0]
    v_mfma_f32_16x16x32_bf16 v[144:147], v[170:173], v[58:61], v[8:11]
    v_pk_fma_f32 v[122:123], v[82:83], v[36:37], v[122:123] op_sel_hi:[1,0,1] neg_lo:[0,1,0] neg_hi:[0,1,0]
    v_cvt_pk_bf16_f32 v42, v120, v121
    v_cvt_pk_bf16_f32 v43, v122, v123
    v_mfma_f32_16x16x32_bf16 v[152:155], v[172:175], v[62:65], v[8:11]
    v_pk_fma_f32 v[124:125], v[84:85], v[36:37], v[124:125] op_sel_hi:[1,0,1] neg_lo:[0,1,0] neg_hi:[0,1,0]
    v_pk_fma_f32 v[126:127], v[86:87], v[36:37], v[126:127] op_sel_hi:[1,0,1] neg_lo:[0,1,0] neg_hi:[0,1,0]
    v_cvt_pk_bf16_f32 v124, v124, v125
    v_mfma_f32_16x16x32_bf16 v[244:247], v[174:177], v[66:69], v[8:11]
    v_cvt_pk_bf16_f32 v125, v126, v127
    v_cndmask_b32 v46, 0, v124, s[70:71]
    v_cndmask_b32 v44, v124, 0, s[70:71]
    v_mfma_f32_16x16x32_bf16 v[252:255], v[176:179], v[70:73], v[8:11]
    v_cndmask_b32 v47, 0, v125, s[70:71]
    v_cndmask_b32 v45, v125, 0, s[70:71]
    v_pk_fma_f32 v[128:129], v[88:89], v[36:37], v[128:129] op_sel_hi:[1,0,1] neg_lo:[0,1,0] neg_hi:[0,1,0]
    v_mfma_f32_16x16x32_bf16 v[140:143], v[160:163], v[58:61], v[16:19]
    v_pk_fma_f32 v[130:131], v[90:91], v[36:37], v[130:131] op_sel_hi:[1,0,1] neg_lo:[0,1,0] neg_hi:[0,1,0]
    v_cvt_pk_bf16_f32 v128, v128, v129
    v_cvt_pk_bf16_f32 v129, v130, v131
    v_mfma_f32_16x16x32_bf16 v[148:151], v[162:165], v[62:65], v[16:19]
    v_cndmask_b32 v50, 0, v128, s[72:73]
    v_cndmask_b32 v48, v128, 0, s[72:73]
    v_cndmask_b32 v51, 0, v129, s[72:73]
    v_mfma_f32_16x16x32_bf16 v[240:243], v[164:167], v[66:69], v[16:19]
    v_cndmask_b32 v49, v129, 0, s[72:73]
    v_pk_fma_f32 v[132:133], v[92:93], v[36:37], v[132:133] op_sel_hi:[1,0,1] neg_lo:[0,1,0] neg_hi:[0,1,0]
    v_pk_fma_f32 v[134:135], v[94:95], v[36:37], v[134:135] op_sel_hi:[1,0,1] neg_lo:[0,1,0] neg_hi:[0,1,0]
    v_mfma_f32_16x16x32_bf16 v[248:251], v[166:169], v[70:73], v[16:19]
    v_cvt_pk_bf16_f32 v132, v132, v133
    v_cvt_pk_bf16_f32 v133, v134, v135
    v_cndmask_b32 v54, 0, v132, s[74:75]
    v_cndmask_b32 v52, v132, 0, s[74:75]
    v_cndmask_b32 v55, 0, v133, s[74:75]
    v_cndmask_b32 v53, v133, 0, s[74:75]
    v_pk_fma_f32 v[136:137], v[96:97], v[36:37], v[136:137] op_sel_hi:[1,0,1] neg_lo:[0,1,0] neg_hi:[0,1,0]
    v_pk_fma_f32 v[138:139], v[98:99], v[36:37], v[138:139] op_sel_hi:[1,0,1] neg_lo:[0,1,0] neg_hi:[0,1,0]
    v_cvt_pk_bf16_f32 v56, v136, v137
    v_cvt_pk_bf16_f32 v57, v138, v139
    s_waitcnt lgkmcnt(0)
    v_cmp_gt_u32 vcc, 4, v5
    s_nop 4
    s_cbranch_vccz L_xd_73
    s_mov_b32 s61, 20000
L_xs_72:
    ds_read_b32 v5, v4
    s_waitcnt lgkmcnt(0)
    v_cmp_gt_u32 vcc, 4, v5
    s_nop 4
    s_cbranch_vccz L_xd_73
    s_sub_u32 s61, s61, 1
    s_cbranch_scc0 L_xs_72
L_xd_73:
    ds_read_b128 v[180:183], v26
    ds_read_b128 v[184:187], v26 offset:1024
    ds_read_b64 v[188:189], v35 offset:2048
    ds_read_b64 v[202:203], v35 offset:2560
    ds_read_b64 v[210:211], v35 offset:3072
    ds_read_b64 v[218:219], v35 offset:3584
    ds_read_b64 v[226:227], v35 offset:4096
    ds_read_b64 v[234:235], v35 offset:4608
    v_mov_b32 v116, v28
    v_mov_b32 v117, v28
    v_mov_b32 v118, v28
    v_mov_b32 v119, v28
    v_max_f32 v144, v140, v144
    v_max_f32 v145, v141, v145
    v_max_f32 v146, v142, v146
    v_max_f32 v147, v143, v147
    v_max3_f32 v110, v144, v145, v146
    v_max_f32 v110, v110, v147
    v_max_f32 v152, v148, v152
    v_max_f32 v153, v149, v153
    v_max_f32 v154, v150, v154
    v_max_f32 v155, v151, v155
    v_max3_f32 v111, v152, v153, v154
    v_max_f32 v111, v111, v155
    v_max_f32 v244, v240, v244
    v_max_f32 v245, v241, v245
    v_max_f32 v246, v242, v246
    v_max_f32 v247, v243, v247
    v_max3_f32 v112, v244, v245, v246
    v_max_f32 v112, v112, v247
    v_max_f32 v252, v248, v252
    v_max_f32 v253, v249, v253
    v_max_f32 v254, v250, v254
    v_max_f32 v255, v251, v255
    v_max3_f32 v113, v252, v253, v254
    v_max_f32 v113, v113, v255
    v_permlane32_swap_b32 v110, v111
    s_nop 0
    v_permlane32_swap_b32 v112, v113
    v_max_f32 v110, v110, v111
    v_max_f32 v112, v112, v113
    s_nop 1
    v_permlane16_swap_b32 v110, v112
    v_max_f32 v110, v110, v112
    v_mul_f32 v110, v110, v39
    v_mov_b32 v112, v110
    s_nop 1
    v_permlane16_swap_b32 v110, v112
    v_mov_b32 v111, v110
    v_mov_b32 v113, v112
    s_nop 0
    v_permlane32_swap_b32 v110, v111
    v_permlane32_swap_b32 v112, v113
    s_waitcnt lgkmcnt(0)
    v_pk_fma_f32 v[144:145], v[144:145], v[38:39], v[110:111] op_sel:[0,1,0] op_sel_hi:[1,1,0] neg_lo:[0,0,1] neg_hi:[0,0,1]
    v_mfma_f32_16x16x32_bf16 v[78:81], v[160:163], v[42:45], v[8:11]
    v_pk_fma_f32 v[146:147], v[146:147], v[38:39], v[110:111] op_sel:[0,1,0] op_sel_hi:[1,1,0] neg_lo:[0,0,1] neg_hi:[0,0,1]
    v_exp_f32 v144, v144
    v_exp_f32 v145, v145
    v_mfma_f32_16x16x32_bf16 v[86:89], v[162:165], v[46:49], v[8:11]
    v_exp_f32 v146, v146
    v_exp_f32 v147, v147
    v_pk_fma_f32 v[152:153], v[152:153], v[38:39], v[110:111] op_sel:[0,1,1] op_sel_hi:[1,1,1] neg_lo:[0,0,1] neg_hi:[0,0,1]
    v_mfma_f32_16x16x32_bf16 v[94:97], v[164:167], v[50:53], v[8:11]
    v_pk_fma_f32 v[154:155], v[154:155], v[38:39], v[110:111] op_sel:[0,1,1] op_sel_hi:[1,1,1] neg_lo:[0,0,1] neg_hi:[0,0,1]
    v_exp_f32 v152, v152
    v_exp_f32 v153, v153
    v_mfma_f32_16x16x32_bf16 v[102:105], v[166:169], v[54:57], v[8:11]
    v_exp_f32 v154, v154
    v_exp_f32 v155, v155
    v_pk_fma_f32 v[244:245], v[244:245], v[38:39], v[112:113] op_sel:[0,1,0] op_sel_hi:[1,1,0] neg_lo:[0,0,1] neg_hi:[0,0,1]
    v_mfma_f32_16x16x32_bf16 v[74:77], v[180:183], v[42:45], v[12:15]
    v_pk_fma_f32 v[246:247], v[246:247], v[38:39], v[112:113] op_sel:[0,1,0] op_sel_hi:[1,1,0] neg_lo:[0,0,1] neg_hi:[0,0,1]
    v_exp_f32 v244, v244
    v_exp_f32 v245, v245
    v_mfma_f32_16x16x32_bf16 v[82:85], v[182:185], v[46:49], v[12:15]
    v_exp_f32 v246, v246
    v_exp_f32 v247, v247
    v_pk_fma_f32 v[252:253], v[252:253], v[38:39], v[112:113] op_sel:[0,1,1] op_sel_hi:[1,1,1] neg_lo:[0,0,1] neg_hi:[0,0,1]
    v_mfma_f32_16x16x32_bf16 v[90:93], v[184:187], v[50:53], v[12:15]
    v_pk_fma_f32 v[254:255], v[254:255], v[38:39], v[112:113] op_sel:[0,1,1] op_sel_hi:[1,1,1] neg_lo:[0,0,1] neg_hi:[0,0,1]
    v_exp_f32 v252, v252
    v_exp_f32 v253, v253
    v_mfma_f32_16x16x32_bf16 v[98:101], v[186:189], v[54:57], v[12:15]
    v_exp_f32 v254, v254
    v_exp_f32 v255, v255
    v_cvt_pk_bf16_f32 v144, v144, v145
    v_cvt_pk_bf16_f32 v145, v146, v147
    v_and_b32 v140, v24, v144
    v_and_b32 v141, v25, v145
    v_and_b32 v142, v20, v144
    v_and_b32 v143, v21, v145
    v_cvt_pk_bf16_f32 v152, v152, v153
    v_cvt_pk_bf16_f32 v153, v154, v155
    v_and_b32 v148, v24, v152
    v_and_b32 v149, v25, v153
    v_and_b32 v150, v20, v152
    v_and_b32 v151, v21, v153
    v_cvt_pk_bf16_f32 v244, v244, v245
    v_cvt_pk_bf16_f32 v245, v246, v247
    v_and_b32 v240, v24, v244
    v_and_b32 v241, v25, v245
    v_and_b32 v242, v20, v244
    v_and_b32 v243, v21, v245
    v_cvt_pk_bf16_f32 v252, v252, v253
    v_cvt_pk_bf16_f32 v253, v254, v255
    v_and_b32 v248, v24, v252
    v_and_b32 v249, v25, v253
    v_and_b32 v250, v20, v252
    v_and_b32 v251, v21, v253
    v_max_f32 v78, v74, v78
    v_max_f32 v79, v75, v79
    v_mfma_f32_16x16x32_bf16 v[144:147], v[116:119], v[140:143], 0
    v_max_f32 v80, v76, v80
    v_max_f32 v81, v77, v81
    v_max3_f32 v106, v78, v79, v80
    v_mfma_f32_16x16x32_bf16 v[152:155], v[116:119], v[148:151], 0
    v_max_f32 v106, v106, v81
    v_max_f32 v86, v82, v86
    v_max_f32 v87, v83, v87
    v_mfma_f32_16x16x32_bf16 v[244:247], v[116:119], v[240:243], 0
    v_max_f32 v88, v84, v88
    v_max_f32 v89, v85, v89
    v_max3_f32 v107, v86, v87, v88
    v_mfma_f32_16x16x32_bf16 v[252:255], v[116:119], v[248:251], 0
    v_max_f32 v107, v107, v89
    v_max_f32 v94, v90, v94
    v_max_f32 v95, v91, v95
    v_mfma_f32_16x16x32_bf16 v[42:45], v[204:207], v[140:143], 0
    v_max_f32 v96, v92, v96
    v_max_f32 v97, v93, v97
    v_max3_f32 v108, v94, v95, v96
    v_mfma_f32_16x16x32_bf16 v[46:49], v[212:215], v[140:143], 0
    v_max_f32 v108, v108, v97
    v_max_f32 v102, v98, v102
    v_max_f32 v103, v99, v103
    v_mfma_f32_16x16x32_bf16 v[50:53], v[212:215], v[148:151], 0
    v_max_f32 v104, v100, v104
    v_max_f32 v105, v101, v105
    v_max3_f32 v109, v102, v103, v104
    v_mfma_f32_16x16x32_bf16 v[54:57], v[220:223], v[148:151], 0
    v_max_f32 v109, v109, v105
    v_permlane32_swap_b32 v106, v107
    s_nop 0
    v_permlane32_swap_b32 v108, v109
    v_mfma_f32_16x16x32_bf16 v[58:61], v[220:223], v[240:243], 0
    v_max_f32 v106, v106, v107
    v_max_f32 v108, v108, v109
    s_nop 1
    v_permlane16_swap_b32 v106, v108
    v_mfma_f32_16x16x32_bf16 v[62:65], v[228:231], v[240:243], 0
    v_max_f32 v106, v106, v108
    v_mul_f32 v106, v106, v37
    v_mov_b32 v108, v106
    v_mfma_f32_16x16x32_bf16 v[66:69], v[228:231], v[248:251], 0
    s_nop 0
    v_permlane16_swap_b32 v106, v108
    v_mov_b32 v107, v106
    v_mov_b32 v109, v108
    v_mfma_f32_16x16x32_bf16 v[70:73], v[236:239], v[248:251], 0
    v_permlane32_swap_b32 v106, v107
    v_permlane32_swap_b32 v108, v109
    v_pk_fma_f32 v[78:79], v[78:79], v[36:37], v[106:107] op_sel:[0,1,0] op_sel_hi:[1,1,0] neg_lo:[0,0,1] neg_hi:[0,0,1]
    v_pk_fma_f32 v[80:81], v[80:81], v[36:37], v[106:107] op_sel:[0,1,0] op_sel_hi:[1,1,0] neg_lo:[0,0,1] neg_hi:[0,0,1]
    v_exp_f32 v78, v78
    v_exp_f32 v79, v79
    v_exp_f32 v80, v80
    v_exp_f32 v81, v81
    v_pk_fma_f32 v[86:87], v[86:87], v[36:37], v[106:107] op_sel:[0,1,1] op_sel_hi:[1,1,1] neg_lo:[0,0,1] neg_hi:[0,0,1]
    v_pk_fma_f32 v[88:89], v[88:89], v[36:37], v[106:107] op_sel:[0,1,1] op_sel_hi:[1,1,1] neg_lo:[0,0,1] neg_hi:[0,0,1]
    v_exp_f32 v86, v86
    v_exp_f32 v87, v87
    v_exp_f32 v88, v88
    v_exp_f32 v89, v89
    v_pk_fma_f32 v[94:95], v[94:95], v[36:37], v[108:109] op_sel:[0,1,0] op_sel_hi:[1,1,0] neg_lo:[0,0,1] neg_hi:[0,0,1]
    v_pk_fma_f32 v[96:97], v[96:97], v[36:37], v[108:109] op_sel:[0,1,0] op_sel_hi:[1,1,0] neg_lo:[0,0,1] neg_hi:[0,0,1]
    v_exp_f32 v94, v94
    v_exp_f32 v95, v95
    v_exp_f32 v96, v96
    v_exp_f32 v97, v97
    v_pk_fma_f32 v[102:103], v[102:103], v[36:37], v[108:109] op_sel:[0,1,1] op_sel_hi:[1,1,1] neg_lo:[0,0,1] neg_hi:[0,0,1]
    v_pk_fma_f32 v[104:105], v[104:105], v[36:37], v[108:109] op_sel:[0,1,1] op_sel_hi:[1,1,1] neg_lo:[0,0,1] neg_hi:[0,0,1]
    v_exp_f32 v102, v102
    v_exp_f32 v103, v103
    v_exp_f32 v104, v104
    v_exp_f32 v105, v105
    v_cvt_pk_bf16_f32 v78, v78, v79
    v_cvt_pk_bf16_f32 v79, v80, v81
    v_and_b32 v74, v22, v78
    v_and_b32 v75, v23, v79
    v_and_b32 v76, v20, v78
    v_and_b32 v77, v21, v79
    v_cvt_pk_bf16_f32 v86, v86, v87
    v_cvt_pk_bf16_f32 v87, v88, v89
    v_and_b32 v82, v22, v86
    v_and_b32 v83, v23, v87
    v_and_b32 v84, v20, v86
    v_and_b32 v85, v21, v87
    v_cvt_pk_bf16_f32 v94, v94, v95
    v_cvt_pk_bf16_f32 v95, v96, v97
    v_and_b32 v90, v22, v94
    v_and_b32 v91, v23, v95
    v_and_b32 v92, v20, v94
    v_and_b32 v93, v21, v95
    v_cvt_pk_bf16_f32 v102, v102, v103
    v_cvt_pk_bf16_f32 v103, v104, v105
    v_and_b32 v98, v22, v102
    v_and_b32 v99, v23, v103
    v_and_b32 v100, v20, v102
    v_and_b32 v101, v21, v103
    v_rcp_f32 v110, v144
    v_rcp_f32 v111, v152
    v_mfma_f32_16x16x32_bf16 v[78:81], v[116:119], v[74:77], 0
    v_rcp_f32 v112, v244
    v_rcp_f32 v113, v252
    v_pk_mul_f32 v[42:43], v[42:43], v[110:111] op_sel:[0,0] op_sel_hi:[1,0]
    v_mfma_f32_16x16x32_bf16 v[86:89], v[116:119], v[82:85], 0
    v_pk_mul_f32 v[44:45], v[44:45], v[110:111] op_sel:[0,0] op_sel_hi:[1,0]
    v_cvt_pk_bf16_f32 v42, v42, v43
    v_cvt_pk_bf16_f32 v43, v44, v45
    v_mfma_f32_16x16x32_bf16 v[94:97], v[116:119], v[90:93], 0
    buffer_store_dwordx2 v[42:43], v27, s[36:39], s8 offen offset:2048 sc0 sc1
    v_cndmask_b32 v46, v46, v50, s[70:71]
    v_cndmask_b32 v47, v47, v51, s[70:71]
    v_mfma_f32_16x16x32_bf16 v[102:105], v[116:119], v[98:101], 0
    v_cndmask_b32 v48, v48, v52, s[70:71]
    v_cndmask_b32 v49, v49, v53, s[70:71]
    v_cndmask_b32 v50, v110, v111, s[70:71]
    v_mfma_f32_16x16x32_bf16 v[160:163], v[202:205], v[74:77], 0
    v_pk_mul_f32 v[46:47], v[46:47], v[50:51] op_sel:[0,0] op_sel_hi:[1,0]
    v_pk_mul_f32 v[48:49], v[48:49], v[50:51] op_sel:[0,0] op_sel_hi:[1,0]
    v_cvt_pk_bf16_f32 v46, v46, v47
    v_mfma_f32_16x16x32_bf16 v[164:167], v[210:213], v[74:77], 0
    v_cvt_pk_bf16_f32 v47, v48, v49
    buffer_store_dwordx2 v[46:47], v27, s[36:39], s9 offen offset:2048 sc0 sc1
    v_cndmask_b32 v54, v54, v58, s[72:73]
    v_mfma_f32_16x16x32_bf16 v[168:171], v[210:213], v[82:85], 0
    v_cndmask_b32 v55, v55, v59, s[72:73]
    v_cndmask_b32 v56, v56, v60, s[72:73]
    v_cndmask_b32 v57, v57, v61, s[72:73]
    v_mfma_f32_16x16x32_bf16 v[172:175], v[218:221], v[82:85], 0
    v_cndmask_b32 v58, v111, v112, s[72:73]
    v_pk_mul_f32 v[54:55], v[54:55], v[58:59] op_sel:[0,0] op_sel_hi:[1,0]
    v_pk_mul_f32 v[56:57], v[56:57], v[58:59] op_sel:[0,0] op_sel_hi:[1,0]
    v_mfma_f32_16x16x32_bf16 v[176:179], v[218:221], v[90:93], 0
    v_cvt_pk_bf16_f32 v54, v54, v55
    v_cvt_pk_bf16_f32 v55, v56, v57
    buffer_store_dwordx2 v[54:55], v27, s[36:39], s12 offen offset:2048 sc0 sc1
    v_mfma_f32_16x16x32_bf16 v[180:183], v[226:229], v[90:93], 0
    v_cndmask_b32 v62, v62, v66, s[74:75]
    v_cndmask_b32 v63, v63, v67, s[74:75]
    v_cndmask_b32 v64, v64, v68, s[74:75]
    v_mfma_f32_16x16x32_bf16 v[184:187], v[226:229], v[98:101], 0
    v_cndmask_b32 v65, v65, v69, s[74:75]
    v_cndmask_b32 v66, v112, v113, s[74:75]
    v_pk_mul_f32 v[62:63], v[62:63], v[66:67] op_sel:[0,0] op_sel_hi:[1,0]
    v_mfma_f32_16x16x32_bf16 v[188:191], v[234:237], v[98:101], 0
    v_pk_mul_f32 v[64:65], v[64:65], v[66:67] op_sel:[0,0] op_sel_hi:[1,0]
    v_cvt_pk_bf16_f32 v62, v62, v63
    v_cvt_pk_bf16_f32 v63, v64, v65
    buffer_store_dwordx2 v[62:63], v27, s[36:39], s13 offen offset:2048 sc0 sc1
    v_pk_mul_f32 v[70:71], v[70:71], v[112:113] op_sel:[0,1] op_sel_hi:[1,1]
    v_pk_mul_f32 v[72:73], v[72:73], v[112:113] op_sel:[0,1] op_sel_hi:[1,1]
    v_cvt_pk_bf16_f32 v70, v70, v71
    v_cvt_pk_bf16_f32 v71, v72, v73
    buffer_store_dwordx2 v[70:71], v27, s[36:39], s14 offen offset:2048 sc0 sc1
    v_rcp_f32 v106, v78
    v_rcp_f32 v107, v86
    v_rcp_f32 v108, v94
    v_rcp_f32 v109, v102
    v_pk_mul_f32 v[160:161], v[160:161], v[106:107] op_sel:[0,0] op_sel_hi:[1,0]
    v_pk_mul_f32 v[162:163], v[162:163], v[106:107] op_sel:[0,0] op_sel_hi:[1,0]
    v_cvt_pk_bf16_f32 v160, v160, v161
    v_cvt_pk_bf16_f32 v161, v162, v163
    buffer_store_dwordx2 v[160:161], v27, s[36:39], s8 offen offset:0 sc0 sc1
    v_cndmask_b32 v164, v164, v168, s[70:71]
    v_cndmask_b32 v165, v165, v169, s[70:71]
    v_cndmask_b32 v166, v166, v170, s[70:71]
    v_cndmask_b32 v167, v167, v171, s[70:71]
    v_cndmask_b32 v168, v106, v107, s[70:71]
    v_pk_mul_f32 v[164:165], v[164:165], v[168:169] op_sel:[0,0] op_sel_hi:[1,0]
    v_pk_mul_f32 v[166:167], v[166:167], v[168:169] op_sel:[0,0] op_sel_hi:[1,0]
    v_cvt_pk_bf16_f32 v164, v164, v165
    v_cvt_pk_bf16_f32 v165, v166, v167
    buffer_store_dwordx2 v[164:165], v27, s[36:39], s9 offen offset:0 sc0 sc1
    v_cndmask_b32 v172, v172, v176, s[72:73]
    v_cndmask_b32 v173, v173, v177, s[72:73]
    v_cndmask_b32 v174, v174, v178, s[72:73]
    v_cndmask_b32 v175, v175, v179, s[72:73]
    v_cndmask_b32 v176, v107, v108, s[72:73]
    v_pk_mul_f32 v[172:173], v[172:173], v[176:177] op_sel:[0,0] op_sel_hi:[1,0]
    v_pk_mul_f32 v[174:175], v[174:175], v[176:177] op_sel:[0,0] op_sel_hi:[1,0]
    v_cvt_pk_bf16_f32 v172, v172, v173
    v_cvt_pk_bf16_f32 v173, v174, v175
    buffer_store_dwordx2 v[172:173], v27, s[36:39], s12 offen offset:0 sc0 sc1
    v_cndmask_b32 v180, v180, v184, s[74:75]
    v_cndmask_b32 v181, v181, v185, s[74:75]
    v_cndmask_b32 v182, v182, v186, s[74:75]
    v_cndmask_b32 v183, v183, v187, s[74:75]
    v_cndmask_b32 v184, v108, v109, s[74:75]
    v_pk_mul_f32 v[180:181], v[180:181], v[184:185] op_sel:[0,0] op_sel_hi:[1,0]
    v_pk_mul_f32 v[182:183], v[182:183], v[184:185] op_sel:[0,0] op_sel_hi:[1,0]
    v_cvt_pk_bf16_f32 v180, v180, v181
    v_cvt_pk_bf16_f32 v181, v182, v183
    buffer_store_dwordx2 v[180:181], v27, s[36:39], s13 offen offset:0 sc0 sc1
    v_pk_mul_f32 v[188:189], v[188:189], v[108:109] op_sel:[0,1] op_sel_hi:[1,1]
    v_pk_mul_f32 v[190:191], v[190:191], v[108:109] op_sel:[0,1] op_sel_hi:[1,1]
    v_cvt_pk_bf16_f32 v188, v188, v189
    v_cvt_pk_bf16_f32 v189, v190, v191
    buffer_store_dwordx2 v[188:189], v27, s[36:39], s14 offen offset:0 sc0 sc1
    s_lshl_b32 s57, s57, 7
    s_add_u32 s57, s57, 768
    s_and_b32 s60, s53, 1
    s_lshl1_add_u32 s60, s56, s60
    s_mul_i32 s60, s60, 40960
    s_add_u32 s60, s60, s57
    s_lshr_b32 s61, s53, 1
    s_mul_i32 s61, s61, 64
    s_add_u32 s69, s60, s61
    s_add_u32 s68, s69, 20480
    v_and_b32 v2, 15, v0
    v_mul_u32_u24 v2, 1280, v2
    v_lshrrev_b32 v3, 5, v0
    v_lshl_add_u32 v2, v3, 4, v2
    v_bfe_u32 v3, v0, 4, 1
    v_lshl_add_u32 v6, v3, 5, v2
    v_lshrrev_b32 v3, 4, v0
    v_bfe_u32 v2, v0, 2, 2
    v_lshl_add_u32 v2, v3, 2, v2
    v_mul_u32_u24 v4, 128, v2
    v_and_b32 v5, 3, v0
    v_lshl_add_u32 v4, v5, 3, v4
    v_bfe_u32 v2, v2, 1, 2
    s_lshr_b32 s60, s53, 1
    s_mul_i32 s60, s60, 2
    s_add_u32 s61, s60, 0
    v_xor_b32 v3, s61, v2
    v_lshl_add_u32 v3, v3, 5, v4
    v_add_u32 v8, 65536, v3
    v_add_u32 v11, 114688, v3
    s_add_u32 s61, s60, 1
    v_xor_b32 v3, s61, v2
    v_lshl_add_u32 v3, v3, 5, v4
    v_add_u32 v9, 65536, v3
    v_add_u32 v12, 114688, v3
    s_and_b32 s60, s53, 1
    s_lshl_b32 s60, s60, 12
    s_add_u32 s60, s60, 40960
    v_lshl_add_u32 v14, v0, 4, s60
    v_lshl_add_u32 v15, v0, 3, s60
    v_add_u32 v10, 57344, v14
    v_add_u32 v13, 57344, v15
    s_barrier
    s_waitcnt lgkmcnt(0)
    ds_read_b128 v[40:43], v10 offset:49152
    ds_read_b128 v[44:47], v10 offset:51200
    ds_read_b64_tr_b16 v[72:73], v8 offset:0
    ds_read_b64_tr_b16 v[74:75], v8 offset:2048
    ds_read_b64_tr_b16 v[76:77], v9 offset:0
    ds_read_b64_tr_b16 v[78:79], v9 offset:2048
    ds_read_b128 v[48:51], v10 offset:50176
    ds_read_b128 v[52:55], v10 offset:52224
    ds_read_b64_tr_b16 v[80:81], v8 offset:4096
    ds_read_b64_tr_b16 v[82:83], v8 offset:6144
    ds_read_b64_tr_b16 v[84:85], v9 offset:4096
    ds_read_b64_tr_b16 v[86:87], v9 offset:6144
    buffer_load_dwordx4 v[120:123], v6, s[20:23], s69 offen offset:0
    s_barrier
    s_waitcnt lgkmcnt(0)
    v_mfma_f32_16x16x32_bf16 v[16:19], v[72:75], v[40:43], 0
    ds_read_b128 v[56:59], v14 offset:8192
    ds_read_b128 v[60:63], v14 offset:10240
    v_mfma_f32_16x16x32_bf16 v[24:27], v[72:75], v[44:47], 0
    ds_read_b64_tr_b16 v[88:89], v8 offset:8192
    ds_read_b64_tr_b16 v[90:91], v8 offset:10240
    v_mfma_f32_16x16x32_bf16 v[20:23], v[76:79], v[40:43], 0
    ds_read_b64_tr_b16 v[92:93], v9 offset:8192
    ds_read_b64_tr_b16 v[94:95], v9 offset:10240
    v_mfma_f32_16x16x32_bf16 v[28:31], v[76:79], v[44:47], 0
    ds_read_b128 v[64:67], v14 offset:9216
    ds_read_b128 v[68:71], v14 offset:11264
    v_mfma_f32_16x16x32_bf16 v[16:19], v[80:83], v[48:51], v[16:19]
    ds_read_b64_tr_b16 v[96:97], v8 offset:12288
    ds_read_b64_tr_b16 v[98:99], v8 offset:14336
    v_mfma_f32_16x16x32_bf16 v[24:27], v[80:83], v[52:55], v[24:27]
    ds_read_b64_tr_b16 v[100:101], v9 offset:12288
    ds_read_b64_tr_b16 v[102:103], v9 offset:14336
    v_mfma_f32_16x16x32_bf16 v[20:23], v[84:87], v[48:51], v[20:23]
    buffer_load_dwordx4 v[124:127], v6, s[20:23], s68 offen offset:0
    v_mfma_f32_16x16x32_bf16 v[28:31], v[84:87], v[52:55], v[28:31]
    s_barrier
    s_waitcnt lgkmcnt(0)
    v_mfma_f32_16x16x32_bf16 v[16:19], v[88:91], v[56:59], v[16:19]
    ds_read_b128 v[40:43], v14 offset:16384
    ds_read_b128 v[44:47], v14 offset:18432
    v_mfma_f32_16x16x32_bf16 v[24:27], v[88:91], v[60:63], v[24:27]
    ds_read_b64_tr_b16 v[72:73], v8 offset:16384
    ds_read_b64_tr_b16 v[74:75], v8 offset:18432
    v_mfma_f32_16x16x32_bf16 v[20:23], v[92:95], v[56:59], v[20:23]
    ds_read_b64_tr_b16 v[76:77], v9 offset:16384
    ds_read_b64_tr_b16 v[78:79], v9 offset:18432
    v_mfma_f32_16x16x32_bf16 v[28:31], v[92:95], v[60:63], v[28:31]
    ds_read_b128 v[48:51], v14 offset:17408
    ds_read_b128 v[52:55], v14 offset:19456
    v_mfma_f32_16x16x32_bf16 v[16:19], v[96:99], v[64:67], v[16:19]
    ds_read_b64_tr_b16 v[80:81], v8 offset:20480
    ds_read_b64_tr_b16 v[82:83], v8 offset:22528
    v_mfma_f32_16x16x32_bf16 v[24:27], v[96:99], v[68:71], v[24:27]
    ds_read_b64_tr_b16 v[84:85], v9 offset:20480
    ds_read_b64_tr_b16 v[86:87], v9 offset:22528
    v_mfma_f32_16x16x32_bf16 v[20:23], v[100:103], v[64:67], v[20:23]
    v_mfma_f32_16x16x32_bf16 v[28:31], v[100:103], v[68:71], v[28:31]
    s_barrier
    s_waitcnt lgkmcnt(0)
    v_mfma_f32_16x16x32_bf16 v[16:19], v[72:75], v[40:43], v[16:19]
    ds_read_b128 v[56:59], v10 offset:0
    ds_read_b128 v[60:63], v10 offset:2048
    v_mfma_f32_16x16x32_bf16 v[24:27], v[72:75], v[44:47], v[24:27]
    ds_read_b64_tr_b16 v[88:89], v8 offset:24576
    ds_read_b64_tr_b16 v[90:91], v8 offset:26624
    v_mfma_f32_16x16x32_bf16 v[20:23], v[76:79], v[40:43], v[20:23]
    ds_read_b64_tr_b16 v[92:93], v9 offset:24576
    ds_read_b64_tr_b16 v[94:95], v9 offset:26624
    v_mfma_f32_16x16x32_bf16 v[28:31], v[76:79], v[44:47], v[28:31]
    ds_read_b128 v[64:67], v10 offset:1024
    ds_read_b128 v[68:71], v10 offset:3072
    v_mfma_f32_16x16x32_bf16 v[16:19], v[80:83], v[48:51], v[16:19]
    ds_read_b64_tr_b16 v[96:97], v8 offset:28672
    ds_read_b64_tr_b16 v[98:99], v8 offset:30720
    v_mfma_f32_16x16x32_bf16 v[24:27], v[80:83], v[52:55], v[24:27]
    ds_read_b64_tr_b16 v[100:101], v9 offset:28672
    ds_read_b64_tr_b16 v[102:103], v9 offset:30720
    v_mfma_f32_16x16x32_bf16 v[20:23], v[84:87], v[48:51], v[20:23]
    v_mfma_f32_16x16x32_bf16 v[28:31], v[84:87], v[52:55], v[28:31]
    s_barrier
    s_waitcnt lgkmcnt(0)
    v_mfma_f32_16x16x32_bf16 v[16:19], v[88:91], v[56:59], v[16:19]
    ds_read_b128 v[40:43], v10 offset:8192
    ds_read_b128 v[44:47], v10 offset:10240
    v_mfma_f32_16x16x32_bf16 v[24:27], v[88:91], v[60:63], v[24:27]
    ds_read_b64_tr_b16 v[72:73], v11 offset:0
    ds_read_b64_tr_b16 v[74:75], v11 offset:2048
    v_mfma_f32_16x16x32_bf16 v[20:23], v[92:95], v[56:59], v[20:23]
    ds_read_b64_tr_b16 v[76:77], v12 offset:0
    ds_read_b64_tr_b16 v[78:79], v12 offset:2048
    v_mfma_f32_16x16x32_bf16 v[28:31], v[92:95], v[60:63], v[28:31]
    ds_read_b128 v[48:51], v10 offset:9216
    ds_read_b128 v[52:55], v10 offset:11264
    v_mfma_f32_16x16x32_bf16 v[16:19], v[96:99], v[64:67], v[16:19]
    ds_read_b64_tr_b16 v[80:81], v11 offset:4096
    ds_read_b64_tr_b16 v[82:83], v11 offset:6144
    v_mfma_f32_16x16x32_bf16 v[24:27], v[96:99], v[68:71], v[24:27]
    ds_read_b64_tr_b16 v[84:85], v12 offset:4096
    ds_read_b64_tr_b16 v[86:87], v12 offset:6144
    v_mfma_f32_16x16x32_bf16 v[20:23], v[100:103], v[64:67], v[20:23]
    v_mfma_f32_16x16x32_bf16 v[28:31], v[100:103], v[68:71], v[28:31]
    s_barrier
    s_waitcnt lgkmcnt(0)
    v_mfma_f32_16x16x32_bf16 v[16:19], v[72:75], v[40:43], v[16:19]
    ds_read_b128 v[56:59], v14 offset:0
    ds_read_b128 v[60:63], v14 offset:2048
    v_mfma_f32_16x16x32_bf16 v[24:27], v[72:75], v[44:47], v[24:27]
    ds_read_b64_tr_b16 v[88:89], v11 offset:8192
    ds_read_b64_tr_b16 v[90:91], v11 offset:10240
    v_mfma_f32_16x16x32_bf16 v[20:23], v[76:79], v[40:43], v[20:23]
    ds_read_b64_tr_b16 v[92:93], v12 offset:8192
    ds_read_b64_tr_b16 v[94:95], v12 offset:10240
    v_mfma_f32_16x16x32_bf16 v[28:31], v[76:79], v[44:47], v[28:31]
    ds_read_b128 v[64:67], v14 offset:1024
    ds_read_b128 v[68:71], v14 offset:3072
    v_mfma_f32_16x16x32_bf16 v[16:19], v[80:83], v[48:51], v[16:19]
    ds_read_b64_tr_b16 v[96:97], v11 offset:12288
    ds_read_b64_tr_b16 v[98:99], v11 offset:14336
    v_mfma_f32_16x16x32_bf16 v[24:27], v[80:83], v[52:55], v[24:27]
    ds_read_b64_tr_b16 v[100:101], v12 offset:12288
    ds_read_b64_tr_b16 v[102:103], v12 offset:14336
    v_mfma_f32_16x16x32_bf16 v[20:23], v[84:87], v[48:51], v[20:23]
    v_mfma_f32_16x16x32_bf16 v[28:31], v[84:87], v[52:55], v[28:31]
    s_barrier
    s_waitcnt lgkmcnt(0)
    v_mfma_f32_16x16x32_bf16 v[16:19], v[88:91], v[56:59], v[16:19]
    ds_read_b128 v[40:43], v10 offset:49152
    ds_read_b128 v[44:47], v10 offset:51200
    v_mfma_f32_16x16x32_bf16 v[24:27], v[88:91], v[60:63], v[24:27]
    ds_read_b64_tr_b16 v[72:73], v11 offset:16384
    ds_read_b64_tr_b16 v[74:75], v11 offset:18432
    v_mfma_f32_16x16x32_bf16 v[20:23], v[92:95], v[56:59], v[20:23]
    ds_read_b64_tr_b16 v[76:77], v12 offset:16384
    ds_read_b64_tr_b16 v[78:79], v12 offset:18432
    v_mfma_f32_16x16x32_bf16 v[28:31], v[92:95], v[60:63], v[28:31]
    ds_read_b128 v[48:51], v10 offset:50176
    ds_read_b128 v[52:55], v10 offset:52224
    v_mfma_f32_16x16x32_bf16 v[16:19], v[96:99], v[64:67], v[16:19]
    ds_read_b64_tr_b16 v[80:81], v11 offset:20480
    ds_read_b64_tr_b16 v[82:83], v11 offset:22528
    v_mfma_f32_16x16x32_bf16 v[24:27], v[96:99], v[68:71], v[24:27]
    ds_read_b64_tr_b16 v[84:85], v12 offset:20480
    ds_read_b64_tr_b16 v[86:87], v12 offset:22528
    v_mfma_f32_16x16x32_bf16 v[20:23], v[100:103], v[64:67], v[20:23]
    v_mfma_f32_16x16x32_bf16 v[28:31], v[100:103], v[68:71], v[28:31]
    s_barrier
    s_waitcnt lgkmcnt(0)
    v_mfma_f32_16x16x32_bf16 v[16:19], v[72:75], v[40:43], v[16:19]
    ds_read_b128 v[56:59], v14 offset:8192
    ds_read_b128 v[60:63], v14 offset:10240
    v_mfma_f32_16x16x32_bf16 v[24:27], v[72:75], v[44:47], v[24:27]
    ds_read_b64_tr_b16 v[88:89], v11 offset:24576
    ds_read_b64_tr_b16 v[90:91], v11 offset:26624
    v_mfma_f32_16x16x32_bf16 v[20:23], v[76:79], v[40:43], v[20:23]
    ds_read_b64_tr_b16 v[92:93], v12 offset:24576
    ds_read_b64_tr_b16 v[94:95], v12 offset:26624
    v_mfma_f32_16x16x32_bf16 v[28:31], v[76:79], v[44:47], v[28:31]
    ds_read_b128 v[64:67], v14 offset:9216
    ds_read_b128 v[68:71], v14 offset:11264
    v_mfma_f32_16x16x32_bf16 v[16:19], v[80:83], v[48:51], v[16:19]
    ds_read_b64_tr_b16 v[96:97], v11 offset:28672
    ds_read_b64_tr_b16 v[98:99], v11 offset:30720
    v_mfma_f32_16x16x32_bf16 v[24:27], v[80:83], v[52:55], v[24:27]
    ds_read_b64_tr_b16 v[100:101], v12 offset:28672
    ds_read_b64_tr_b16 v[102:103], v12 offset:30720
    v_mfma_f32_16x16x32_bf16 v[20:23], v[84:87], v[48:51], v[20:23]
    v_mfma_f32_16x16x32_bf16 v[28:31], v[84:87], v[52:55], v[28:31]
    s_barrier
    s_waitcnt lgkmcnt(0)
    v_mov_b32 v4, 163072
    v_mov_b32 v5, 1
    s_waitcnt vmcnt(2)
    s_mov_b64 exec, 1
    ds_add_rtn_u32 v1, v4, v5
    s_mov_b64 exec, -1
    s_lshr_b32 s60, s55, 2
    s_lshl2_add_u32 s60, s54, s60
    s_lshl_b32 s60, s60, 7
    s_add_u32 s60, s60, 16777472
    v_mov_b32 v4, s60
    v_mfma_f32_16x16x32_bf16 v[16:19], v[88:91], v[56:59], v[16:19]
    ds_read_b128 v[40:43], v14 offset:16384
    ds_read_b128 v[44:47], v14 offset:18432
    v_mfma_f32_16x16x32_bf16 v[24:27], v[88:91], v[60:63], v[24:27]
    ds_read_b64_tr_b16 v[72:73], v8 offset:0
    ds_read_b64_tr_b16 v[74:75], v8 offset:2048
    v_mfma_f32_16x16x32_bf16 v[20:23], v[92:95], v[56:59], v[20:23]
    ds_read_b64_tr_b16 v[76:77], v9 offset:0
    ds_read_b64_tr_b16 v[78:79], v9 offset:2048
    v_mfma_f32_16x16x32_bf16 v[28:31], v[92:95], v[60:63], v[28:31]
    ds_read_b128 v[48:51], v14 offset:17408
    ds_read_b128 v[52:55], v14 offset:19456
    v_mfma_f32_16x16x32_bf16 v[16:19], v[96:99], v[64:67], v[16:19]
    ds_read_b64_tr_b16 v[80:81], v8 offset:4096
    ds_read_b64_tr_b16 v[82:83], v8 offset:6144
    v_mfma_f32_16x16x32_bf16 v[24:27], v[96:99], v[68:71], v[24:27]
    ds_read_b64_tr_b16 v[84:85], v9 offset:4096
    ds_read_b64_tr_b16 v[86:87], v9 offset:6144
    v_mfma_f32_16x16x32_bf16 v[20:23], v[100:103], v[64:67], v[20:23]
    v_mfma_f32_16x16x32_bf16 v[28:31], v[100:103], v[68:71], v[28:31]
    s_barrier
    s_waitcnt lgkmcnt(0)
    v_readfirstlane_b32 s60, v1
    s_nop 0
    s_cmp_lg_u32 s60, 3
    s_cbranch_scc1 L_pb_74
    s_mov_b64 exec, 1
    buffer_atomic_add v5, v4, s[36:39], 0 offen sc1
    s_mov_b64 exec, -1
L_pb_74:
    v_mfma_f32_16x16x32_bf16 v[16:19], v[72:75], v[40:43], v[16:19]
    ds_read_b128 v[56:59], v10 offset:0
    ds_read_b128 v[60:63], v10 offset:2048
    v_mfma_f32_16x16x32_bf16 v[24:27], v[72:75], v[44:47], v[24:27]
    ds_read_b64_tr_b16 v[88:89], v8 offset:8192
    ds_read_b64_tr_b16 v[90:91], v8 offset:10240
    v_mfma_f32_16x16x32_bf16 v[20:23], v[76:79], v[40:43], v[20:23]
    ds_read_b64_tr_b16 v[92:93], v9 offset:8192
    ds_read_b64_tr_b16 v[94:95], v9 offset:10240
    v_mfma_f32_16x16x32_bf16 v[28:31], v[76:79], v[44:47], v[28:31]
    ds_read_b128 v[64:67], v10 offset:1024
    ds_read_b128 v[68:71], v10 offset:3072
    v_mfma_f32_16x16x32_bf16 v[16:19], v[80:83], v[48:51], v[16:19]
    ds_read_b64_tr_b16 v[96:97], v8 offset:12288
    ds_read_b64_tr_b16 v[98:99], v8 offset:14336
    v_mfma_f32_16x16x32_bf16 v[24:27], v[80:83], v[52:55], v[24:27]
    ds_read_b64_tr_b16 v[100:101], v9 offset:12288
    ds_read_b64_tr_b16 v[102:103], v9 offset:14336
    v_mfma_f32_16x16x32_bf16 v[20:23], v[84:87], v[48:51], v[20:23]
    v_mfma_f32_16x16x32_bf16 v[28:31], v[84:87], v[52:55], v[28:31]
    s_barrier
    s_waitcnt lgkmcnt(0)
    v_mfma_f32_16x16x32_bf16 v[16:19], v[88:91], v[56:59], v[16:19]
    ds_read_b128 v[40:43], v10 offset:8192
    ds_read_b128 v[44:47], v10 offset:10240
    v_mfma_f32_16x16x32_bf16 v[24:27], v[88:91], v[60:63], v[24:27]
    ds_read_b64_tr_b16 v[72:73], v8 offset:16384
    ds_read_b64_tr_b16 v[74:75], v8 offset:18432
    v_mfma_f32_16x16x32_bf16 v[20:23], v[92:95], v[56:59], v[20:23]
    ds_read_b64_tr_b16 v[76:77], v9 offset:16384
    ds_read_b64_tr_b16 v[78:79], v9 offset:18432
    v_mfma_f32_16x16x32_bf16 v[28:31], v[92:95], v[60:63], v[28:31]
    ds_read_b128 v[48:51], v10 offset:9216
    ds_read_b128 v[52:55], v10 offset:11264
    v_mfma_f32_16x16x32_bf16 v[16:19], v[96:99], v[64:67], v[16:19]
    ds_read_b64_tr_b16 v[80:81], v8 offset:20480
    ds_read_b64_tr_b16 v[82:83], v8 offset:22528
    v_mfma_f32_16x16x32_bf16 v[24:27], v[96:99], v[68:71], v[24:27]
    ds_read_b64_tr_b16 v[84:85], v9 offset:20480
    ds_read_b64_tr_b16 v[86:87], v9 offset:22528
    v_mfma_f32_16x16x32_bf16 v[20:23], v[100:103], v[64:67], v[20:23]
    v_mfma_f32_16x16x32_bf16 v[28:31], v[100:103], v[68:71], v[28:31]
    s_barrier
    s_waitcnt lgkmcnt(0)
    v_mfma_f32_16x16x32_bf16 v[16:19], v[72:75], v[40:43], v[16:19]
    ds_read_b128 v[56:59], v14 offset:0
    ds_read_b128 v[60:63], v14 offset:2048
    v_mfma_f32_16x16x32_bf16 v[24:27], v[72:75], v[44:47], v[24:27]
    ds_read_b64_tr_b16 v[88:89], v8 offset:24576
    ds_read_b64_tr_b16 v[90:91], v8 offset:26624
    v_mfma_f32_16x16x32_bf16 v[20:23], v[76:79], v[40:43], v[20:23]
    ds_read_b64_tr_b16 v[92:93], v9 offset:24576
    ds_read_b64_tr_b16 v[94:95], v9 offset:26624
    v_mfma_f32_16x16x32_bf16 v[28:31], v[76:79], v[44:47], v[28:31]
    ds_read_b128 v[64:67], v14 offset:1024
    ds_read_b128 v[68:71], v14 offset:3072
    v_mfma_f32_16x16x32_bf16 v[16:19], v[80:83], v[48:51], v[16:19]
    ds_read_b64_tr_b16 v[96:97], v8 offset:28672
    ds_read_b64_tr_b16 v[98:99], v8 offset:30720
    v_mfma_f32_16x16x32_bf16 v[24:27], v[80:83], v[52:55], v[24:27]
    ds_read_b64_tr_b16 v[100:101], v9 offset:28672
    ds_read_b64_tr_b16 v[102:103], v9 offset:30720
    v_mfma_f32_16x16x32_bf16 v[20:23], v[84:87], v[48:51], v[20:23]
    v_mfma_f32_16x16x32_bf16 v[28:31], v[84:87], v[52:55], v[28:31]
    s_barrier
    s_waitcnt lgkmcnt(0)
    v_mfma_f32_16x16x32_bf16 v[16:19], v[88:91], v[56:59], v[16:19]
    ds_read_b128 v[40:43], v10 offset:49152
    ds_read_b128 v[44:47], v10 offset:51200
    v_mfma_f32_16x16x32_bf16 v[24:27], v[88:91], v[60:63], v[24:27]
    ds_read_b64_tr_b16 v[72:73], v11 offset:0
    ds_read_b64_tr_b16 v[74:75], v11 offset:2048
    v_mfma_f32_16x16x32_bf16 v[20:23], v[92:95], v[56:59], v[20:23]
    ds_read_b64_tr_b16 v[76:77], v12 offset:0
    ds_read_b64_tr_b16 v[78:79], v12 offset:2048
    v_mfma_f32_16x16x32_bf16 v[28:31], v[92:95], v[60:63], v[28:31]
    ds_read_b128 v[48:51], v10 offset:50176
    ds_read_b128 v[52:55], v10 offset:52224
    v_mfma_f32_16x16x32_bf16 v[16:19], v[96:99], v[64:67], v[16:19]
    ds_read_b64_tr_b16 v[80:81], v11 offset:4096
    ds_read_b64_tr_b16 v[82:83], v11 offset:6144
    v_mfma_f32_16x16x32_bf16 v[24:27], v[96:99], v[68:71], v[24:27]
    ds_read_b64_tr_b16 v[84:85], v12 offset:4096
    ds_read_b64_tr_b16 v[86:87], v12 offset:6144
    v_mfma_f32_16x16x32_bf16 v[20:23], v[100:103], v[64:67], v[20:23]
    v_mfma_f32_16x16x32_bf16 v[28:31], v[100:103], v[68:71], v[28:31]
    s_barrier
    s_waitcnt lgkmcnt(0)
    v_mfma_f32_16x16x32_bf16 v[16:19], v[72:75], v[40:43], v[16:19]
    ds_read_b128 v[56:59], v14 offset:8192
    ds_read_b128 v[60:63], v14 offset:10240
    v_mfma_f32_16x16x32_bf16 v[24:27], v[72:75], v[44:47], v[24:27]
    ds_read_b64_tr_b16 v[88:89], v11 offset:8192
    ds_read_b64_tr_b16 v[90:91], v11 offset:10240
    v_mfma_f32_16x16x32_bf16 v[20:23], v[76:79], v[40:43], v[20:23]
    ds_read_b64_tr_b16 v[92:93], v12 offset:8192
    ds_read_b64_tr_b16 v[94:95], v12 offset:10240
    v_mfma_f32_16x16x32_bf16 v[28:31], v[76:79], v[44:47], v[28:31]
    ds_read_b128 v[64:67], v14 offset:9216
    ds_read_b128 v[68:71], v14 offset:11264
    v_mfma_f32_16x16x32_bf16 v[16:19], v[80:83], v[48:51], v[16:19]
    ds_read_b64_tr_b16 v[96:97], v11 offset:12288
    ds_read_b64_tr_b16 v[98:99], v11 offset:14336
    v_mfma_f32_16x16x32_bf16 v[24:27], v[80:83], v[52:55], v[24:27]
    ds_read_b64_tr_b16 v[100:101], v12 offset:12288
    ds_read_b64_tr_b16 v[102:103], v12 offset:14336
    v_mfma_f32_16x16x32_bf16 v[20:23], v[84:87], v[48:51], v[20:23]
    v_mfma_f32_16x16x32_bf16 v[28:31], v[84:87], v[52:55], v[28:31]
    s_barrier
    s_waitcnt lgkmcnt(0)
    v_mfma_f32_16x16x32_bf16 v[16:19], v[88:91], v[56:59], v[16:19]
    ds_read_b128 v[40:43], v14 offset:16384
    ds_read_b128 v[44:47], v14 offset:18432
    v_mfma_f32_16x16x32_bf16 v[24:27], v[88:91], v[60:63], v[24:27]
    ds_read_b64_tr_b16 v[72:73], v11 offset:16384
    ds_read_b64_tr_b16 v[74:75], v11 offset:18432
    v_mfma_f32_16x16x32_bf16 v[20:23], v[92:95], v[56:59], v[20:23]
    ds_read_b64_tr_b16 v[76:77], v12 offset:16384
    ds_read_b64_tr_b16 v[78:79], v12 offset:18432
    v_mfma_f32_16x16x32_bf16 v[28:31], v[92:95], v[60:63], v[28:31]
    ds_read_b128 v[48:51], v14 offset:17408
    ds_read_b128 v[52:55], v14 offset:19456
    v_mfma_f32_16x16x32_bf16 v[16:19], v[96:99], v[64:67], v[16:19]
    ds_read_b64_tr_b16 v[80:81], v11 offset:20480
    ds_read_b64_tr_b16 v[82:83], v11 offset:22528
    v_mfma_f32_16x16x32_bf16 v[24:27], v[96:99], v[68:71], v[24:27]
    ds_read_b64_tr_b16 v[84:85], v12 offset:20480
    ds_read_b64_tr_b16 v[86:87], v12 offset:22528
    v_mfma_f32_16x16x32_bf16 v[20:23], v[100:103], v[64:67], v[20:23]
    v_mfma_f32_16x16x32_bf16 v[28:31], v[100:103], v[68:71], v[28:31]
    s_barrier
    s_waitcnt lgkmcnt(0)
    v_mfma_f32_16x16x32_bf16 v[16:19], v[72:75], v[40:43], v[16:19]
    ds_read_b128 v[56:59], v10 offset:0
    ds_read_b128 v[60:63], v10 offset:2048
    v_mfma_f32_16x16x32_bf16 v[24:27], v[72:75], v[44:47], v[24:27]
    ds_read_b64_tr_b16 v[88:89], v11 offset:24576
    ds_read_b64_tr_b16 v[90:91], v11 offset:26624
    v_mfma_f32_16x16x32_bf16 v[20:23], v[76:79], v[40:43], v[20:23]
    ds_read_b64_tr_b16 v[92:93], v12 offset:24576
    ds_read_b64_tr_b16 v[94:95], v12 offset:26624
    v_mfma_f32_16x16x32_bf16 v[28:31], v[76:79], v[44:47], v[28:31]
    ds_read_b128 v[64:67], v10 offset:1024
    ds_read_b128 v[68:71], v10 offset:3072
    v_mfma_f32_16x16x32_bf16 v[16:19], v[80:83], v[48:51], v[16:19]
    ds_read_b64_tr_b16 v[96:97], v11 offset:28672
    ds_read_b64_tr_b16 v[98:99], v11 offset:30720
    v_mfma_f32_16x16x32_bf16 v[24:27], v[80:83], v[52:55], v[24:27]
    ds_read_b64_tr_b16 v[100:101], v12 offset:28672
    ds_read_b64_tr_b16 v[102:103], v12 offset:30720
    v_mfma_f32_16x16x32_bf16 v[20:23], v[84:87], v[48:51], v[20:23]
    v_mfma_f32_16x16x32_bf16 v[28:31], v[84:87], v[52:55], v[28:31]
    s_barrier
    s_waitcnt lgkmcnt(0)
    v_mfma_f32_16x16x32_bf16 v[16:19], v[88:91], v[56:59], v[16:19]
    ds_read_b128 v[40:43], v10 offset:8192
    ds_read_b128 v[44:47], v10 offset:10240
    v_mfma_f32_16x16x32_bf16 v[24:27], v[88:91], v[60:63], v[24:27]
    ds_read_b64_tr_b16 v[72:73], v8 offset:0
    ds_read_b64_tr_b16 v[74:75], v8 offset:2048
    v_mfma_f32_16x16x32_bf16 v[20:23], v[92:95], v[56:59], v[20:23]
    ds_read_b64_tr_b16 v[76:77], v9 offset:0
    ds_read_b64_tr_b16 v[78:79], v9 offset:2048
    v_mfma_f32_16x16x32_bf16 v[28:31], v[92:95], v[60:63], v[28:31]
    ds_read_b128 v[48:51], v10 offset:9216
    ds_read_b128 v[52:55], v10 offset:11264
    v_mfma_f32_16x16x32_bf16 v[16:19], v[96:99], v[64:67], v[16:19]
    ds_read_b64_tr_b16 v[80:81], v8 offset:4096
    ds_read_b64_tr_b16 v[82:83], v8 offset:6144
    v_mfma_f32_16x16x32_bf16 v[24:27], v[96:99], v[68:71], v[24:27]
    ds_read_b64_tr_b16 v[84:85], v9 offset:4096
    ds_read_b64_tr_b16 v[86:87], v9 offset:6144
    v_mfma_f32_16x16x32_bf16 v[20:23], v[100:103], v[64:67], v[20:23]
    v_mfma_f32_16x16x32_bf16 v[28:31], v[100:103], v[68:71], v[28:31]
    s_barrier
    s_waitcnt lgkmcnt(0)
    v_mfma_f32_16x16x32_bf16 v[16:19], v[72:75], v[40:43], v[16:19]
    ds_read_b128 v[56:59], v14 offset:0
    ds_read_b128 v[60:63], v14 offset:2048
    v_mfma_f32_16x16x32_bf16 v[24:27], v[72:75], v[44:47], v[24:27]
    ds_read_b64_tr_b16 v[88:89], v8 offset:8192
    ds_read_b64_tr_b16 v[90:91], v8 offset:10240
    v_mfma_f32_16x16x32_bf16 v[20:23], v[76:79], v[40:43], v[20:23]
    ds_read_b64_tr_b16 v[92:93], v9 offset:8192
    ds_read_b64_tr_b16 v[94:95], v9 offset:10240
    v_mfma_f32_16x16x32_bf16 v[28:31], v[76:79], v[44:47], v[28:31]
    ds_read_b128 v[64:67], v14 offset:1024
    ds_read_b128 v[68:71], v14 offset:3072
    v_mfma_f32_16x16x32_bf16 v[16:19], v[80:83], v[48:51], v[16:19]
    ds_read_b64_tr_b16 v[96:97], v8 offset:12288
    ds_read_b64_tr_b16 v[98:99], v8 offset:14336
    v_mfma_f32_16x16x32_bf16 v[24:27], v[80:83], v[52:55], v[24:27]
    ds_read_b64_tr_b16 v[100:101], v9 offset:12288
    ds_read_b64_tr_b16 v[102:103], v9 offset:14336
    v_mfma_f32_16x16x32_bf16 v[20:23], v[84:87], v[48:51], v[20:23]
    v_mfma_f32_16x16x32_bf16 v[28:31], v[84:87], v[52:55], v[28:31]
    s_barrier
    s_waitcnt lgkmcnt(0)
    v_mfma_f32_16x16x32_bf16 v[16:19], v[88:91], v[56:59], v[16:19]
    ds_read_b128 v[40:43], v10 offset:49152
    ds_read_b128 v[44:47], v10 offset:51200
    v_mfma_f32_16x16x32_bf16 v[24:27], v[88:91], v[60:63], v[24:27]
    ds_read_b64_tr_b16 v[72:73], v8 offset:16384
    ds_read_b64_tr_b16 v[74:75], v8 offset:18432
    v_mfma_f32_16x16x32_bf16 v[20:23], v[92:95], v[56:59], v[20:23]
    ds_read_b64_tr_b16 v[76:77], v9 offset:16384
    ds_read_b64_tr_b16 v[78:79], v9 offset:18432
    v_mfma_f32_16x16x32_bf16 v[28:31], v[92:95], v[60:63], v[28:31]
    ds_read_b128 v[48:51], v10 offset:50176
    ds_read_b128 v[52:55], v10 offset:52224
    v_mfma_f32_16x16x32_bf16 v[16:19], v[96:99], v[64:67], v[16:19]
    ds_read_b64_tr_b16 v[80:81], v8 offset:20480
    ds_read_b64_tr_b16 v[82:83], v8 offset:22528
    v_mfma_f32_16x16x32_bf16 v[24:27], v[96:99], v[68:71], v[24:27]
    ds_read_b64_tr_b16 v[84:85], v9 offset:20480
    ds_read_b64_tr_b16 v[86:87], v9 offset:22528
    v_mfma_f32_16x16x32_bf16 v[20:23], v[100:103], v[64:67], v[20:23]
    v_mfma_f32_16x16x32_bf16 v[28:31], v[100:103], v[68:71], v[28:31]
    s_barrier
    s_waitcnt lgkmcnt(0)
    v_mfma_f32_16x16x32_bf16 v[16:19], v[72:75], v[40:43], v[16:19]
    ds_read_b128 v[56:59], v14 offset:8192
    ds_read_b128 v[60:63], v14 offset:10240
    v_mfma_f32_16x16x32_bf16 v[24:27], v[72:75], v[44:47], v[24:27]
    ds_read_b64_tr_b16 v[88:89], v8 offset:24576
    ds_read_b64_tr_b16 v[90:91], v8 offset:26624
    v_mfma_f32_16x16x32_bf16 v[20:23], v[76:79], v[40:43], v[20:23]
    ds_read_b64_tr_b16 v[92:93], v9 offset:24576
    ds_read_b64_tr_b16 v[94:95], v9 offset:26624
    v_mfma_f32_16x16x32_bf16 v[28:31], v[76:79], v[44:47], v[28:31]
    ds_read_b128 v[64:67], v14 offset:9216
    ds_read_b128 v[68:71], v14 offset:11264
    v_mfma_f32_16x16x32_bf16 v[16:19], v[80:83], v[48:51], v[16:19]
    ds_read_b64_tr_b16 v[96:97], v8 offset:28672
    ds_read_b64_tr_b16 v[98:99], v8 offset:30720
    v_mfma_f32_16x16x32_bf16 v[24:27], v[80:83], v[52:55], v[24:27]
    ds_read_b64_tr_b16 v[100:101], v9 offset:28672
    ds_read_b64_tr_b16 v[102:103], v9 offset:30720
    v_mfma_f32_16x16x32_bf16 v[20:23], v[84:87], v[48:51], v[20:23]
    v_mfma_f32_16x16x32_bf16 v[28:31], v[84:87], v[52:55], v[28:31]
    s_barrier
    s_waitcnt lgkmcnt(0)
    v_mfma_f32_16x16x32_bf16 v[16:19], v[88:91], v[56:59], v[16:19]
    ds_read_b128 v[40:43], v14 offset:16384
    ds_read_b128 v[44:47], v14 offset:18432
    ds_read_b64_tr_b16 v[72:73], v11 offset:0
    v_mfma_f32_16x16x32_bf16 v[24:27], v[88:91], v[60:63], v[24:27]
    ds_read_b64_tr_b16 v[74:75], v11 offset:2048
    ds_read_b64_tr_b16 v[76:77], v12 offset:0
    ds_read_b64_tr_b16 v[78:79], v12 offset:2048
    v_mfma_f32_16x16x32_bf16 v[20:23], v[92:95], v[56:59], v[20:23]
    ds_read_b128 v[48:51], v14 offset:17408
    ds_read_b128 v[52:55], v14 offset:19456
    ds_read_b64_tr_b16 v[80:81], v11 offset:4096
    v_mfma_f32_16x16x32_bf16 v[28:31], v[92:95], v[60:63], v[28:31]
    ds_read_b64_tr_b16 v[82:83], v11 offset:6144
    ds_read_b64_tr_b16 v[84:85], v12 offset:4096
    ds_read_b64_tr_b16 v[86:87], v12 offset:6144
    v_mfma_f32_16x16x32_bf16 v[16:19], v[96:99], v[64:67], v[16:19]
    s_and_b32 s60, s56, 1
    s_and_b32 s61, s53, 1
    s_lshl1_add_u32 s60, s60, s61
    v_mfma_f32_16x16x32_bf16 v[24:27], v[96:99], v[68:71], v[24:27]
    s_lshl_b32 s60, s60, 7
    s_add_u32 s60, s60, 161408
    v_and_b32 v2, 15, v0
    v_mfma_f32_16x16x32_bf16 v[20:23], v[100:103], v[64:67], v[20:23]
    v_lshl_add_u32 v2, v2, 2, s60
    ds_read_b32 v132, v2
    ds_read_b32 v134, v2 offset:64
    v_mfma_f32_16x16x32_bf16 v[28:31], v[100:103], v[68:71], v[28:31]
    s_barrier
    s_waitcnt lgkmcnt(0)
    v_mfma_f32_16x16x32_bf16 v[16:19], v[72:75], v[40:43], v[16:19]
    ds_read_b128 v[56:59], v10 offset:0
    ds_read_b128 v[60:63], v10 offset:2048
    v_mfma_f32_16x16x32_bf16 v[24:27], v[72:75], v[44:47], v[24:27]
    ds_read_b64_tr_b16 v[88:89], v11 offset:8192
    ds_read_b64_tr_b16 v[90:91], v11 offset:10240
    v_mfma_f32_16x16x32_bf16 v[20:23], v[76:79], v[40:43], v[20:23]
    ds_read_b64_tr_b16 v[92:93], v12 offset:8192
    ds_read_b64_tr_b16 v[94:95], v12 offset:10240
    v_mfma_f32_16x16x32_bf16 v[28:31], v[76:79], v[44:47], v[28:31]
    ds_read_b128 v[64:67], v10 offset:1024
    ds_read_b128 v[68:71], v10 offset:3072
    v_mfma_f32_16x16x32_bf16 v[16:19], v[80:83], v[48:51], v[16:19]
    ds_read_b64_tr_b16 v[96:97], v11 offset:12288
    ds_read_b64_tr_b16 v[98:99], v11 offset:14336
    v_mfma_f32_16x16x32_bf16 v[24:27], v[80:83], v[52:55], v[24:27]
    ds_read_b64_tr_b16 v[100:101], v12 offset:12288
    ds_read_b64_tr_b16 v[102:103], v12 offset:14336
    v_mfma_f32_16x16x32_bf16 v[20:23], v[84:87], v[48:51], v[20:23]
    v_mfma_f32_16x16x32_bf16 v[28:31], v[84:87], v[52:55], v[28:31]
    s_barrier
    s_waitcnt lgkmcnt(0)
    v_mfma_f32_16x16x32_bf16 v[16:19], v[88:91], v[56:59], v[16:19]
    ds_read_b128 v[40:43], v10 offset:8192
    ds_read_b128 v[44:47], v10 offset:10240
    v_mfma_f32_16x16x32_bf16 v[24:27], v[88:91], v[60:63], v[24:27]
    ds_read_b64_tr_b16 v[72:73], v11 offset:16384
    ds_read_b64_tr_b16 v[74:75], v11 offset:18432
    v_mfma_f32_16x16x32_bf16 v[20:23], v[92:95], v[56:59], v[20:23]
    ds_read_b64_tr_b16 v[76:77], v12 offset:16384
    ds_read_b64_tr_b16 v[78:79], v12 offset:18432
    v_mfma_f32_16x16x32_bf16 v[28:31], v[92:95], v[60:63], v[28:31]
    ds_read_b128 v[48:51], v10 offset:9216
    ds_read_b128 v[52:55], v10 offset:11264
    v_mfma_f32_16x16x32_bf16 v[16:19], v[96:99], v[64:67], v[16:19]
    ds_read_b64_tr_b16 v[80:81], v11 offset:20480
    ds_read_b64_tr_b16 v[82:83], v11 offset:22528
    v_mfma_f32_16x16x32_bf16 v[24:27], v[96:99], v[68:71], v[24:27]
    ds_read_b64_tr_b16 v[84:85], v12 offset:20480
    ds_read_b64_tr_b16 v[86:87], v12 offset:22528
    v_mfma_f32_16x16x32_bf16 v[20:23], v[100:103], v[64:67], v[20:23]
    v_mfma_f32_16x16x32_bf16 v[28:31], v[100:103], v[68:71], v[28:31]
    s_barrier
    s_waitcnt lgkmcnt(0)
    v_mfma_f32_16x16x32_bf16 v[16:19], v[72:75], v[40:43], v[16:19]
    ds_read_b128 v[56:59], v14 offset:0
    ds_read_b128 v[60:63], v14 offset:2048
    v_mfma_f32_16x16x32_bf16 v[24:27], v[72:75], v[44:47], v[24:27]
    ds_read_b64_tr_b16 v[88:89], v11 offset:24576
    ds_read_b64_tr_b16 v[90:91], v11 offset:26624
    v_mfma_f32_16x16x32_bf16 v[20:23], v[76:79], v[40:43], v[20:23]
    ds_read_b64_tr_b16 v[92:93], v12 offset:24576
    ds_read_b64_tr_b16 v[94:95], v12 offset:26624
    v_mfma_f32_16x16x32_bf16 v[28:31], v[76:79], v[44:47], v[28:31]
    ds_read_b128 v[64:67], v14 offset:1024
    ds_read_b128 v[68:71], v14 offset:3072
    v_mfma_f32_16x16x32_bf16 v[16:19], v[80:83], v[48:51], v[16:19]
    ds_read_b64_tr_b16 v[96:97], v11 offset:28672
    ds_read_b64_tr_b16 v[98:99], v11 offset:30720
    v_mfma_f32_16x16x32_bf16 v[24:27], v[80:83], v[52:55], v[24:27]
    ds_read_b64_tr_b16 v[100:101], v12 offset:28672
    ds_read_b64_tr_b16 v[102:103], v12 offset:30720
    v_mfma_f32_16x16x32_bf16 v[20:23], v[84:87], v[48:51], v[20:23]
    v_mfma_f32_16x16x32_bf16 v[28:31], v[84:87], v[52:55], v[28:31]
    s_barrier
    s_waitcnt lgkmcnt(0)
    v_mfma_f32_16x16x32_bf16 v[16:19], v[88:91], v[56:59], v[16:19]
    ds_read_b64 v[40:41], v13 offset:49152
    ds_read_b64 v[42:43], v13 offset:49664
    ds_read_b64 v[44:45], v13 offset:51200
    v_mfma_f32_16x16x32_bf16 v[24:27], v[88:91], v[60:63], v[24:27]
    ds_read_b64 v[46:47], v13 offset:51712
    ds_read_b64_tr_b16 v[72:73], v8 offset:0
    ds_read_b64_tr_b16 v[74:75], v8 offset:2048
    v_mfma_f32_16x16x32_bf16 v[20:23], v[92:95], v[56:59], v[20:23]
    ds_read_b64_tr_b16 v[76:77], v9 offset:0
    ds_read_b64_tr_b16 v[78:79], v9 offset:2048
    ds_read_b64 v[48:49], v13 offset:50176
    v_mfma_f32_16x16x32_bf16 v[28:31], v[92:95], v[60:63], v[28:31]
    ds_read_b64 v[50:51], v13 offset:50688
    ds_read_b64 v[52:53], v13 offset:52224
    ds_read_b64 v[54:55], v13 offset:52736
    v_mfma_f32_16x16x32_bf16 v[16:19], v[96:99], v[64:67], v[16:19]
    ds_read_b64_tr_b16 v[80:81], v8 offset:4096
    ds_read_b64_tr_b16 v[82:83], v8 offset:6144
    ds_read_b64_tr_b16 v[84:85], v9 offset:4096
    v_mfma_f32_16x16x32_bf16 v[24:27], v[96:99], v[68:71], v[24:27]
    ds_read_b64_tr_b16 v[86:87], v9 offset:6144
    s_waitcnt vmcnt(0)
    v_permlane16_swap_b32 v120, v122
    v_mfma_f32_16x16x32_bf16 v[20:23], v[100:103], v[64:67], v[20:23]
    v_permlane16_swap_b32 v121, v123
    v_lshlrev_b32 v136, 16, v120
    v_mfma_f32_16x16x32_bf16 v[28:31], v[100:103], v[68:71], v[28:31]
    s_barrier
    s_waitcnt lgkmcnt(0)
    v_pk_mul_f32 v[16:17], v[16:17], v[132:133] op_sel_hi:[1,0]
    v_pk_mul_f32 v[18:19], v[18:19], v[132:133] op_sel_hi:[1,0]
    s_nop 0
    v_pk_mul_f32 v[20:21], v[20:21], v[132:133] op_sel_hi:[1,0]
    v_pk_mul_f32 v[22:23], v[22:23], v[132:133] op_sel_hi:[1,0]
    v_pk_mul_f32 v[24:25], v[24:25], v[134:135] op_sel_hi:[1,0]
    v_pk_mul_f32 v[26:27], v[26:27], v[134:135] op_sel_hi:[1,0]
    v_pk_mul_f32 v[28:29], v[28:29], v[134:135] op_sel_hi:[1,0]
    v_pk_mul_f32 v[30:31], v[30:31], v[134:135] op_sel_hi:[1,0]
    v_mfma_f32_16x16x32_bf16 v[16:19], v[72:75], v[40:43], v[16:19]
    ds_read_b64 v[56:57], v15 offset:8192
    ds_read_b64 v[58:59], v15 offset:8704
    ds_read_b64 v[60:61], v15 offset:10240
    v_mfma_f32_16x16x32_bf16 v[24:27], v[72:75], v[44:47], v[24:27]
    ds_read_b64 v[62:63], v15 offset:10752
    ds_read_b64_tr_b16 v[88:89], v8 offset:8192
    ds_read_b64_tr_b16 v[90:91], v8 offset:10240
    v_mfma_f32_16x16x32_bf16 v[20:23], v[76:79], v[40:43], v[20:23]
    ds_read_b64_tr_b16 v[92:93], v9 offset:8192
    ds_read_b64_tr_b16 v[94:95], v9 offset:10240
    ds_read_b64 v[64:65], v15 offset:9216
    v_mfma_f32_16x16x32_bf16 v[28:31], v[76:79], v[44:47], v[28:31]
    ds_read_b64 v[66:67], v15 offset:9728
    ds_read_b64 v[68:69], v15 offset:11264
    ds_read_b64 v[70:71], v15 offset:11776
    v_mfma_f32_16x16x32_bf16 v[16:19], v[80:83], v[48:51], v[16:19]
    ds_read_b64_tr_b16 v[96:97], v8 offset:12288
    ds_read_b64_tr_b16 v[98:99], v8 offset:14336
    ds_read_b64_tr_b16 v[100:101], v9 offset:12288
    v_mfma_f32_16x16x32_bf16 v[24:27], v[80:83], v[52:55], v[24:27]
    ds_read_b64_tr_b16 v[102:103], v9 offset:14336
    v_and_b32 v137, 0xffff0000, v120
    v_lshlrev_b32 v138, 16, v121
    v_mfma_f32_16x16x32_bf16 v[20:23], v[84:87], v[48:51], v[20:23]
    v_and_b32 v139, 0xffff0000, v121
    v_lshlrev_b32 v140, 16, v122
    v_mfma_f32_16x16x32_bf16 v[28:31], v[84:87], v[52:55], v[28:31]
    s_barrier
    s_waitcnt lgkmcnt(0)
    v_mfma_f32_16x16x32_bf16 v[16:19], v[88:91], v[56:59], v[16:19]
    ds_read_b64 v[40:41], v15 offset:16384
    ds_read_b64 v[42:43], v15 offset:16896
    ds_read_b64 v[44:45], v15 offset:18432
    v_mfma_f32_16x16x32_bf16 v[24:27], v[88:91], v[60:63], v[24:27]
    ds_read_b64 v[46:47], v15 offset:18944
    ds_read_b64_tr_b16 v[72:73], v8 offset:16384
    ds_read_b64_tr_b16 v[74:75], v8 offset:18432
    v_mfma_f32_16x16x32_bf16 v[20:23], v[92:95], v[56:59], v[20:23]
    ds_read_b64_tr_b16 v[76:77], v9 offset:16384
    ds_read_b64_tr_b16 v[78:79], v9 offset:18432
    ds_read_b64 v[48:49], v15 offset:17408
    v_mfma_f32_16x16x32_bf16 v[28:31], v[92:95], v[60:63], v[28:31]
    ds_read_b64 v[50:51], v15 offset:17920
    ds_read_b64 v[52:53], v15 offset:19456
    ds_read_b64 v[54:55], v15 offset:19968
    v_mfma_f32_16x16x32_bf16 v[16:19], v[96:99], v[64:67], v[16:19]
    ds_read_b64_tr_b16 v[80:81], v8 offset:20480
    ds_read_b64_tr_b16 v[82:83], v8 offset:22528
    ds_read_b64_tr_b16 v[84:85], v9 offset:20480
    v_mfma_f32_16x16x32_bf16 v[24:27], v[96:99], v[68:71], v[24:27]
    ds_read_b64_tr_b16 v[86:87], v9 offset:22528
    v_and_b32 v141, 0xffff0000, v122
    v_lshlrev_b32 v142, 16, v123
    v_mfma_f32_16x16x32_bf16 v[20:23], v[100:103], v[64:67], v[20:23]
    v_and_b32 v143, 0xffff0000, v123
    v_permlane16_swap_b32 v124, v126
    v_mfma_f32_16x16x32_bf16 v[28:31], v[100:103], v[68:71], v[28:31]
    s_barrier
    s_waitcnt lgkmcnt(0)
    v_mfma_f32_16x16x32_bf16 v[16:19], v[72:75], v[40:43], v[16:19]
    ds_read_b64 v[56:57], v13 offset:0
    ds_read_b64 v[58:59], v13 offset:512
    ds_read_b64 v[60:61], v13 offset:2048
    v_mfma_f32_16x16x32_bf16 v[24:27], v[72:75], v[44:47], v[24:27]
    ds_read_b64 v[62:63], v13 offset:2560
    ds_read_b64_tr_b16 v[88:89], v8 offset:24576
    ds_read_b64_tr_b16 v[90:91], v8 offset:26624
    v_mfma_f32_16x16x32_bf16 v[20:23], v[76:79], v[40:43], v[20:23]
    ds_read_b64_tr_b16 v[92:93], v9 offset:24576
    ds_read_b64_tr_b16 v[94:95], v9 offset:26624
    ds_read_b64 v[64:65], v13 offset:1024
    v_mfma_f32_16x16x32_bf16 v[28:31], v[76:79], v[44:47], v[28:31]
    ds_read_b64 v[66:67], v13 offset:1536
    ds_read_b64 v[68:69], v13 offset:3072
    ds_read_b64 v[70:71], v13 offset:3584
    v_mfma_f32_16x16x32_bf16 v[16:19], v[80:83], v[48:51], v[16:19]
    ds_read_b64_tr_b16 v[96:97], v8 offset:28672
    ds_read_b64_tr_b16 v[98:99], v8 offset:30720
    ds_read_b64_tr_b16 v[100:101], v9 offset:28672
    v_mfma_f32_16x16x32_bf16 v[24:27], v[80:83], v[52:55], v[24:27]
    ds_read_b64_tr_b16 v[102:103], v9 offset:30720
    v_permlane16_swap_b32 v125, v127
    v_lshlrev_b32 v144, 16, v124
    v_mfma_f32_16x16x32_bf16 v[20:23], v[84:87], v[48:51], v[20:23]
    v_and_b32 v145, 0xffff0000, v124
    v_mfma_f32_16x16x32_bf16 v[28:31], v[84:87], v[52:55], v[28:31]
    s_barrier
    s_waitcnt lgkmcnt(0)
    v_mfma_f32_16x16x32_bf16 v[16:19], v[88:91], v[56:59], v[16:19]
    ds_read_b64 v[40:41], v13 offset:8192
    ds_read_b64 v[42:43], v13 offset:8704
    ds_read_b64 v[44:45], v13 offset:10240
    v_mfma_f32_16x16x32_bf16 v[24:27], v[88:91], v[60:63], v[24:27]
    ds_read_b64 v[46:47], v13 offset:10752
    ds_read_b64_tr_b16 v[72:73], v11 offset:0
    ds_read_b64_tr_b16 v[74:75], v11 offset:2048
    v_mfma_f32_16x16x32_bf16 v[20:23], v[92:95], v[56:59], v[20:23]
    ds_read_b64_tr_b16 v[76:77], v12 offset:0
    ds_read_b64_tr_b16 v[78:79], v12 offset:2048
    ds_read_b64 v[48:49], v13 offset:9216
    v_mfma_f32_16x16x32_bf16 v[28:31], v[92:95], v[60:63], v[28:31]
    ds_read_b64 v[50:51], v13 offset:9728
    ds_read_b64 v[52:53], v13 offset:11264
    ds_read_b64 v[54:55], v13 offset:11776
    v_mfma_f32_16x16x32_bf16 v[16:19], v[96:99], v[64:67], v[16:19]
    ds_read_b64_tr_b16 v[80:81], v11 offset:4096
    ds_read_b64_tr_b16 v[82:83], v11 offset:6144
    ds_read_b64_tr_b16 v[84:85], v12 offset:4096
    v_mfma_f32_16x16x32_bf16 v[24:27], v[96:99], v[68:71], v[24:27]
    ds_read_b64_tr_b16 v[86:87], v12 offset:6144
    v_lshlrev_b32 v146, 16, v125
    v_and_b32 v147, 0xffff0000, v125
    v_mfma_f32_16x16x32_bf16 v[20:23], v[100:103], v[64:67], v[20:23]
    v_lshlrev_b32 v148, 16, v126
    v_mfma_f32_16x16x32_bf16 v[28:31], v[100:103], v[68:71], v[28:31]
    s_barrier
    s_waitcnt lgkmcnt(0)
    v_mfma_f32_16x16x32_bf16 v[16:19], v[72:75], v[40:43], v[16:19]
    ds_read_b64 v[56:57], v15 offset:0
    ds_read_b64 v[58:59], v15 offset:512
    ds_read_b64 v[60:61], v15 offset:2048
    v_mfma_f32_16x16x32_bf16 v[24:27], v[72:75], v[44:47], v[24:27]
    ds_read_b64 v[62:63], v15 offset:2560
    ds_read_b64_tr_b16 v[88:89], v11 offset:8192
    ds_read_b64_tr_b16 v[90:91], v11 offset:10240
    v_mfma_f32_16x16x32_bf16 v[20:23], v[76:79], v[40:43], v[20:23]
    ds_read_b64_tr_b16 v[92:93], v12 offset:8192
    ds_read_b64_tr_b16 v[94:95], v12 offset:10240
    ds_read_b64 v[64:65], v15 offset:1024
    v_mfma_f32_16x16x32_bf16 v[28:31], v[76:79], v[44:47], v[28:31]
    ds_read_b64 v[66:67], v15 offset:1536
    ds_read_b64 v[68:69], v15 offset:3072
    ds_read_b64 v[70:71], v15 offset:3584
    v_mfma_f32_16x16x32_bf16 v[16:19], v[80:83], v[48:51], v[16:19]
    ds_read_b64_tr_b16 v[96:97], v11 offset:12288
    ds_read_b64_tr_b16 v[98:99], v11 offset:14336
    ds_read_b64_tr_b16 v[100:101], v12 offset:12288
    v_mfma_f32_16x16x32_bf16 v[24:27], v[80:83], v[52:55], v[24:27]
    ds_read_b64_tr_b16 v[102:103], v12 offset:14336
    v_and_b32 v149, 0xffff0000, v126
    v_lshlrev_b32 v150, 16, v127
    v_mfma_f32_16x16x32_bf16 v[20:23], v[84:87], v[48:51], v[20:23]
    v_and_b32 v151, 0xffff0000, v127
    v_mfma_f32_16x16x32_bf16 v[28:31], v[84:87], v[52:55], v[28:31]
    s_barrier
    s_waitcnt lgkmcnt(0)
    v_mfma_f32_16x16x32_bf16 v[16:19], v[88:91], v[56:59], v[16:19]
    ds_read_b64 v[40:41], v13 offset:49152
    ds_read_b64 v[42:43], v13 offset:49664
    v_mfma_f32_16x16x32_bf16 v[24:27], v[88:91], v[60:63], v[24:27]
    ds_read_b64 v[44:45], v13 offset:51200
    ds_read_b64 v[46:47], v13 offset:51712
    v_mfma_f32_16x16x32_bf16 v[20:23], v[92:95], v[56:59], v[20:23]
    ds_read_b64_tr_b16 v[72:73], v11 offset:16384
    ds_read_b64_tr_b16 v[74:75], v11 offset:18432
    v_mfma_f32_16x16x32_bf16 v[28:31], v[92:95], v[60:63], v[28:31]
    ds_read_b64_tr_b16 v[76:77], v12 offset:16384
    ds_read_b64_tr_b16 v[78:79], v12 offset:18432
    v_mfma_f32_16x16x32_bf16 v[16:19], v[96:99], v[64:67], v[16:19]
    ds_read_b64 v[48:49], v13 offset:50176
    ds_read_b64 v[50:51], v13 offset:50688
    v_mfma_f32_16x16x32_bf16 v[24:27], v[96:99], v[68:71], v[24:27]
    ds_read_b64 v[52:53], v13 offset:52224
    ds_read_b64 v[54:55], v13 offset:52736
    v_mfma_f32_16x16x32_bf16 v[20:23], v[100:103], v[64:67], v[20:23]
    ds_read_b64_tr_b16 v[80:81], v11 offset:20480
    ds_read_b64_tr_b16 v[82:83], v11 offset:22528
    v_mfma_f32_16x16x32_bf16 v[28:31], v[100:103], v[68:71], v[28:31]
    ds_read_b64_tr_b16 v[84:85], v12 offset:20480
    ds_read_b64_tr_b16 v[86:87], v12 offset:22528
    s_barrier
    s_waitcnt lgkmcnt(0)
    v_mfma_f32_16x16x32_bf16 v[16:19], v[72:75], v[40:43], v[16:19]
    ds_read_b64 v[56:57], v15 offset:8192
    ds_read_b64 v[58:59], v15 offset:8704
    v_mfma_f32_16x16x32_bf16 v[24:27], v[72:75], v[44:47], v[24:27]
    ds_read_b64 v[60:61], v15 offset:10240
    ds_read_b64 v[62:63], v15 offset:10752
    v_mfma_f32_16x16x32_bf16 v[20:23], v[76:79], v[40:43], v[20:23]
    ds_read_b64_tr_b16 v[88:89], v11 offset:24576
    ds_read_b64_tr_b16 v[90:91], v11 offset:26624
    v_mfma_f32_16x16x32_bf16 v[28:31], v[76:79], v[44:47], v[28:31]
    ds_read_b64_tr_b16 v[92:93], v12 offset:24576
    ds_read_b64_tr_b16 v[94:95], v12 offset:26624
    v_mfma_f32_16x16x32_bf16 v[16:19], v[80:83], v[48:51], v[16:19]
    ds_read_b64 v[64:65], v15 offset:9216
    ds_read_b64 v[66:67], v15 offset:9728
    v_mfma_f32_16x16x32_bf16 v[24:27], v[80:83], v[52:55], v[24:27]
    ds_read_b64 v[68:69], v15 offset:11264
    ds_read_b64 v[70:71], v15 offset:11776
    v_mfma_f32_16x16x32_bf16 v[20:23], v[84:87], v[48:51], v[20:23]
    ds_read_b64_tr_b16 v[96:97], v11 offset:28672
    ds_read_b64_tr_b16 v[98:99], v11 offset:30720
    v_mfma_f32_16x16x32_bf16 v[28:31], v[84:87], v[52:55], v[28:31]
    ds_read_b64_tr_b16 v[100:101], v12 offset:28672
    ds_read_b64_tr_b16 v[102:103], v12 offset:30720
    s_barrier
    s_waitcnt lgkmcnt(0)
    v_mfma_f32_16x16x32_bf16 v[16:19], v[88:91], v[56:59], v[16:19]
    ds_read_b64 v[40:41], v15 offset:16384
    ds_read_b64 v[42:43], v15 offset:16896
    v_mfma_f32_16x16x32_bf16 v[24:27], v[88:91], v[60:63], v[24:27]
    ds_read_b64 v[44:45], v15 offset:18432
    ds_read_b64 v[46:47], v15 offset:18944
    v_mfma_f32_16x16x32_bf16 v[20:23], v[92:95], v[56:59], v[20:23]
    ds_read_b64_tr_b16 v[72:73], v8 offset:0
    ds_read_b64_tr_b16 v[74:75], v8 offset:2048
    v_mfma_f32_16x16x32_bf16 v[28:31], v[92:95], v[60:63], v[28:31]
    ds_read_b64_tr_b16 v[76:77], v9 offset:0
    ds_read_b64_tr_b16 v[78:79], v9 offset:2048
    v_mfma_f32_16x16x32_bf16 v[16:19], v[96:99], v[64:67], v[16:19]
    ds_read_b64 v[48:49], v15 offset:17408
    ds_read_b64 v[50:51], v15 offset:17920
    v_mfma_f32_16x16x32_bf16 v[24:27], v[96:99], v[68:71], v[24:27]
    ds_read_b64 v[52:53], v15 offset:19456
    ds_read_b64 v[54:55], v15 offset:19968
    v_mfma_f32_16x16x32_bf16 v[20:23], v[100:103], v[64:67], v[20:23]
    ds_read_b64_tr_b16 v[80:81], v8 offset:4096
    ds_read_b64_tr_b16 v[82:83], v8 offset:6144
    v_mfma_f32_16x16x32_bf16 v[28:31], v[100:103], v[68:71], v[28:31]
    ds_read_b64_tr_b16 v[84:85], v9 offset:4096
    ds_read_b64_tr_b16 v[86:87], v9 offset:6144
    s_barrier
    s_waitcnt lgkmcnt(0)
    v_mfma_f32_16x16x32_bf16 v[16:19], v[72:75], v[40:43], v[16:19]
    ds_read_b64 v[56:57], v13 offset:0
    ds_read_b64 v[58:59], v13 offset:512
    v_mfma_f32_16x16x32_bf16 v[24:27], v[72:75], v[44:47], v[24:27]
    ds_read_b64 v[60:61], v13 offset:2048
    ds_read_b64 v[62:63], v13 offset:2560
    v_mfma_f32_16x16x32_bf16 v[20:23], v[76:79], v[40:43], v[20:23]
    ds_read_b64_tr_b16 v[88:89], v8 offset:8192
    ds_read_b64_tr_b16 v[90:91], v8 offset:10240
    v_mfma_f32_16x16x32_bf16 v[28:31], v[76:79], v[44:47], v[28:31]
    ds_read_b64_tr_b16 v[92:93], v9 offset:8192
    ds_read_b64_tr_b16 v[94:95], v9 offset:10240
    v_mfma_f32_16x16x32_bf16 v[16:19], v[80:83], v[48:51], v[16:19]
    ds_read_b64 v[64:65], v13 offset:1024
    ds_read_b64 v[66:67], v13 offset:1536
    v_mfma_f32_16x16x32_bf16 v[24:27], v[80:83], v[52:55], v[24:27]
    ds_read_b64 v[68:69], v13 offset:3072
    ds_read_b64 v[70:71], v13 offset:3584
    v_mfma_f32_16x16x32_bf16 v[20:23], v[84:87], v[48:51], v[20:23]
    ds_read_b64_tr_b16 v[96:97], v8 offset:12288
    ds_read_b64_tr_b16 v[98:99], v8 offset:14336
    v_mfma_f32_16x16x32_bf16 v[28:31], v[84:87], v[52:55], v[28:31]
    ds_read_b64_tr_b16 v[100:101], v9 offset:12288
    ds_read_b64_tr_b16 v[102:103], v9 offset:14336
    s_waitcnt lgkmcnt(0)
    v_mfma_f32_16x16x32_bf16 v[16:19], v[88:91], v[56:59], v[16:19]
    v_mfma_f32_16x16x32_bf16 v[24:27], v[88:91], v[60:63], v[24:27]
    v_mfma_f32_16x16x32_bf16 v[20:23], v[92:95], v[56:59], v[20:23]
    v_mfma_f32_16x16x32_bf16 v[28:31], v[92:95], v[60:63], v[28:31]
    v_mfma_f32_16x16x32_bf16 v[16:19], v[96:99], v[64:67], v[16:19]
    v_mfma_f32_16x16x32_bf16 v[24:27], v[96:99], v[68:71], v[24:27]
    v_mfma_f32_16x16x32_bf16 v[20:23], v[100:103], v[64:67], v[20:23]
    v_mfma_f32_16x16x32_bf16 v[28:31], v[100:103], v[68:71], v[28:31]
    s_nop 4
    v_pk_add_f32 v[16:17], v[16:17], v[136:137]
    v_pk_add_f32 v[18:19], v[18:19], v[138:139]
    v_cvt_pk_bf16_f32 v40, v16, v17
    v_cvt_pk_bf16_f32 v41, v18, v19
    v_pk_add_f32 v[20:21], v[20:21], v[140:141]
    v_pk_add_f32 v[22:23], v[22:23], v[142:143]
    v_cvt_pk_bf16_f32 v42, v20, v21
    v_cvt_pk_bf16_f32 v43, v22, v23
    s_nop 0
    v_permlane16_swap_b32 v40, v42
    v_permlane16_swap_b32 v41, v43
    buffer_store_dwordx4 v[40:43], v6, s[48:51], s69 offen offset:0
    v_pk_add_f32 v[24:25], v[24:25], v[144:145]
    v_pk_add_f32 v[26:27], v[26:27], v[146:147]
    v_cvt_pk_bf16_f32 v44, v24, v25
    v_cvt_pk_bf16_f32 v45, v26, v27
    v_pk_add_f32 v[28:29], v[28:29], v[148:149]
    v_pk_add_f32 v[30:31], v[30:31], v[150:151]
    v_cvt_pk_bf16_f32 v46, v28, v29
    v_cvt_pk_bf16_f32 v47, v30, v31
    s_nop 0
    v_permlane16_swap_b32 v44, v46
    v_permlane16_swap_b32 v45, v47
    buffer_store_dwordx4 v[44:47], v6, s[48:51], s68 offen offset:0
    s_endpgm
L_HC_a:
    s_and_b32 s63, s55, 1
    s_lshl1_add_u32 s56, s54, s63
    s_lshr_b32 s57, s55, 1
    s_and_b32 s63, s57, 1
    s_lshr_b32 s61, s2, 7
    s_and_b32 s60, s56, 7
    s_lshl1_add_u32 s63, s61, s63
    s_mul_i32 s61, s60, 3
    s_lshr_b32 s61, s61, 1
    s_mul_i32 s78, s63, 3
    s_add_u32 s78, s78, s61
    s_mul_i32 s60, s60, 5
    s_lshr_b32 s60, s60, 3
    s_add_u32 s79, s60, s63
    s_waitcnt lgkmcnt(0)
    s_mov_b32 s20, s4
    s_mov_b32 s21, s5
    s_mov_b32 s22, 2621440
    s_mov_b32 s23, 0x20000
    s_mov_b32 s36, s10
    s_mov_b32 s37, s11
    s_mov_b32 s38, 33554432
    s_mov_b32 s39, 0x20000
    s_mov_b32 s40, s18
    s_mov_b32 s41, s19
    s_mov_b32 s42, 256
    s_mov_b32 s43, 0x20000
    s_mov_b32 s48, s16
    s_mov_b32 s49, s17
    s_mov_b32 s50, 2621440
    s_mov_b32 s51, 0x20000
    s_cmp_ge_u32 s53, 2
    s_cbranch_scc1 L_nl_76
    s_lshl4_add_u32 s60, s54, s55
    s_add_u32 s60, s60, 8
    s_lshl1_add_u32 s60, s60, s53
    s_lshl_b32 s60, s60, 2
    v_lshrrev_b32 v212, 4, v0
    v_add_u32 v212, s60, v212
    v_mul_u32_u24 v213, 1280, v212
    v_and_b32 v214, 15, v0
    v_lshl_add_u32 v213, v214, 4, v213
    buffer_load_dwordx4 v[192:195], v213, s[20:23], 0 offen offset:0
    buffer_load_dwordx4 v[196:199], v213, s[20:23], 0 offen offset:256
    buffer_load_dwordx4 v[200:203], v213, s[20:23], 0 offen offset:512
    buffer_load_dwordx4 v[204:207], v213, s[20:23], 0 offen offset:768
    buffer_load_dwordx4 v[208:211], v213, s[20:23], 0 offen offset:1024
L_nl_76:
    s_getpc_b64 s[32:33]
L_pc_77:
    s_lshr_b32 s60, s2, 3
    s_lshl2_add_u32 s60, s60, s53
    s_mul_i32 s60, s60, 448
    s_min_u32 s60, s60, L_end_a-L_helper_a-448
    s_sub_u32 s32, s32, L_pc_77-L_helper_a
    s_subb_u32 s33, s33, 0
    s_add_u32 s32, s32, s60
    s_addc_u32 s33, s33, 0
    s_load_dword s101, s[32:33], 0
    s_load_dword s101, s[32:33], 64
    s_load_dword s101, s[32:33], 128
    s_load_dword s101, s[32:33], 192
    s_load_dword s101, s[32:33], 256
    s_load_dword s101, s[32:33], 320
    s_load_dword s101, s[32:33], 384
    s_lshr_b32 s63, s53, 1
    s_mul_i32 s63, s63, 6
    v_bfe_u32 v2, v0, 2, 3
    v_lshrrev_b32 v3, 5, v0
    v_lshl_add_u32 v3, v3, 4, v2
    v_mul_u32_u24 v3, 384, v3
    v_and_b32 v4, 3, v0
    v_lshl_add_u32 v3, v4, 3, v3
    v_lshrrev_b32 v2, 1, v2
    s_add_u32 s62, s63, 0
    v_xor_b32 v4, s62, v2
    v_lshl_add_u32 v8, v4, 5, v3
    s_add_u32 s62, s63, 1
    v_xor_b32 v4, s62, v2
    v_lshl_add_u32 v9, v4, 5, v3
    s_add_u32 s62, s63, 2
    v_xor_b32 v4, s62, v2
    v_lshl_add_u32 v10, v4, 5, v3
    s_add_u32 s62, s63, 3
    v_xor_b32 v4, s62, v2
    v_lshl_add_u32 v11, v4, 5, v3
    s_and_b32 s60, s53, 1
    s_lshl_b32 s60, s60, 13
    s_add_u32 s60, s60, 24576
    v_and_b32 v2, 15, v0
    v_lshrrev_b32 v15, 1, v2
    v_lshrrev_b32 v14, 4, v0
    v_xor_b32 v14, v14, v15
    v_lshlrev_b32 v14, 4, v14
    v_lshl_add_u32 v14, v2, 7, v14
    v_add_u32 v14, s60, v14
    v_xor_b32 v15, 64, v14
    v_mov_b32 v80, 0
    v_mov_b32 v81, 0
    v_mov_b32 v82, 0
    v_mov_b32 v83, 0
    v_mov_b32 v84, 0
    v_mov_b32 v85, 0
    v_mov_b32 v86, 0
    v_mov_b32 v87, 0
    v_mov_b32 v88, 0
    v_mov_b32 v89, 0
    v_mov_b32 v90, 0
    v_mov_b32 v91, 0
    v_mov_b32 v92, 0
    v_mov_b32 v93, 0
    v_mov_b32 v94, 0
    v_mov_b32 v95, 0
    v_mov_b32 v96, 0
    v_mov_b32 v97, 0
    v_mov_b32 v98, 0
    v_mov_b32 v99, 0
    v_mov_b32 v100, 0
    v_mov_b32 v101, 0
    v_mov_b32 v102, 0
    v_mov_b32 v103, 0
    v_mov_b32 v104, 0
    v_mov_b32 v105, 0
    v_mov_b32 v106, 0
    v_mov_b32 v107, 0
    v_mov_b32 v108, 0
    v_mov_b32 v109, 0
    v_mov_b32 v110, 0
    v_mov_b32 v111, 0
    v_mov_b32 v112, 0
    v_mov_b32 v113, 0
    v_mov_b32 v114, 0
    v_mov_b32 v115, 0
    v_mov_b32 v116, 0
    v_mov_b32 v117, 0
    v_mov_b32 v118, 0
    v_mov_b32 v119, 0
    v_mov_b32 v120, 0
    v_mov_b32 v121, 0
    v_mov_b32 v122, 0
    v_mov_b32 v123, 0
    v_mov_b32 v124, 0
    v_mov_b32 v125, 0
    v_mov_b32 v126, 0
    v_mov_b32 v127, 0
    v_mov_b32 v128, 0
    v_mov_b32 v129, 0
    v_mov_b32 v130, 0
    v_mov_b32 v131, 0
    v_mov_b32 v132, 0
    v_mov_b32 v133, 0
    v_mov_b32 v134, 0
    v_mov_b32 v135, 0
    v_mov_b32 v136, 0
    v_mov_b32 v137, 0
    v_mov_b32 v138, 0
    v_mov_b32 v139, 0
    v_mov_b32 v140, 0
    v_mov_b32 v141, 0
    v_mov_b32 v142, 0
    v_mov_b32 v143, 0
    v_mov_b32 v144, 0
    v_mov_b32 v145, 0
    v_mov_b32 v146, 0
    v_mov_b32 v147, 0
    v_mov_b32 v148, 0
    v_mov_b32 v149, 0
    v_mov_b32 v150, 0
    v_mov_b32 v151, 0
    v_mov_b32 v152, 0
    v_mov_b32 v153, 0
    v_mov_b32 v154, 0
    v_mov_b32 v155, 0
    v_mov_b32 v156, 0
    v_mov_b32 v157, 0
    v_mov_b32 v158, 0
    v_mov_b32 v159, 0
    v_mov_b32 v160, 0
    v_mov_b32 v161, 0
    v_mov_b32 v162, 0
    v_mov_b32 v163, 0
    v_mov_b32 v164, 0
    v_mov_b32 v165, 0
    v_mov_b32 v166, 0
    v_mov_b32 v167, 0
    v_mov_b32 v168, 0
    v_mov_b32 v169, 0
    v_mov_b32 v170, 0
    v_mov_b32 v171, 0
    v_mov_b32 v172, 0
    v_mov_b32 v173, 0
    v_mov_b32 v174, 0
    v_mov_b32 v175, 0
    v_lshrrev_b32 v2, 4, v0
    s_lshr_b32 s62, s53, 1
    s_mul_i32 s61, s62, 384
    s_add_u32 s61, s61, 161920
    v_lshl_add_u32 v16, v2, 4, s61
    v_and_b32 v2, 15, v0
    s_and_b32 s60, s53, 1
    s_lshl_b32 s61, s60, 8
    s_add_u32 s61, s61, 160768
    v_lshl_add_u32 v17, v2, 2, s61
    v_lshlrev_b32 v18, 4, v0
    v_add_u32 v19, 4096, v18
    s_lshl1_add_u32 s60, s54, s60
    s_mul_i32 s60, s60, 196608
    s_mul_i32 s61, s55, 6
    s_mul_i32 s62, s62, 3
    s_add_u32 s61, s61, s62
    s_add_u32 s62, s61, 0
    s_lshr_b32 s63, s62, 1
    s_lshl_b32 s63, s63, 13
    s_and_b32 s62, s62, 1
    s_lshl_b32 s62, s62, 10
    s_add_u32 s66, s60, s63
    s_add_u32 s66, s66, s62
    s_add_u32 s62, s61, 1
    s_lshr_b32 s63, s62, 1
    s_lshl_b32 s63, s63, 13
    s_and_b32 s62, s62, 1
    s_lshl_b32 s62, s62, 10
    s_add_u32 s67, s60, s63
    s_add_u32 s67, s67, s62
    s_add_u32 s62, s61, 2
    s_lshr_b32 s63, s62, 1
    s_lshl_b32 s63, s63, 13
    s_and_b32 s62, s62, 1
    s_lshl_b32 s62, s62, 10
    s_add_u32 s68, s60, s63
    s_add_u32 s68, s68, s62
    v_mov_b32 v2, 163072
    v_mov_b32 v3, 0
    ds_write_b32 v2, v3
    s_cmp_ge_u32 s53, 2
    s_cbranch_scc1 L_ns_75
    v_mov_b32 v214, 0
    v_mov_b32 v215, 0
    v_mov_b32 v213, 0x3f803f80
    v_lshlrev_b32 v212, 3, v212
    v_add_u32 v212, 18874368, v212
    s_waitcnt vmcnt(4)
    v_dot2c_f32_bf16 v214, v192, v213
    v_dot2c_f32_bf16 v215, v192, v192
    v_dot2c_f32_bf16 v214, v193, v213
    v_dot2c_f32_bf16 v215, v193, v193
    v_dot2c_f32_bf16 v214, v194, v213
    v_dot2c_f32_bf16 v215, v194, v194
    v_dot2c_f32_bf16 v214, v195, v213
    v_dot2c_f32_bf16 v215, v195, v195
    s_waitcnt vmcnt(3)
    v_dot2c_f32_bf16 v214, v196, v213
    v_dot2c_f32_bf16 v215, v196, v196
    v_dot2c_f32_bf16 v214, v197, v213
    v_dot2c_f32_bf16 v215, v197, v197
    v_dot2c_f32_bf16 v214, v198, v213
    v_dot2c_f32_bf16 v215, v198, v198
    v_dot2c_f32_bf16 v214, v199, v213
    v_dot2c_f32_bf16 v215, v199, v199
    s_waitcnt vmcnt(2)
    v_dot2c_f32_bf16 v214, v200, v213
    v_dot2c_f32_bf16 v215, v200, v200
    v_dot2c_f32_bf16 v214, v201, v213
    v_dot2c_f32_bf16 v215, v201, v201
    v_dot2c_f32_bf16 v214, v202, v213
    v_dot2c_f32_bf16 v215, v202, v202
    v_dot2c_f32_bf16 v214, v203, v213
    v_dot2c_f32_bf16 v215, v203, v203
    s_waitcnt vmcnt(1)
    v_dot2c_f32_bf16 v214, v204, v213
    v_dot2c_f32_bf16 v215, v204, v204
    v_dot2c_f32_bf16 v214, v205, v213
    v_dot2c_f32_bf16 v215, v205, v205
    v_dot2c_f32_bf16 v214, v206, v213
    v_dot2c_f32_bf16 v215, v206, v206
    v_dot2c_f32_bf16 v214, v207, v213
    v_dot2c_f32_bf16 v215, v207, v207
    s_waitcnt vmcnt(0)
    v_dot2c_f32_bf16 v214, v208, v213
    v_dot2c_f32_bf16 v215, v208, v208
    v_dot2c_f32_bf16 v214, v209, v213
    v_dot2c_f32_bf16 v215, v209, v209
    v_dot2c_f32_bf16 v214, v210, v213
    v_dot2c_f32_bf16 v215, v210, v210
    v_dot2c_f32_bf16 v214, v211, v213
    v_dot2c_f32_bf16 v215, v211, v211
    s_nop 1
    v_add_f32_dpp v214, v214, v214 row_ror:8 row_mask:0xf bank_mask:0xf
    v_add_f32_dpp v215, v215, v215 row_ror:8 row_mask:0xf bank_mask:0xf
    s_nop 0
    v_add_f32_dpp v214, v214, v214 row_ror:4 row_mask:0xf bank_mask:0xf
    v_add_f32_dpp v215, v215, v215 row_ror:4 row_mask:0xf bank_mask:0xf
    s_nop 0
    v_add_f32_dpp v214, v214, v214 row_ror:2 row_mask:0xf bank_mask:0xf
    v_add_f32_dpp v215, v215, v215 row_ror:2 row_mask:0xf bank_mask:0xf
    s_nop 0
    v_add_f32_dpp v214, v214, v214 row_ror:1 row_mask:0xf bank_mask:0xf
    v_add_f32_dpp v215, v215, v215 row_ror:1 row_mask:0xf bank_mask:0xf
    s_mov_b32 s61, 0x3acccccd
    s_mov_b32 s62, 0x3727c5ac
    v_mul_f32 v214, s61, v214
    v_mul_f32 v192, v214, v214
    v_fma_f32 v215, v215, s61, -v192
    v_max_f32 v215, 0, v215
    v_add_f32 v215, s62, v215
    v_rsq_f32 v215, v215
    s_mov_b32 exec_lo, 0x10001
    s_mov_b32 exec_hi, 0x10001
    buffer_store_dwordx2 v[214:215], v212, s[36:39], 0 offen sc0 sc1
    s_mov_b64 exec, -1
L_ns_75:
    s_mov_b32 s64, -40960
    s_mov_b32 s65, 81920
    s_mov_b32 s80, 0
    s_waitcnt lgkmcnt(0)
    s_barrier
    s_cmp_eq_u32 s80, 0
    s_cselect_b32 s80, 3, s80
    s_cselect_b32 s60, s65, s64
    s_sub_u32 s80, s80, 1
    ds_read_b128 v[24:27], v14 offset:0
    ds_read_b64_tr_b16 v[56:57], v8 offset:12288
    ds_read_b64_tr_b16 v[58:59], v8 offset:15360
    ds_read_b128 v[28:31], v14 offset:2048
    ds_read_b128 v[32:35], v14 offset:4096
    ds_read_b128 v[36:39], v14 offset:6144
    v_add_u32 v14, s60, v14
    ds_read_b64_tr_b16 v[60:61], v9 offset:12288
    ds_read_b64_tr_b16 v[62:63], v9 offset:15360
    ds_read_b64_tr_b16 v[64:65], v10 offset:12288
    ds_read_b64_tr_b16 v[66:67], v10 offset:15360
    ds_read_b64_tr_b16 v[68:69], v11 offset:12288
    ds_read_b64_tr_b16 v[70:71], v11 offset:15360
    ds_read_b64_tr_b16 v[72:73], v8 offset:12416
    ds_read_b64_tr_b16 v[74:75], v8 offset:15488
    ds_read_b64_tr_b16 v[76:77], v9 offset:12416
    s_waitcnt lgkmcnt(0)
    s_mov_b32 s59, 9
    s_branch L_ml_78
.p2align 5
    s_nop 0
    s_nop 0
    s_nop 0
L_ml_78:
    s_waitcnt lgkmcnt(5)
    v_mfma_f32_16x16x32_bf16 v[80:83], v[56:59], v[24:27], v[80:83]
    ds_read_b64_tr_b16 v[78:79], v9 offset:15488
    v_mfma_f32_16x16x32_bf16 v[104:107], v[56:59], v[28:31], v[104:107]
    ds_read_b128 v[40:43], v15 offset:0
    v_mfma_f32_16x16x32_bf16 v[128:131], v[56:59], v[32:35], v[128:131]
    v_mfma_f32_16x16x32_bf16 v[152:155], v[56:59], v[36:39], v[152:155]
    ds_read_b64_tr_b16 v[56:57], v8 offset:0
    ds_read_b64_tr_b16 v[58:59], v8 offset:3072
    v_mfma_f32_16x16x32_bf16 v[84:87], v[60:63], v[24:27], v[84:87]
    ds_read_b128 v[44:47], v15 offset:2048
    v_mfma_f32_16x16x32_bf16 v[108:111], v[60:63], v[28:31], v[108:111]
    ds_read_b128 v[48:51], v15 offset:4096
    v_mfma_f32_16x16x32_bf16 v[132:135], v[60:63], v[32:35], v[132:135]
    ds_read_b128 v[52:55], v15 offset:6144
    v_mfma_f32_16x16x32_bf16 v[156:159], v[60:63], v[36:39], v[156:159]
    v_add_u32 v15, s60, v15
    v_mfma_f32_16x16x32_bf16 v[88:91], v[64:67], v[24:27], v[88:91]
    ds_read_b64_tr_b16 v[60:61], v9 offset:0
    v_mfma_f32_16x16x32_bf16 v[112:115], v[64:67], v[28:31], v[112:115]
    ds_read_b64_tr_b16 v[62:63], v9 offset:3072
    v_mfma_f32_16x16x32_bf16 v[136:139], v[64:67], v[32:35], v[136:139]
    v_mfma_f32_16x16x32_bf16 v[160:163], v[64:67], v[36:39], v[160:163]
    ds_read_b64_tr_b16 v[64:65], v10 offset:0
    s_waitcnt lgkmcnt(8)
    v_mfma_f32_16x16x32_bf16 v[92:95], v[68:71], v[24:27], v[92:95]
    ds_read_b64_tr_b16 v[66:67], v10 offset:3072
    v_mfma_f32_16x16x32_bf16 v[116:119], v[68:71], v[28:31], v[116:119]
    v_add_u32 v10, s60, v10
    v_mfma_f32_16x16x32_bf16 v[140:143], v[68:71], v[32:35], v[140:143]
    v_mfma_f32_16x16x32_bf16 v[164:167], v[68:71], v[36:39], v[164:167]
    ds_read_b64_tr_b16 v[68:69], v11 offset:0
    v_mfma_f32_16x16x32_bf16 v[96:99], v[72:75], v[24:27], v[96:99]
    ds_read_b64_tr_b16 v[70:71], v11 offset:3072
    v_mfma_f32_16x16x32_bf16 v[120:123], v[72:75], v[28:31], v[120:123]
    v_add_u32 v11, s60, v11
    v_mfma_f32_16x16x32_bf16 v[144:147], v[72:75], v[32:35], v[144:147]
    v_mfma_f32_16x16x32_bf16 v[168:171], v[72:75], v[36:39], v[168:171]
    ds_read_b64_tr_b16 v[72:73], v8 offset:128
    v_mfma_f32_16x16x32_bf16 v[100:103], v[76:79], v[24:27], v[100:103]
    ds_read_b64_tr_b16 v[74:75], v8 offset:3200
    v_mfma_f32_16x16x32_bf16 v[124:127], v[76:79], v[28:31], v[124:127]
    s_sub_u32 s59, s59, 1
    v_mfma_f32_16x16x32_bf16 v[148:151], v[76:79], v[32:35], v[148:151]
    v_add_u32 v8, s60, v8
    v_mfma_f32_16x16x32_bf16 v[172:175], v[76:79], v[36:39], v[172:175]
    s_waitcnt vmcnt(0) lgkmcnt(4)
    s_barrier
    s_cbranch_scc1 L_tl_79
    v_mfma_f32_16x16x32_bf16 v[80:83], v[56:59], v[40:43], v[80:83]
    ds_read_b64_tr_b16 v[76:77], v9 offset:128
    v_mfma_f32_16x16x32_bf16 v[104:107], v[56:59], v[44:47], v[104:107]
    ds_read_b64_tr_b16 v[78:79], v9 offset:3200
    v_mfma_f32_16x16x32_bf16 v[128:131], v[56:59], v[48:51], v[128:131]
    v_add_u32 v9, s60, v9
    v_mfma_f32_16x16x32_bf16 v[152:155], v[56:59], v[52:55], v[152:155]
    s_cmp_eq_u32 s80, 0
    ds_read_b128 v[24:27], v14 offset:0
    v_mfma_f32_16x16x32_bf16 v[84:87], v[60:63], v[40:43], v[84:87]
    s_cselect_b32 s80, 3, s80
    ds_read_b64_tr_b16 v[56:57], v8 offset:12288
    v_mfma_f32_16x16x32_bf16 v[108:111], v[60:63], v[44:47], v[108:111]
    s_cselect_b32 s60, s65, s64
    ds_read_b64_tr_b16 v[58:59], v8 offset:15360
    v_mfma_f32_16x16x32_bf16 v[132:135], v[60:63], v[48:51], v[132:135]
    s_sub_u32 s80, s80, 1
    v_mfma_f32_16x16x32_bf16 v[156:159], v[60:63], v[52:55], v[156:159]
    ds_read_b128 v[28:31], v14 offset:2048
    ds_read_b128 v[32:35], v14 offset:4096
    v_mfma_f32_16x16x32_bf16 v[88:91], v[64:67], v[40:43], v[88:91]
    ds_read_b128 v[36:39], v14 offset:6144
    v_mfma_f32_16x16x32_bf16 v[112:115], v[64:67], v[44:47], v[112:115]
    v_add_u32 v14, s60, v14
    v_mfma_f32_16x16x32_bf16 v[136:139], v[64:67], v[48:51], v[136:139]
    ds_read_b64_tr_b16 v[60:61], v9 offset:12288
    v_mfma_f32_16x16x32_bf16 v[160:163], v[64:67], v[52:55], v[160:163]
    ds_read_b64_tr_b16 v[62:63], v9 offset:15360
    s_waitcnt lgkmcnt(8)
    v_mfma_f32_16x16x32_bf16 v[92:95], v[68:71], v[40:43], v[92:95]
    ds_read_b64_tr_b16 v[64:65], v10 offset:12288
    v_mfma_f32_16x16x32_bf16 v[116:119], v[68:71], v[44:47], v[116:119]
    ds_read_b64_tr_b16 v[66:67], v10 offset:15360
    v_mfma_f32_16x16x32_bf16 v[140:143], v[68:71], v[48:51], v[140:143]
    v_mfma_f32_16x16x32_bf16 v[164:167], v[68:71], v[52:55], v[164:167]
    ds_read_b64_tr_b16 v[68:69], v11 offset:12288
    v_mfma_f32_16x16x32_bf16 v[96:99], v[72:75], v[40:43], v[96:99]
    ds_read_b64_tr_b16 v[70:71], v11 offset:15360
    v_mfma_f32_16x16x32_bf16 v[120:123], v[72:75], v[44:47], v[120:123]
    v_mfma_f32_16x16x32_bf16 v[144:147], v[72:75], v[48:51], v[144:147]
    v_mfma_f32_16x16x32_bf16 v[168:171], v[72:75], v[52:55], v[168:171]
    ds_read_b64_tr_b16 v[72:73], v8 offset:12416
    v_mfma_f32_16x16x32_bf16 v[100:103], v[76:79], v[40:43], v[100:103]
    ds_read_b64_tr_b16 v[74:75], v8 offset:15488
    v_mfma_f32_16x16x32_bf16 v[124:127], v[76:79], v[44:47], v[124:127]
    v_mfma_f32_16x16x32_bf16 v[148:151], v[76:79], v[48:51], v[148:151]
    v_mfma_f32_16x16x32_bf16 v[172:175], v[76:79], v[52:55], v[172:175]
    ds_read_b64_tr_b16 v[76:77], v9 offset:12416
    s_branch L_ml_78
L_tl_79:
    v_mfma_f32_16x16x32_bf16 v[80:83], v[56:59], v[40:43], v[80:83]
    ds_read_b64_tr_b16 v[76:77], v9 offset:128
    ds_read_b64_tr_b16 v[78:79], v9 offset:3200
    v_mfma_f32_16x16x32_bf16 v[104:107], v[56:59], v[44:47], v[104:107]
    ds_read2_b32 v[216:217], v17 offset0:0 offset1:144
    ds_read2_b32 v[218:219], v17 offset0:16 offset1:160
    v_mfma_f32_16x16x32_bf16 v[128:131], v[56:59], v[48:51], v[128:131]
    ds_read2_b32 v[220:221], v17 offset0:32 offset1:176
    ds_read2_b32 v[222:223], v17 offset0:48 offset1:192
    v_mfma_f32_16x16x32_bf16 v[152:155], v[56:59], v[52:55], v[152:155]
    ds_read_b128 v[176:179], v16 offset:0
    ds_read_b128 v[180:183], v16 offset:64
    v_mfma_f32_16x16x32_bf16 v[84:87], v[60:63], v[40:43], v[84:87]
    ds_read_b128 v[184:187], v16 offset:128
    ds_read_b128 v[188:191], v16 offset:192
    v_mfma_f32_16x16x32_bf16 v[108:111], v[60:63], v[44:47], v[108:111]
    ds_read_b128 v[192:195], v16 offset:256
    ds_read_b128 v[196:199], v16 offset:320
    v_mfma_f32_16x16x32_bf16 v[132:135], v[60:63], v[48:51], v[132:135]
    v_mfma_f32_16x16x32_bf16 v[156:159], v[60:63], v[52:55], v[156:159]
    v_mfma_f32_16x16x32_bf16 v[88:91], v[64:67], v[40:43], v[88:91]
    v_mfma_f32_16x16x32_bf16 v[112:115], v[64:67], v[44:47], v[112:115]
    v_mfma_f32_16x16x32_bf16 v[136:139], v[64:67], v[48:51], v[136:139]
    v_mfma_f32_16x16x32_bf16 v[160:163], v[64:67], v[52:55], v[160:163]
    s_waitcnt lgkmcnt(10)
    v_mfma_f32_16x16x32_bf16 v[92:95], v[68:71], v[40:43], v[92:95]
    v_mfma_f32_16x16x32_bf16 v[116:119], v[68:71], v[44:47], v[116:119]
    v_mfma_f32_16x16x32_bf16 v[140:143], v[68:71], v[48:51], v[140:143]
    v_mfma_f32_16x16x32_bf16 v[164:167], v[68:71], v[52:55], v[164:167]
    v_mfma_f32_16x16x32_bf16 v[96:99], v[72:75], v[40:43], v[96:99]
    v_mfma_f32_16x16x32_bf16 v[120:123], v[72:75], v[44:47], v[120:123]
    v_mfma_f32_16x16x32_bf16 v[144:147], v[72:75], v[48:51], v[144:147]
    v_mfma_f32_16x16x32_bf16 v[168:171], v[72:75], v[52:55], v[168:171]
    v_mfma_f32_16x16x32_bf16 v[100:103], v[76:79], v[40:43], v[100:103]
    v_mfma_f32_16x16x32_bf16 v[124:127], v[76:79], v[44:47], v[124:127]
    v_mfma_f32_16x16x32_bf16 v[148:151], v[76:79], v[48:51], v[148:151]
    v_mfma_f32_16x16x32_bf16 v[172:175], v[76:79], v[52:55], v[172:175]
    s_waitcnt lgkmcnt(0)
    v_pk_fma_f32 v[80:81], v[176:177], v[216:217], v[80:81] op_sel_hi:[1,0,1] neg_lo:[0,1,0] neg_hi:[0,1,0]
    v_pk_fma_f32 v[82:83], v[178:179], v[216:217], v[82:83] op_sel_hi:[1,0,1] neg_lo:[0,1,0] neg_hi:[0,1,0]
    v_cvt_pk_bf16_f32 v224, v80, v81
    v_cvt_pk_bf16_f32 v225, v82, v83
    v_pk_fma_f32 v[84:85], v[180:181], v[216:217], v[84:85] op_sel_hi:[1,0,1] neg_lo:[0,1,0] neg_hi:[0,1,0]
    v_pk_fma_f32 v[86:87], v[182:183], v[216:217], v[86:87] op_sel_hi:[1,0,1] neg_lo:[0,1,0] neg_hi:[0,1,0]
    v_cvt_pk_bf16_f32 v226, v84, v85
    v_cvt_pk_bf16_f32 v227, v86, v87
    v_pk_max_i16 v224, v224, 0
    v_pk_max_i16 v225, v225, 0
    v_pk_max_i16 v226, v226, 0
    v_pk_max_i16 v227, v227, 0
    buffer_store_dwordx4 v[224:227], v18, s[36:39], s66 offen offset:0 sc0 sc1
    v_pk_fma_f32 v[104:105], v[176:177], v[218:219], v[104:105] op_sel_hi:[1,0,1] neg_lo:[0,1,0] neg_hi:[0,1,0]
    v_pk_fma_f32 v[106:107], v[178:179], v[218:219], v[106:107] op_sel_hi:[1,0,1] neg_lo:[0,1,0] neg_hi:[0,1,0]
    v_cvt_pk_bf16_f32 v228, v104, v105
    v_cvt_pk_bf16_f32 v229, v106, v107
    v_pk_fma_f32 v[108:109], v[180:181], v[218:219], v[108:109] op_sel_hi:[1,0,1] neg_lo:[0,1,0] neg_hi:[0,1,0]
    v_pk_fma_f32 v[110:111], v[182:183], v[218:219], v[110:111] op_sel_hi:[1,0,1] neg_lo:[0,1,0] neg_hi:[0,1,0]
    v_cvt_pk_bf16_f32 v230, v108, v109
    v_cvt_pk_bf16_f32 v231, v110, v111
    v_pk_max_i16 v228, v228, 0
    v_pk_max_i16 v229, v229, 0
    v_pk_max_i16 v230, v230, 0
    v_pk_max_i16 v231, v231, 0
    buffer_store_dwordx4 v[228:231], v18, s[36:39], s66 offen offset:2048 sc0 sc1
    v_pk_fma_f32 v[128:129], v[176:177], v[220:221], v[128:129] op_sel_hi:[1,0,1] neg_lo:[0,1,0] neg_hi:[0,1,0]
    v_pk_fma_f32 v[130:131], v[178:179], v[220:221], v[130:131] op_sel_hi:[1,0,1] neg_lo:[0,1,0] neg_hi:[0,1,0]
    v_cvt_pk_bf16_f32 v232, v128, v129
    v_cvt_pk_bf16_f32 v233, v130, v131
    v_pk_fma_f32 v[132:133], v[180:181], v[220:221], v[132:133] op_sel_hi:[1,0,1] neg_lo:[0,1,0] neg_hi:[0,1,0]
    v_pk_fma_f32 v[134:135], v[182:183], v[220:221], v[134:135] op_sel_hi:[1,0,1] neg_lo:[0,1,0] neg_hi:[0,1,0]
    v_cvt_pk_bf16_f32 v234, v132, v133
    v_cvt_pk_bf16_f32 v235, v134, v135
    v_pk_max_i16 v232, v232, 0
    v_pk_max_i16 v233, v233, 0
    v_pk_max_i16 v234, v234, 0
    v_pk_max_i16 v235, v235, 0
    buffer_store_dwordx4 v[232:235], v19, s[36:39], s66 offen offset:0 sc0 sc1
    v_pk_fma_f32 v[152:153], v[176:177], v[222:223], v[152:153] op_sel_hi:[1,0,1] neg_lo:[0,1,0] neg_hi:[0,1,0]
    v_pk_fma_f32 v[154:155], v[178:179], v[222:223], v[154:155] op_sel_hi:[1,0,1] neg_lo:[0,1,0] neg_hi:[0,1,0]
    v_cvt_pk_bf16_f32 v236, v152, v153
    v_cvt_pk_bf16_f32 v237, v154, v155
    v_pk_fma_f32 v[156:157], v[180:181], v[222:223], v[156:157] op_sel_hi:[1,0,1] neg_lo:[0,1,0] neg_hi:[0,1,0]
    v_pk_fma_f32 v[158:159], v[182:183], v[222:223], v[158:159] op_sel_hi:[1,0,1] neg_lo:[0,1,0] neg_hi:[0,1,0]
    v_cvt_pk_bf16_f32 v238, v156, v157
    v_cvt_pk_bf16_f32 v239, v158, v159
    v_pk_max_i16 v236, v236, 0
    v_pk_max_i16 v237, v237, 0
    v_pk_max_i16 v238, v238, 0
    v_pk_max_i16 v239, v239, 0
    buffer_store_dwordx4 v[236:239], v19, s[36:39], s66 offen offset:2048 sc0 sc1
    v_pk_fma_f32 v[88:89], v[184:185], v[216:217], v[88:89] op_sel_hi:[1,0,1] neg_lo:[0,1,0] neg_hi:[0,1,0]
    v_pk_fma_f32 v[90:91], v[186:187], v[216:217], v[90:91] op_sel_hi:[1,0,1] neg_lo:[0,1,0] neg_hi:[0,1,0]
    v_cvt_pk_bf16_f32 v240, v88, v89
    v_cvt_pk_bf16_f32 v241, v90, v91
    v_pk_fma_f32 v[92:93], v[188:189], v[216:217], v[92:93] op_sel_hi:[1,0,1] neg_lo:[0,1,0] neg_hi:[0,1,0]
    v_pk_fma_f32 v[94:95], v[190:191], v[216:217], v[94:95] op_sel_hi:[1,0,1] neg_lo:[0,1,0] neg_hi:[0,1,0]
    v_cvt_pk_bf16_f32 v242, v92, v93
    v_cvt_pk_bf16_f32 v243, v94, v95
    v_pk_max_i16 v240, v240, 0
    v_pk_max_i16 v241, v241, 0
    v_pk_max_i16 v242, v242, 0
    v_pk_max_i16 v243, v243, 0
    buffer_store_dwordx4 v[240:243], v18, s[36:39], s67 offen offset:0 sc0 sc1
    v_pk_fma_f32 v[112:113], v[184:185], v[218:219], v[112:113] op_sel_hi:[1,0,1] neg_lo:[0,1,0] neg_hi:[0,1,0]
    v_pk_fma_f32 v[114:115], v[186:187], v[218:219], v[114:115] op_sel_hi:[1,0,1] neg_lo:[0,1,0] neg_hi:[0,1,0]
    v_cvt_pk_bf16_f32 v244, v112, v113
    v_cvt_pk_bf16_f32 v245, v114, v115
    v_pk_fma_f32 v[116:117], v[188:189], v[218:219], v[116:117] op_sel_hi:[1,0,1] neg_lo:[0,1,0] neg_hi:[0,1,0]
    v_pk_fma_f32 v[118:119], v[190:191], v[218:219], v[118:119] op_sel_hi:[1,0,1] neg_lo:[0,1,0] neg_hi:[0,1,0]
    v_cvt_pk_bf16_f32 v246, v116, v117
    v_cvt_pk_bf16_f32 v247, v118, v119
    v_pk_max_i16 v244, v244, 0
    v_pk_max_i16 v245, v245, 0
    v_pk_max_i16 v246, v246, 0
    v_pk_max_i16 v247, v247, 0
    buffer_store_dwordx4 v[244:247], v18, s[36:39], s67 offen offset:2048 sc0 sc1
    v_pk_fma_f32 v[136:137], v[184:185], v[220:221], v[136:137] op_sel_hi:[1,0,1] neg_lo:[0,1,0] neg_hi:[0,1,0]
    v_pk_fma_f32 v[138:139], v[186:187], v[220:221], v[138:139] op_sel_hi:[1,0,1] neg_lo:[0,1,0] neg_hi:[0,1,0]
    v_cvt_pk_bf16_f32 v224, v136, v137
    v_cvt_pk_bf16_f32 v225, v138, v139
    v_pk_fma_f32 v[140:141], v[188:189], v[220:221], v[140:141] op_sel_hi:[1,0,1] neg_lo:[0,1,0] neg_hi:[0,1,0]
    v_pk_fma_f32 v[142:143], v[190:191], v[220:221], v[142:143] op_sel_hi:[1,0,1] neg_lo:[0,1,0] neg_hi:[0,1,0]
    v_cvt_pk_bf16_f32 v226, v140, v141
    v_cvt_pk_bf16_f32 v227, v142, v143
    v_pk_max_i16 v224, v224, 0
    v_pk_max_i16 v225, v225, 0
    v_pk_max_i16 v226, v226, 0
    v_pk_max_i16 v227, v227, 0
    buffer_store_dwordx4 v[224:227], v19, s[36:39], s67 offen offset:0 sc0 sc1
    v_pk_fma_f32 v[160:161], v[184:185], v[222:223], v[160:161] op_sel_hi:[1,0,1] neg_lo:[0,1,0] neg_hi:[0,1,0]
    v_pk_fma_f32 v[162:163], v[186:187], v[222:223], v[162:163] op_sel_hi:[1,0,1] neg_lo:[0,1,0] neg_hi:[0,1,0]
    v_cvt_pk_bf16_f32 v228, v160, v161
    v_cvt_pk_bf16_f32 v229, v162, v163
    v_pk_fma_f32 v[164:165], v[188:189], v[222:223], v[164:165] op_sel_hi:[1,0,1] neg_lo:[0,1,0] neg_hi:[0,1,0]
    v_pk_fma_f32 v[166:167], v[190:191], v[222:223], v[166:167] op_sel_hi:[1,0,1] neg_lo:[0,1,0] neg_hi:[0,1,0]
    v_cvt_pk_bf16_f32 v230, v164, v165
    v_cvt_pk_bf16_f32 v231, v166, v167
    v_pk_max_i16 v228, v228, 0
    v_pk_max_i16 v229, v229, 0
    v_pk_max_i16 v230, v230, 0
    v_pk_max_i16 v231, v231, 0
    buffer_store_dwordx4 v[228:231], v19, s[36:39], s67 offen offset:2048 sc0 sc1
    v_pk_fma_f32 v[96:97], v[192:193], v[216:217], v[96:97] op_sel_hi:[1,0,1] neg_lo:[0,1,0] neg_hi:[0,1,0]
    v_pk_fma_f32 v[98:99], v[194:195], v[216:217], v[98:99] op_sel_hi:[1,0,1] neg_lo:[0,1,0] neg_hi:[0,1,0]
    v_cvt_pk_bf16_f32 v232, v96, v97
    v_cvt_pk_bf16_f32 v233, v98, v99
    v_pk_fma_f32 v[100:101], v[196:197], v[216:217], v[100:101] op_sel_hi:[1,0,1] neg_lo:[0,1,0] neg_hi:[0,1,0]
    v_pk_fma_f32 v[102:103], v[198:199], v[216:217], v[102:103] op_sel_hi:[1,0,1] neg_lo:[0,1,0] neg_hi:[0,1,0]
    v_cvt_pk_bf16_f32 v234, v100, v101
    v_cvt_pk_bf16_f32 v235, v102, v103
    v_pk_max_i16 v232, v232, 0
    v_pk_max_i16 v233, v233, 0
    v_pk_max_i16 v234, v234, 0
    v_pk_max_i16 v235, v235, 0
    buffer_store_dwordx4 v[232:235], v18, s[36:39], s68 offen offset:0 sc0 sc1
    v_pk_fma_f32 v[120:121], v[192:193], v[218:219], v[120:121] op_sel_hi:[1,0,1] neg_lo:[0,1,0] neg_hi:[0,1,0]
    v_pk_fma_f32 v[122:123], v[194:195], v[218:219], v[122:123] op_sel_hi:[1,0,1] neg_lo:[0,1,0] neg_hi:[0,1,0]
    v_cvt_pk_bf16_f32 v236, v120, v121
    v_cvt_pk_bf16_f32 v237, v122, v123
    v_pk_fma_f32 v[124:125], v[196:197], v[218:219], v[124:125] op_sel_hi:[1,0,1] neg_lo:[0,1,0] neg_hi:[0,1,0]
    v_pk_fma_f32 v[126:127], v[198:199], v[218:219], v[126:127] op_sel_hi:[1,0,1] neg_lo:[0,1,0] neg_hi:[0,1,0]
    v_cvt_pk_bf16_f32 v238, v124, v125
    v_cvt_pk_bf16_f32 v239, v126, v127
    v_pk_max_i16 v236, v236, 0
    v_pk_max_i16 v237, v237, 0
    v_pk_max_i16 v238, v238, 0
    v_pk_max_i16 v239, v239, 0
    buffer_store_dwordx4 v[236:239], v18, s[36:39], s68 offen offset:2048 sc0 sc1
    v_pk_fma_f32 v[144:145], v[192:193], v[220:221], v[144:145] op_sel_hi:[1,0,1] neg_lo:[0,1,0] neg_hi:[0,1,0]
    v_pk_fma_f32 v[146:147], v[194:195], v[220:221], v[146:147] op_sel_hi:[1,0,1] neg_lo:[0,1,0] neg_hi:[0,1,0]
    v_cvt_pk_bf16_f32 v240, v144, v145
    v_cvt_pk_bf16_f32 v241, v146, v147
    v_pk_fma_f32 v[148:149], v[196:197], v[220:221], v[148:149] op_sel_hi:[1,0,1] neg_lo:[0,1,0] neg_hi:[0,1,0]
    v_pk_fma_f32 v[150:151], v[198:199], v[220:221], v[150:151] op_sel_hi:[1,0,1] neg_lo:[0,1,0] neg_hi:[0,1,0]
    v_cvt_pk_bf16_f32 v242, v148, v149
    v_cvt_pk_bf16_f32 v243, v150, v151
    v_pk_max_i16 v240, v240, 0
    v_pk_max_i16 v241, v241, 0
    v_pk_max_i16 v242, v242, 0
    v_pk_max_i16 v243, v243, 0
    buffer_store_dwordx4 v[240:243], v19, s[36:39], s68 offen offset:0 sc0 sc1
    v_pk_fma_f32 v[168:169], v[192:193], v[222:223], v[168:169] op_sel_hi:[1,0,1] neg_lo:[0,1,0] neg_hi:[0,1,0]
    v_pk_fma_f32 v[170:171], v[194:195], v[222:223], v[170:171] op_sel_hi:[1,0,1] neg_lo:[0,1,0] neg_hi:[0,1,0]
    v_cvt_pk_bf16_f32 v244, v168, v169
    v_cvt_pk_bf16_f32 v245, v170, v171
    v_pk_fma_f32 v[172:173], v[196:197], v[222:223], v[172:173] op_sel_hi:[1,0,1] neg_lo:[0,1,0] neg_hi:[0,1,0]
    v_pk_fma_f32 v[174:175], v[198:199], v[222:223], v[174:175] op_sel_hi:[1,0,1] neg_lo:[0,1,0] neg_hi:[0,1,0]
    v_cvt_pk_bf16_f32 v246, v172, v173
    v_cvt_pk_bf16_f32 v247, v174, v175
    v_pk_max_i16 v244, v244, 0
    v_pk_max_i16 v245, v245, 0
    v_pk_max_i16 v246, v246, 0
    v_pk_max_i16 v247, v247, 0
    buffer_store_dwordx4 v[244:247], v19, s[36:39], s68 offen offset:2048 sc0 sc1
    v_lshrrev_b32 v3, 4, v0
    v_bfe_u32 v2, v0, 2, 2
    v_lshl_add_u32 v2, v3, 2, v2
    v_mul_u32_u24 v4, 192, v2
    v_and_b32 v5, 3, v0
    v_lshl_add_u32 v4, v5, 3, v4
    v_and_b32 v2, 1, v3
    s_lshr_b32 s60, s53, 1
    s_mul_i32 s60, s60, 3
    s_add_u32 s61, s60, 0
    v_xor_b32 v3, s61, v2
    v_lshl_add_u32 v3, v3, 5, v4
    v_add_u32 v8, 61440, v3
    v_add_u32 v11, 110592, v3
    s_add_u32 s61, s60, 1
    v_xor_b32 v3, s61, v2
    v_lshl_add_u32 v3, v3, 5, v4
    v_add_u32 v9, 61440, v3
    v_add_u32 v12, 110592, v3
    s_add_u32 s61, s60, 2
    v_xor_b32 v3, s61, v2
    v_lshl_add_u32 v3, v3, 5, v4
    v_add_u32 v10, 61440, v3
    v_add_u32 v13, 110592, v3
    s_barrier
    ds_read_b64_tr_b16 v[160:161], v11 offset:36864
    ds_read_b64_tr_b16 v[162:163], v11 offset:39936
    ds_read_b64_tr_b16 v[164:165], v12 offset:36864
    ds_read_b64_tr_b16 v[166:167], v12 offset:39936
    ds_read_b64_tr_b16 v[168:169], v13 offset:36864
    ds_read_b64_tr_b16 v[170:171], v13 offset:39936
    ds_read_b64_tr_b16 v[172:173], v11 offset:43008
    ds_read_b64_tr_b16 v[174:175], v11 offset:46080
    ds_read_b64_tr_b16 v[176:177], v12 offset:43008
    ds_read_b64_tr_b16 v[178:179], v12 offset:46080
    ds_read_b64_tr_b16 v[180:181], v13 offset:43008
    ds_read_b64_tr_b16 v[182:183], v13 offset:46080
    ds_read_b64_tr_b16 v[184:185], v11 offset:24576
    ds_read_b64_tr_b16 v[186:187], v11 offset:27648
    ds_read_b64_tr_b16 v[188:189], v12 offset:24576
    ds_read_b64_tr_b16 v[190:191], v12 offset:27648
    ds_read_b64_tr_b16 v[192:193], v13 offset:24576
    ds_read_b64_tr_b16 v[194:195], v13 offset:27648
    ds_read_b64_tr_b16 v[196:197], v11 offset:30720
    ds_read_b64_tr_b16 v[198:199], v11 offset:33792
    ds_read_b64_tr_b16 v[200:201], v12 offset:30720
    ds_read_b64_tr_b16 v[202:203], v12 offset:33792
    ds_read_b64_tr_b16 v[204:205], v13 offset:30720
    ds_read_b64_tr_b16 v[206:207], v13 offset:33792
    ds_read_b64_tr_b16 v[208:209], v11 offset:12288
    ds_read_b64_tr_b16 v[210:211], v11 offset:15360
    ds_read_b64_tr_b16 v[212:213], v12 offset:12288
    ds_read_b64_tr_b16 v[214:215], v12 offset:15360
    ds_read_b64_tr_b16 v[216:217], v13 offset:12288
    ds_read_b64_tr_b16 v[218:219], v13 offset:15360
    ds_read_b64_tr_b16 v[220:221], v11 offset:18432
    ds_read_b64_tr_b16 v[222:223], v11 offset:21504
    ds_read_b64_tr_b16 v[224:225], v12 offset:18432
    ds_read_b64_tr_b16 v[226:227], v12 offset:21504
    ds_read_b64_tr_b16 v[228:229], v13 offset:18432
    ds_read_b64_tr_b16 v[230:231], v13 offset:21504
    ds_read_b64_tr_b16 v[232:233], v11 offset:0
    ds_read_b64_tr_b16 v[234:235], v11 offset:3072
    ds_read_b64_tr_b16 v[236:237], v12 offset:0
    ds_read_b64_tr_b16 v[238:239], v12 offset:3072
    ds_read_b64_tr_b16 v[240:241], v13 offset:0
    ds_read_b64_tr_b16 v[242:243], v13 offset:3072
    ds_read_b64_tr_b16 v[244:245], v11 offset:6144
    ds_read_b64_tr_b16 v[246:247], v11 offset:9216
    ds_read_b64_tr_b16 v[248:249], v12 offset:6144
    ds_read_b64_tr_b16 v[250:251], v12 offset:9216
    ds_read_b64_tr_b16 v[252:253], v13 offset:6144
    ds_read_b64_tr_b16 v[254:255], v13 offset:9216
    v_mov_b32 v4, 163072
    v_mov_b32 v5, 1
    s_waitcnt vmcnt(0)
    s_mov_b64 exec, 1
    ds_add_rtn_u32 v1, v4, v5
    s_mov_b64 exec, -1
    s_lshr_b32 s60, s55, 2
    s_lshl2_add_u32 s60, s54, s60
    s_lshl_b32 s60, s60, 7
    s_add_u32 s60, s60, 16777216
    v_mov_b32 v4, s60
    s_waitcnt lgkmcnt(0)
    v_readfirstlane_b32 s60, v1
    s_nop 0
    s_cmp_lg_u32 s60, 3
    s_cbranch_scc1 L_pb_80
    s_mov_b64 exec, 1
    buffer_atomic_add v5, v4, s[36:39], 0 offen sc1
    s_mov_b64 exec, -1
L_pb_80:
    s_barrier
    s_mul_i32 s57, s57, 192
    s_and_b32 s60, s53, 1
    s_lshl1_add_u32 s60, s56, s60
    s_mul_i32 s60, s60, 40960
    s_add_u32 s60, s60, s57
    s_lshr_b32 s61, s53, 1
    s_mul_i32 s61, s61, 96
    s_add_u32 s69, s60, s61
    s_add_u32 s68, s69, 20480
    v_and_b32 v2, 15, v0
    v_mul_u32_u24 v2, 1280, v2
    v_lshrrev_b32 v3, 5, v0
    v_lshl_add_u32 v2, v3, 4, v2
    v_bfe_u32 v3, v0, 4, 1
    v_lshl_add_u32 v6, v3, 5, v2
    v_mul_u32_u24 v3, 20480, v3
    v_add_u32 v7, v2, v3
    s_and_b32 s60, s53, 1
    s_lshl_b32 s60, s60, 12
    s_add_u32 s60, s60, 12288
    v_lshl_add_u32 v14, v0, 4, s60
    v_lshl_add_u32 v15, v0, 3, s60
    s_barrier
    s_waitcnt lgkmcnt(0)
    ds_read_b128 v[40:43], v14 offset:40960
    ds_read_b128 v[44:47], v14 offset:43008
    ds_read_b128 v[48:51], v14 offset:41984
    ds_read_b128 v[52:55], v14 offset:44032
    s_barrier
    s_waitcnt lgkmcnt(0)
    v_mfma_f32_16x16x32_bf16 v[16:19], v[160:163], v[40:43], 0
    ds_read_b128 v[56:59], v14 offset:32768
    ds_read_b128 v[60:63], v14 offset:34816
    v_mfma_f32_16x16x32_bf16 v[28:31], v[160:163], v[44:47], 0
    ds_read_b128 v[64:67], v14 offset:33792
    ds_read_b128 v[68:71], v14 offset:35840
    v_mfma_f32_16x16x32_bf16 v[20:23], v[164:167], v[40:43], 0
    v_mfma_f32_16x16x32_bf16 v[32:35], v[164:167], v[44:47], 0
    v_mfma_f32_16x16x32_bf16 v[24:27], v[168:171], v[40:43], 0
    v_mfma_f32_16x16x32_bf16 v[36:39], v[168:171], v[44:47], 0
    v_mfma_f32_16x16x32_bf16 v[16:19], v[172:175], v[48:51], v[16:19]
    v_mfma_f32_16x16x32_bf16 v[28:31], v[172:175], v[52:55], v[28:31]
    v_mfma_f32_16x16x32_bf16 v[20:23], v[176:179], v[48:51], v[20:23]
    v_mfma_f32_16x16x32_bf16 v[32:35], v[176:179], v[52:55], v[32:35]
    v_mfma_f32_16x16x32_bf16 v[24:27], v[180:183], v[48:51], v[24:27]
    v_mfma_f32_16x16x32_bf16 v[36:39], v[180:183], v[52:55], v[36:39]
    s_barrier
    s_waitcnt lgkmcnt(0)
    v_mfma_f32_16x16x32_bf16 v[16:19], v[184:187], v[56:59], v[16:19]
    ds_read_b128 v[40:43], v14 offset:24576
    ds_read_b128 v[44:47], v14 offset:26624
    v_mfma_f32_16x16x32_bf16 v[28:31], v[184:187], v[60:63], v[28:31]
    ds_read_b128 v[48:51], v14 offset:25600
    ds_read_b128 v[52:55], v14 offset:27648
    v_mfma_f32_16x16x32_bf16 v[20:23], v[188:191], v[56:59], v[20:23]
    buffer_load_dwordx4 v[120:123], v6, s[20:23], s69 offen offset:0
    v_mfma_f32_16x16x32_bf16 v[32:35], v[188:191], v[60:63], v[32:35]
    v_mfma_f32_16x16x32_bf16 v[24:27], v[192:195], v[56:59], v[24:27]
    v_mfma_f32_16x16x32_bf16 v[36:39], v[192:195], v[60:63], v[36:39]
    v_mfma_f32_16x16x32_bf16 v[16:19], v[196:199], v[64:67], v[16:19]
    v_mfma_f32_16x16x32_bf16 v[28:31], v[196:199], v[68:71], v[28:31]
    v_mfma_f32_16x16x32_bf16 v[20:23], v[200:203], v[64:67], v[20:23]
    v_mfma_f32_16x16x32_bf16 v[32:35], v[200:203], v[68:71], v[32:35]
    v_mfma_f32_16x16x32_bf16 v[24:27], v[204:207], v[64:67], v[24:27]
    v_mfma_f32_16x16x32_bf16 v[36:39], v[204:207], v[68:71], v[36:39]
    s_barrier
    s_waitcnt lgkmcnt(0)
    v_mfma_f32_16x16x32_bf16 v[16:19], v[208:211], v[40:43], v[16:19]
    ds_read_b128 v[56:59], v14 offset:16384
    ds_read_b128 v[60:63], v14 offset:18432
    v_mfma_f32_16x16x32_bf16 v[28:31], v[208:211], v[44:47], v[28:31]
    ds_read_b128 v[64:67], v14 offset:17408
    ds_read_b128 v[68:71], v14 offset:19456
    v_mfma_f32_16x16x32_bf16 v[20:23], v[212:215], v[40:43], v[20:23]
    buffer_load_dwordx4 v[124:127], v6, s[20:23], s68 offen offset:0
    v_mfma_f32_16x16x32_bf16 v[32:35], v[212:215], v[44:47], v[32:35]
    v_mfma_f32_16x16x32_bf16 v[24:27], v[216:219], v[40:43], v[24:27]
    v_mfma_f32_16x16x32_bf16 v[36:39], v[216:219], v[44:47], v[36:39]
    v_mfma_f32_16x16x32_bf16 v[16:19], v[220:223], v[48:51], v[16:19]
    v_mfma_f32_16x16x32_bf16 v[28:31], v[220:223], v[52:55], v[28:31]
    v_mfma_f32_16x16x32_bf16 v[20:23], v[224:227], v[48:51], v[20:23]
    v_mfma_f32_16x16x32_bf16 v[32:35], v[224:227], v[52:55], v[32:35]
    v_mfma_f32_16x16x32_bf16 v[24:27], v[228:231], v[48:51], v[24:27]
    v_mfma_f32_16x16x32_bf16 v[36:39], v[228:231], v[52:55], v[36:39]
    s_barrier
    s_waitcnt lgkmcnt(0)
    v_mfma_f32_16x16x32_bf16 v[16:19], v[232:235], v[56:59], v[16:19]
    ds_read_b128 v[40:43], v14 offset:8192
    ds_read_b128 v[44:47], v14 offset:10240
    v_mfma_f32_16x16x32_bf16 v[28:31], v[232:235], v[60:63], v[28:31]
    ds_read_b64_tr_b16 v[72:73], v8 offset:36864
    ds_read_b64_tr_b16 v[74:75], v8 offset:39936
    v_mfma_f32_16x16x32_bf16 v[20:23], v[236:239], v[56:59], v[20:23]
    ds_read_b64_tr_b16 v[76:77], v9 offset:36864
    ds_read_b64_tr_b16 v[78:79], v9 offset:39936
    v_mfma_f32_16x16x32_bf16 v[32:35], v[236:239], v[60:63], v[32:35]
    ds_read_b64_tr_b16 v[80:81], v10 offset:36864
    ds_read_b64_tr_b16 v[82:83], v10 offset:39936
    v_mfma_f32_16x16x32_bf16 v[24:27], v[240:243], v[56:59], v[24:27]
    ds_read_b128 v[48:51], v14 offset:9216
    ds_read_b128 v[52:55], v14 offset:11264
    v_mfma_f32_16x16x32_bf16 v[36:39], v[240:243], v[60:63], v[36:39]
    ds_read_b64_tr_b16 v[84:85], v8 offset:43008
    ds_read_b64_tr_b16 v[86:87], v8 offset:46080
    v_mfma_f32_16x16x32_bf16 v[16:19], v[244:247], v[64:67], v[16:19]
    ds_read_b64_tr_b16 v[88:89], v9 offset:43008
    ds_read_b64_tr_b16 v[90:91], v9 offset:46080
    v_mfma_f32_16x16x32_bf16 v[28:31], v[244:247], v[68:71], v[28:31]
    ds_read_b64_tr_b16 v[92:93], v10 offset:43008
    ds_read_b64_tr_b16 v[94:95], v10 offset:46080
    v_mfma_f32_16x16x32_bf16 v[20:23], v[248:251], v[64:67], v[20:23]
    buffer_load_dwordx4 v[128:131], v7, s[20:23], s69 offen offset:64
    v_mfma_f32_16x16x32_bf16 v[32:35], v[248:251], v[68:71], v[32:35]
    v_mfma_f32_16x16x32_bf16 v[24:27], v[252:255], v[64:67], v[24:27]
    v_mfma_f32_16x16x32_bf16 v[36:39], v[252:255], v[68:71], v[36:39]
    s_barrier
    s_waitcnt lgkmcnt(0)
    v_mfma_f32_16x16x32_bf16 v[16:19], v[72:75], v[40:43], v[16:19]
    ds_read_b128 v[56:59], v14 offset:0
    ds_read_b128 v[60:63], v14 offset:2048
    v_mfma_f32_16x16x32_bf16 v[28:31], v[72:75], v[44:47], v[28:31]
    ds_read_b64_tr_b16 v[96:97], v8 offset:24576
    ds_read_b64_tr_b16 v[98:99], v8 offset:27648
    v_mfma_f32_16x16x32_bf16 v[20:23], v[76:79], v[40:43], v[20:23]
    ds_read_b64_tr_b16 v[100:101], v9 offset:24576
    ds_read_b64_tr_b16 v[102:103], v9 offset:27648
    v_mfma_f32_16x16x32_bf16 v[32:35], v[76:79], v[44:47], v[32:35]
    ds_read_b64_tr_b16 v[104:105], v10 offset:24576
    ds_read_b64_tr_b16 v[106:107], v10 offset:27648
    v_mfma_f32_16x16x32_bf16 v[24:27], v[80:83], v[40:43], v[24:27]
    ds_read_b128 v[64:67], v14 offset:1024
    ds_read_b128 v[68:71], v14 offset:3072
    v_mfma_f32_16x16x32_bf16 v[36:39], v[80:83], v[44:47], v[36:39]
    ds_read_b64_tr_b16 v[108:109], v8 offset:30720
    ds_read_b64_tr_b16 v[110:111], v8 offset:33792
    v_mfma_f32_16x16x32_bf16 v[16:19], v[84:87], v[48:51], v[16:19]
    ds_read_b64_tr_b16 v[112:113], v9 offset:30720
    ds_read_b64_tr_b16 v[114:115], v9 offset:33792
    v_mfma_f32_16x16x32_bf16 v[28:31], v[84:87], v[52:55], v[28:31]
    ds_read_b64_tr_b16 v[116:117], v10 offset:30720
    ds_read_b64_tr_b16 v[118:119], v10 offset:33792
    v_mfma_f32_16x16x32_bf16 v[20:23], v[88:91], v[48:51], v[20:23]
    v_mfma_f32_16x16x32_bf16 v[32:35], v[88:91], v[52:55], v[32:35]
    v_mfma_f32_16x16x32_bf16 v[24:27], v[92:95], v[48:51], v[24:27]
    v_mfma_f32_16x16x32_bf16 v[36:39], v[92:95], v[52:55], v[36:39]
    s_barrier
    s_waitcnt lgkmcnt(0)
    v_mfma_f32_16x16x32_bf16 v[16:19], v[96:99], v[56:59], v[16:19]
    ds_read_b128 v[40:43], v14 offset:40960
    ds_read_b128 v[44:47], v14 offset:43008
    v_mfma_f32_16x16x32_bf16 v[28:31], v[96:99], v[60:63], v[28:31]
    ds_read_b64_tr_b16 v[72:73], v8 offset:12288
    ds_read_b64_tr_b16 v[74:75], v8 offset:15360
    v_mfma_f32_16x16x32_bf16 v[20:23], v[100:103], v[56:59], v[20:23]
    ds_read_b64_tr_b16 v[76:77], v9 offset:12288
    ds_read_b64_tr_b16 v[78:79], v9 offset:15360
    v_mfma_f32_16x16x32_bf16 v[32:35], v[100:103], v[60:63], v[32:35]
    ds_read_b64_tr_b16 v[80:81], v10 offset:12288
    ds_read_b64_tr_b16 v[82:83], v10 offset:15360
    v_mfma_f32_16x16x32_bf16 v[24:27], v[104:107], v[56:59], v[24:27]
    ds_read_b128 v[48:51], v14 offset:41984
    ds_read_b128 v[52:55], v14 offset:44032
    v_mfma_f32_16x16x32_bf16 v[36:39], v[104:107], v[60:63], v[36:39]
    ds_read_b64_tr_b16 v[84:85], v8 offset:18432
    ds_read_b64_tr_b16 v[86:87], v8 offset:21504
    v_mfma_f32_16x16x32_bf16 v[16:19], v[108:111], v[64:67], v[16:19]
    ds_read_b64_tr_b16 v[88:89], v9 offset:18432
    ds_read_b64_tr_b16 v[90:91], v9 offset:21504
    v_mfma_f32_16x16x32_bf16 v[28:31], v[108:111], v[68:71], v[28:31]
    ds_read_b64_tr_b16 v[92:93], v10 offset:18432
    ds_read_b64_tr_b16 v[94:95], v10 offset:21504
    v_mfma_f32_16x16x32_bf16 v[20:23], v[112:115], v[64:67], v[20:23]
    v_mfma_f32_16x16x32_bf16 v[32:35], v[112:115], v[68:71], v[32:35]
    v_mfma_f32_16x16x32_bf16 v[24:27], v[116:119], v[64:67], v[24:27]
    v_mfma_f32_16x16x32_bf16 v[36:39], v[116:119], v[68:71], v[36:39]
    s_barrier
    s_waitcnt lgkmcnt(0)
    v_mfma_f32_16x16x32_bf16 v[16:19], v[72:75], v[40:43], v[16:19]
    ds_read_b128 v[56:59], v14 offset:32768
    ds_read_b128 v[60:63], v14 offset:34816
    v_mfma_f32_16x16x32_bf16 v[28:31], v[72:75], v[44:47], v[28:31]
    ds_read_b64_tr_b16 v[96:97], v8 offset:0
    ds_read_b64_tr_b16 v[98:99], v8 offset:3072
    v_mfma_f32_16x16x32_bf16 v[20:23], v[76:79], v[40:43], v[20:23]
    ds_read_b64_tr_b16 v[100:101], v9 offset:0
    ds_read_b64_tr_b16 v[102:103], v9 offset:3072
    v_mfma_f32_16x16x32_bf16 v[32:35], v[76:79], v[44:47], v[32:35]
    ds_read_b64_tr_b16 v[104:105], v10 offset:0
    ds_read_b64_tr_b16 v[106:107], v10 offset:3072
    v_mfma_f32_16x16x32_bf16 v[24:27], v[80:83], v[40:43], v[24:27]
    ds_read_b128 v[64:67], v14 offset:33792
    ds_read_b128 v[68:71], v14 offset:35840
    v_mfma_f32_16x16x32_bf16 v[36:39], v[80:83], v[44:47], v[36:39]
    ds_read_b64_tr_b16 v[108:109], v8 offset:6144
    ds_read_b64_tr_b16 v[110:111], v8 offset:9216
    v_mfma_f32_16x16x32_bf16 v[16:19], v[84:87], v[48:51], v[16:19]
    ds_read_b64_tr_b16 v[112:113], v9 offset:6144
    ds_read_b64_tr_b16 v[114:115], v9 offset:9216
    v_mfma_f32_16x16x32_bf16 v[28:31], v[84:87], v[52:55], v[28:31]
    ds_read_b64_tr_b16 v[116:117], v10 offset:6144
    ds_read_b64_tr_b16 v[118:119], v10 offset:9216
    v_mfma_f32_16x16x32_bf16 v[20:23], v[88:91], v[48:51], v[20:23]
    v_mfma_f32_16x16x32_bf16 v[32:35], v[88:91], v[52:55], v[32:35]
    v_mfma_f32_16x16x32_bf16 v[24:27], v[92:95], v[48:51], v[24:27]
    v_mfma_f32_16x16x32_bf16 v[36:39], v[92:95], v[52:55], v[36:39]
    s_barrier
    s_waitcnt lgkmcnt(0)
    v_mfma_f32_16x16x32_bf16 v[16:19], v[96:99], v[56:59], v[16:19]
    ds_read_b128 v[40:43], v14 offset:24576
    ds_read_b128 v[44:47], v14 offset:26624
    v_mfma_f32_16x16x32_bf16 v[28:31], v[96:99], v[60:63], v[28:31]
    ds_read_b64_tr_b16 v[72:73], v11 offset:36864
    ds_read_b64_tr_b16 v[74:75], v11 offset:39936
    v_mfma_f32_16x16x32_bf16 v[20:23], v[100:103], v[56:59], v[20:23]
    ds_read_b64_tr_b16 v[76:77], v12 offset:36864
    ds_read_b64_tr_b16 v[78:79], v12 offset:39936
    v_mfma_f32_16x16x32_bf16 v[32:35], v[100:103], v[60:63], v[32:35]
    ds_read_b64_tr_b16 v[80:81], v13 offset:36864
    ds_read_b64_tr_b16 v[82:83], v13 offset:39936
    v_mfma_f32_16x16x32_bf16 v[24:27], v[104:107], v[56:59], v[24:27]
    ds_read_b128 v[48:51], v14 offset:25600
    ds_read_b128 v[52:55], v14 offset:27648
    v_mfma_f32_16x16x32_bf16 v[36:39], v[104:107], v[60:63], v[36:39]
    ds_read_b64_tr_b16 v[84:85], v11 offset:43008
    ds_read_b64_tr_b16 v[86:87], v11 offset:46080
    v_mfma_f32_16x16x32_bf16 v[16:19], v[108:111], v[64:67], v[16:19]
    ds_read_b64_tr_b16 v[88:89], v12 offset:43008
    ds_read_b64_tr_b16 v[90:91], v12 offset:46080
    v_mfma_f32_16x16x32_bf16 v[28:31], v[108:111], v[68:71], v[28:31]
    ds_read_b64_tr_b16 v[92:93], v13 offset:43008
    ds_read_b64_tr_b16 v[94:95], v13 offset:46080
    v_mfma_f32_16x16x32_bf16 v[20:23], v[112:115], v[64:67], v[20:23]
    v_mfma_f32_16x16x32_bf16 v[32:35], v[112:115], v[68:71], v[32:35]
    v_mfma_f32_16x16x32_bf16 v[24:27], v[116:119], v[64:67], v[24:27]
    v_mfma_f32_16x16x32_bf16 v[36:39], v[116:119], v[68:71], v[36:39]
    s_barrier
    s_waitcnt lgkmcnt(0)
    v_mfma_f32_16x16x32_bf16 v[16:19], v[72:75], v[40:43], v[16:19]
    ds_read_b128 v[56:59], v14 offset:16384
    ds_read_b128 v[60:63], v14 offset:18432
    v_mfma_f32_16x16x32_bf16 v[28:31], v[72:75], v[44:47], v[28:31]
    ds_read_b64_tr_b16 v[96:97], v11 offset:24576
    ds_read_b64_tr_b16 v[98:99], v11 offset:27648
    v_mfma_f32_16x16x32_bf16 v[20:23], v[76:79], v[40:43], v[20:23]
    ds_read_b64_tr_b16 v[100:101], v12 offset:24576
    ds_read_b64_tr_b16 v[102:103], v12 offset:27648
    v_mfma_f32_16x16x32_bf16 v[32:35], v[76:79], v[44:47], v[32:35]
    ds_read_b64_tr_b16 v[104:105], v13 offset:24576
    ds_read_b64_tr_b16 v[106:107], v13 offset:27648
    v_mfma_f32_16x16x32_bf16 v[24:27], v[80:83], v[40:43], v[24:27]
    ds_read_b128 v[64:67], v14 offset:17408
    ds_read_b128 v[68:71], v14 offset:19456
    v_mfma_f32_16x16x32_bf16 v[36:39], v[80:83], v[44:47], v[36:39]
    ds_read_b64_tr_b16 v[108:109], v11 offset:30720
    ds_read_b64_tr_b16 v[110:111], v11 offset:33792
    v_mfma_f32_16x16x32_bf16 v[16:19], v[84:87], v[48:51], v[16:19]
    ds_read_b64_tr_b16 v[112:113], v12 offset:30720
    ds_read_b64_tr_b16 v[114:115], v12 offset:33792
    v_mfma_f32_16x16x32_bf16 v[28:31], v[84:87], v[52:55], v[28:31]
    ds_read_b64_tr_b16 v[116:117], v13 offset:30720
    ds_read_b64_tr_b16 v[118:119], v13 offset:33792
    v_mfma_f32_16x16x32_bf16 v[20:23], v[88:91], v[48:51], v[20:23]
    v_mfma_f32_16x16x32_bf16 v[32:35], v[88:91], v[52:55], v[32:35]
    v_mfma_f32_16x16x32_bf16 v[24:27], v[92:95], v[48:51], v[24:27]
    v_mfma_f32_16x16x32_bf16 v[36:39], v[92:95], v[52:55], v[36:39]
    s_barrier
    s_waitcnt lgkmcnt(0)
    v_mfma_f32_16x16x32_bf16 v[16:19], v[96:99], v[56:59], v[16:19]
    ds_read_b128 v[40:43], v14 offset:8192
    ds_read_b128 v[44:47], v14 offset:10240
    v_mfma_f32_16x16x32_bf16 v[28:31], v[96:99], v[60:63], v[28:31]
    ds_read_b64_tr_b16 v[72:73], v11 offset:12288
    ds_read_b64_tr_b16 v[74:75], v11 offset:15360
    v_mfma_f32_16x16x32_bf16 v[20:23], v[100:103], v[56:59], v[20:23]
    ds_read_b64_tr_b16 v[76:77], v12 offset:12288
    ds_read_b64_tr_b16 v[78:79], v12 offset:15360
    v_mfma_f32_16x16x32_bf16 v[32:35], v[100:103], v[60:63], v[32:35]
    ds_read_b64_tr_b16 v[80:81], v13 offset:12288
    ds_read_b64_tr_b16 v[82:83], v13 offset:15360
    v_mfma_f32_16x16x32_bf16 v[24:27], v[104:107], v[56:59], v[24:27]
    ds_read_b128 v[48:51], v14 offset:9216
    ds_read_b128 v[52:55], v14 offset:11264
    v_mfma_f32_16x16x32_bf16 v[36:39], v[104:107], v[60:63], v[36:39]
    ds_read_b64_tr_b16 v[84:85], v11 offset:18432
    ds_read_b64_tr_b16 v[86:87], v11 offset:21504
    v_mfma_f32_16x16x32_bf16 v[16:19], v[108:111], v[64:67], v[16:19]
    ds_read_b64_tr_b16 v[88:89], v12 offset:18432
    ds_read_b64_tr_b16 v[90:91], v12 offset:21504
    v_mfma_f32_16x16x32_bf16 v[28:31], v[108:111], v[68:71], v[28:31]
    ds_read_b64_tr_b16 v[92:93], v13 offset:18432
    ds_read_b64_tr_b16 v[94:95], v13 offset:21504
    v_mfma_f32_16x16x32_bf16 v[20:23], v[112:115], v[64:67], v[20:23]
    v_mfma_f32_16x16x32_bf16 v[32:35], v[112:115], v[68:71], v[32:35]
    v_mfma_f32_16x16x32_bf16 v[24:27], v[116:119], v[64:67], v[24:27]
    v_mfma_f32_16x16x32_bf16 v[36:39], v[116:119], v[68:71], v[36:39]
    s_barrier
    s_waitcnt lgkmcnt(0)
    v_mfma_f32_16x16x32_bf16 v[16:19], v[72:75], v[40:43], v[16:19]
    ds_read_b128 v[56:59], v14 offset:0
    ds_read_b128 v[60:63], v14 offset:2048
    v_mfma_f32_16x16x32_bf16 v[28:31], v[72:75], v[44:47], v[28:31]
    ds_read_b64_tr_b16 v[96:97], v11 offset:0
    ds_read_b64_tr_b16 v[98:99], v11 offset:3072
    v_mfma_f32_16x16x32_bf16 v[20:23], v[76:79], v[40:43], v[20:23]
    ds_read_b64_tr_b16 v[100:101], v12 offset:0
    ds_read_b64_tr_b16 v[102:103], v12 offset:3072
    v_mfma_f32_16x16x32_bf16 v[32:35], v[76:79], v[44:47], v[32:35]
    ds_read_b64_tr_b16 v[104:105], v13 offset:0
    ds_read_b64_tr_b16 v[106:107], v13 offset:3072
    v_mfma_f32_16x16x32_bf16 v[24:27], v[80:83], v[40:43], v[24:27]
    ds_read_b128 v[64:67], v14 offset:1024
    ds_read_b128 v[68:71], v14 offset:3072
    v_mfma_f32_16x16x32_bf16 v[36:39], v[80:83], v[44:47], v[36:39]
    ds_read_b64_tr_b16 v[108:109], v11 offset:6144
    ds_read_b64_tr_b16 v[110:111], v11 offset:9216
    v_mfma_f32_16x16x32_bf16 v[16:19], v[84:87], v[48:51], v[16:19]
    ds_read_b64_tr_b16 v[112:113], v12 offset:6144
    ds_read_b64_tr_b16 v[114:115], v12 offset:9216
    v_mfma_f32_16x16x32_bf16 v[28:31], v[84:87], v[52:55], v[28:31]
    ds_read_b64_tr_b16 v[116:117], v13 offset:6144
    ds_read_b64_tr_b16 v[118:119], v13 offset:9216
    v_mfma_f32_16x16x32_bf16 v[20:23], v[88:91], v[48:51], v[20:23]
    v_mfma_f32_16x16x32_bf16 v[32:35], v[88:91], v[52:55], v[32:35]
    v_mfma_f32_16x16x32_bf16 v[24:27], v[92:95], v[48:51], v[24:27]
    v_mfma_f32_16x16x32_bf16 v[36:39], v[92:95], v[52:55], v[36:39]
    s_barrier
    s_waitcnt lgkmcnt(0)
    v_mfma_f32_16x16x32_bf16 v[16:19], v[96:99], v[56:59], v[16:19]
    ds_read_b128 v[40:43], v14 offset:40960
    ds_read_b128 v[44:47], v14 offset:43008
    v_mfma_f32_16x16x32_bf16 v[28:31], v[96:99], v[60:63], v[28:31]
    ds_read_b64_tr_b16 v[72:73], v8 offset:36864
    ds_read_b64_tr_b16 v[74:75], v8 offset:39936
    v_mfma_f32_16x16x32_bf16 v[20:23], v[100:103], v[56:59], v[20:23]
    ds_read_b64_tr_b16 v[76:77], v9 offset:36864
    ds_read_b64_tr_b16 v[78:79], v9 offset:39936
    v_mfma_f32_16x16x32_bf16 v[32:35], v[100:103], v[60:63], v[32:35]
    ds_read_b64_tr_b16 v[80:81], v10 offset:36864
    ds_read_b64_tr_b16 v[82:83], v10 offset:39936
    v_mfma_f32_16x16x32_bf16 v[24:27], v[104:107], v[56:59], v[24:27]
    ds_read_b128 v[48:51], v14 offset:41984
    ds_read_b128 v[52:55], v14 offset:44032
    v_mfma_f32_16x16x32_bf16 v[36:39], v[104:107], v[60:63], v[36:39]
    ds_read_b64_tr_b16 v[84:85], v8 offset:43008
    ds_read_b64_tr_b16 v[86:87], v8 offset:46080
    v_mfma_f32_16x16x32_bf16 v[16:19], v[108:111], v[64:67], v[16:19]
    ds_read_b64_tr_b16 v[88:89], v9 offset:43008
    ds_read_b64_tr_b16 v[90:91], v9 offset:46080
    v_mfma_f32_16x16x32_bf16 v[28:31], v[108:111], v[68:71], v[28:31]
    ds_read_b64_tr_b16 v[92:93], v10 offset:43008
    ds_read_b64_tr_b16 v[94:95], v10 offset:46080
    v_mfma_f32_16x16x32_bf16 v[20:23], v[112:115], v[64:67], v[20:23]
    v_mfma_f32_16x16x32_bf16 v[32:35], v[112:115], v[68:71], v[32:35]
    v_mfma_f32_16x16x32_bf16 v[24:27], v[116:119], v[64:67], v[24:27]
    v_mfma_f32_16x16x32_bf16 v[36:39], v[116:119], v[68:71], v[36:39]
    s_barrier
    s_waitcnt lgkmcnt(0)
    v_mfma_f32_16x16x32_bf16 v[16:19], v[72:75], v[40:43], v[16:19]
    ds_read_b128 v[56:59], v14 offset:32768
    ds_read_b128 v[60:63], v14 offset:34816
    v_mfma_f32_16x16x32_bf16 v[28:31], v[72:75], v[44:47], v[28:31]
    ds_read_b64_tr_b16 v[96:97], v8 offset:24576
    ds_read_b64_tr_b16 v[98:99], v8 offset:27648
    v_mfma_f32_16x16x32_bf16 v[20:23], v[76:79], v[40:43], v[20:23]
    ds_read_b64_tr_b16 v[100:101], v9 offset:24576
    ds_read_b64_tr_b16 v[102:103], v9 offset:27648
    v_mfma_f32_16x16x32_bf16 v[32:35], v[76:79], v[44:47], v[32:35]
    ds_read_b64_tr_b16 v[104:105], v10 offset:24576
    ds_read_b64_tr_b16 v[106:107], v10 offset:27648
    v_mfma_f32_16x16x32_bf16 v[24:27], v[80:83], v[40:43], v[24:27]
    ds_read_b128 v[64:67], v14 offset:33792
    ds_read_b128 v[68:71], v14 offset:35840
    v_mfma_f32_16x16x32_bf16 v[36:39], v[80:83], v[44:47], v[36:39]
    ds_read_b64_tr_b16 v[108:109], v8 offset:30720
    ds_read_b64_tr_b16 v[110:111], v8 offset:33792
    v_mfma_f32_16x16x32_bf16 v[16:19], v[84:87], v[48:51], v[16:19]
    ds_read_b64_tr_b16 v[112:113], v9 offset:30720
    ds_read_b64_tr_b16 v[114:115], v9 offset:33792
    v_mfma_f32_16x16x32_bf16 v[28:31], v[84:87], v[52:55], v[28:31]
    ds_read_b64_tr_b16 v[116:117], v10 offset:30720
    ds_read_b64_tr_b16 v[118:119], v10 offset:33792
    v_mfma_f32_16x16x32_bf16 v[20:23], v[88:91], v[48:51], v[20:23]
    v_mfma_f32_16x16x32_bf16 v[32:35], v[88:91], v[52:55], v[32:35]
    v_mfma_f32_16x16x32_bf16 v[24:27], v[92:95], v[48:51], v[24:27]
    v_mfma_f32_16x16x32_bf16 v[36:39], v[92:95], v[52:55], v[36:39]
    s_barrier
    s_waitcnt lgkmcnt(0)
    v_mfma_f32_16x16x32_bf16 v[16:19], v[96:99], v[56:59], v[16:19]
    ds_read_b128 v[40:43], v14 offset:24576
    ds_read_b128 v[44:47], v14 offset:26624
    v_mfma_f32_16x16x32_bf16 v[28:31], v[96:99], v[60:63], v[28:31]
    ds_read_b64_tr_b16 v[72:73], v8 offset:12288
    ds_read_b64_tr_b16 v[74:75], v8 offset:15360
    v_mfma_f32_16x16x32_bf16 v[20:23], v[100:103], v[56:59], v[20:23]
    ds_read_b64_tr_b16 v[76:77], v9 offset:12288
    ds_read_b64_tr_b16 v[78:79], v9 offset:15360
    v_mfma_f32_16x16x32_bf16 v[32:35], v[100:103], v[60:63], v[32:35]
    ds_read_b64_tr_b16 v[80:81], v10 offset:12288
    ds_read_b64_tr_b16 v[82:83], v10 offset:15360
    v_mfma_f32_16x16x32_bf16 v[24:27], v[104:107], v[56:59], v[24:27]
    ds_read_b128 v[48:51], v14 offset:25600
    ds_read_b128 v[52:55], v14 offset:27648
    v_mfma_f32_16x16x32_bf16 v[36:39], v[104:107], v[60:63], v[36:39]
    ds_read_b64_tr_b16 v[84:85], v8 offset:18432
    ds_read_b64_tr_b16 v[86:87], v8 offset:21504
    v_mfma_f32_16x16x32_bf16 v[16:19], v[108:111], v[64:67], v[16:19]
    ds_read_b64_tr_b16 v[88:89], v9 offset:18432
    ds_read_b64_tr_b16 v[90:91], v9 offset:21504
    v_mfma_f32_16x16x32_bf16 v[28:31], v[108:111], v[68:71], v[28:31]
    ds_read_b64_tr_b16 v[92:93], v10 offset:18432
    ds_read_b64_tr_b16 v[94:95], v10 offset:21504
    v_mfma_f32_16x16x32_bf16 v[20:23], v[112:115], v[64:67], v[20:23]
    v_mfma_f32_16x16x32_bf16 v[32:35], v[112:115], v[68:71], v[32:35]
    v_mfma_f32_16x16x32_bf16 v[24:27], v[116:119], v[64:67], v[24:27]
    v_mfma_f32_16x16x32_bf16 v[36:39], v[116:119], v[68:71], v[36:39]
    s_barrier
    s_waitcnt lgkmcnt(0)
    v_mfma_f32_16x16x32_bf16 v[16:19], v[72:75], v[40:43], v[16:19]
    ds_read_b128 v[56:59], v14 offset:16384
    ds_read_b128 v[60:63], v14 offset:18432
    v_mfma_f32_16x16x32_bf16 v[28:31], v[72:75], v[44:47], v[28:31]
    ds_read_b64_tr_b16 v[96:97], v8 offset:0
    ds_read_b64_tr_b16 v[98:99], v8 offset:3072
    v_mfma_f32_16x16x32_bf16 v[20:23], v[76:79], v[40:43], v[20:23]
    ds_read_b64_tr_b16 v[100:101], v9 offset:0
    ds_read_b64_tr_b16 v[102:103], v9 offset:3072
    v_mfma_f32_16x16x32_bf16 v[32:35], v[76:79], v[44:47], v[32:35]
    ds_read_b64_tr_b16 v[104:105], v10 offset:0
    ds_read_b64_tr_b16 v[106:107], v10 offset:3072
    v_mfma_f32_16x16x32_bf16 v[24:27], v[80:83], v[40:43], v[24:27]
    ds_read_b128 v[64:67], v14 offset:17408
    ds_read_b128 v[68:71], v14 offset:19456
    v_mfma_f32_16x16x32_bf16 v[36:39], v[80:83], v[44:47], v[36:39]
    ds_read_b64_tr_b16 v[108:109], v8 offset:6144
    ds_read_b64_tr_b16 v[110:111], v8 offset:9216
    v_mfma_f32_16x16x32_bf16 v[16:19], v[84:87], v[48:51], v[16:19]
    ds_read_b64_tr_b16 v[112:113], v9 offset:6144
    ds_read_b64_tr_b16 v[114:115], v9 offset:9216
    v_mfma_f32_16x16x32_bf16 v[28:31], v[84:87], v[52:55], v[28:31]
    ds_read_b64_tr_b16 v[116:117], v10 offset:6144
    ds_read_b64_tr_b16 v[118:119], v10 offset:9216
    v_mfma_f32_16x16x32_bf16 v[20:23], v[88:91], v[48:51], v[20:23]
    v_mfma_f32_16x16x32_bf16 v[32:35], v[88:91], v[52:55], v[32:35]
    v_mfma_f32_16x16x32_bf16 v[24:27], v[92:95], v[48:51], v[24:27]
    v_mfma_f32_16x16x32_bf16 v[36:39], v[92:95], v[52:55], v[36:39]
    s_barrier
    s_waitcnt lgkmcnt(0)
    v_mfma_f32_16x16x32_bf16 v[16:19], v[96:99], v[56:59], v[16:19]
    ds_read_b128 v[40:43], v14 offset:8192
    ds_read_b128 v[44:47], v14 offset:10240
    v_mfma_f32_16x16x32_bf16 v[28:31], v[96:99], v[60:63], v[28:31]
    ds_read_b64_tr_b16 v[72:73], v11 offset:36864
    ds_read_b64_tr_b16 v[74:75], v11 offset:39936
    v_mfma_f32_16x16x32_bf16 v[20:23], v[100:103], v[56:59], v[20:23]
    ds_read_b64_tr_b16 v[76:77], v12 offset:36864
    ds_read_b64_tr_b16 v[78:79], v12 offset:39936
    v_mfma_f32_16x16x32_bf16 v[32:35], v[100:103], v[60:63], v[32:35]
    ds_read_b64_tr_b16 v[80:81], v13 offset:36864
    ds_read_b64_tr_b16 v[82:83], v13 offset:39936
    v_mfma_f32_16x16x32_bf16 v[24:27], v[104:107], v[56:59], v[24:27]
    ds_read_b128 v[48:51], v14 offset:9216
    ds_read_b128 v[52:55], v14 offset:11264
    v_mfma_f32_16x16x32_bf16 v[36:39], v[104:107], v[60:63], v[36:39]
    ds_read_b64_tr_b16 v[84:85], v11 offset:43008
    ds_read_b64_tr_b16 v[86:87], v11 offset:46080
    v_mfma_f32_16x16x32_bf16 v[16:19], v[108:111], v[64:67], v[16:19]
    ds_read_b64_tr_b16 v[88:89], v12 offset:43008
    ds_read_b64_tr_b16 v[90:91], v12 offset:46080
    v_mfma_f32_16x16x32_bf16 v[28:31], v[108:111], v[68:71], v[28:31]
    ds_read_b64_tr_b16 v[92:93], v13 offset:43008
    ds_read_b64_tr_b16 v[94:95], v13 offset:46080
    v_mfma_f32_16x16x32_bf16 v[20:23], v[112:115], v[64:67], v[20:23]
    v_mfma_f32_16x16x32_bf16 v[32:35], v[112:115], v[68:71], v[32:35]
    v_mfma_f32_16x16x32_bf16 v[24:27], v[116:119], v[64:67], v[24:27]
    v_mfma_f32_16x16x32_bf16 v[36:39], v[116:119], v[68:71], v[36:39]
    s_barrier
    s_waitcnt lgkmcnt(0)
    v_mfma_f32_16x16x32_bf16 v[16:19], v[72:75], v[40:43], v[16:19]
    ds_read_b128 v[56:59], v14 offset:0
    ds_read_b128 v[60:63], v14 offset:2048
    v_mfma_f32_16x16x32_bf16 v[28:31], v[72:75], v[44:47], v[28:31]
    ds_read_b64_tr_b16 v[96:97], v11 offset:24576
    ds_read_b64_tr_b16 v[98:99], v11 offset:27648
    v_mfma_f32_16x16x32_bf16 v[20:23], v[76:79], v[40:43], v[20:23]
    ds_read_b64_tr_b16 v[100:101], v12 offset:24576
    ds_read_b64_tr_b16 v[102:103], v12 offset:27648
    v_mfma_f32_16x16x32_bf16 v[32:35], v[76:79], v[44:47], v[32:35]
    ds_read_b64_tr_b16 v[104:105], v13 offset:24576
    ds_read_b64_tr_b16 v[106:107], v13 offset:27648
    v_mfma_f32_16x16x32_bf16 v[24:27], v[80:83], v[40:43], v[24:27]
    ds_read_b128 v[64:67], v14 offset:1024
    ds_read_b128 v[68:71], v14 offset:3072
    v_mfma_f32_16x16x32_bf16 v[36:39], v[80:83], v[44:47], v[36:39]
    ds_read_b64_tr_b16 v[108:109], v11 offset:30720
    ds_read_b64_tr_b16 v[110:111], v11 offset:33792
    v_mfma_f32_16x16x32_bf16 v[16:19], v[84:87], v[48:51], v[16:19]
    ds_read_b64_tr_b16 v[112:113], v12 offset:30720
    ds_read_b64_tr_b16 v[114:115], v12 offset:33792
    v_mfma_f32_16x16x32_bf16 v[28:31], v[84:87], v[52:55], v[28:31]
    ds_read_b64_tr_b16 v[116:117], v13 offset:30720
    ds_read_b64_tr_b16 v[118:119], v13 offset:33792
    v_mfma_f32_16x16x32_bf16 v[20:23], v[88:91], v[48:51], v[20:23]
    v_mfma_f32_16x16x32_bf16 v[32:35], v[88:91], v[52:55], v[32:35]
    v_mfma_f32_16x16x32_bf16 v[24:27], v[92:95], v[48:51], v[24:27]
    v_mfma_f32_16x16x32_bf16 v[36:39], v[92:95], v[52:55], v[36:39]
    s_barrier
    s_waitcnt lgkmcnt(0)
    v_mfma_f32_16x16x32_bf16 v[16:19], v[96:99], v[56:59], v[16:19]
    ds_read_b128 v[40:43], v14 offset:40960
    ds_read_b128 v[44:47], v14 offset:43008
    v_mfma_f32_16x16x32_bf16 v[28:31], v[96:99], v[60:63], v[28:31]
    ds_read_b64_tr_b16 v[72:73], v11 offset:12288
    ds_read_b64_tr_b16 v[74:75], v11 offset:15360
    v_mfma_f32_16x16x32_bf16 v[20:23], v[100:103], v[56:59], v[20:23]
    ds_read_b64_tr_b16 v[76:77], v12 offset:12288
    ds_read_b64_tr_b16 v[78:79], v12 offset:15360
    v_mfma_f32_16x16x32_bf16 v[32:35], v[100:103], v[60:63], v[32:35]
    ds_read_b64_tr_b16 v[80:81], v13 offset:12288
    ds_read_b64_tr_b16 v[82:83], v13 offset:15360
    v_mfma_f32_16x16x32_bf16 v[24:27], v[104:107], v[56:59], v[24:27]
    ds_read_b128 v[48:51], v14 offset:41984
    ds_read_b128 v[52:55], v14 offset:44032
    v_mfma_f32_16x16x32_bf16 v[36:39], v[104:107], v[60:63], v[36:39]
    ds_read_b64_tr_b16 v[84:85], v11 offset:18432
    ds_read_b64_tr_b16 v[86:87], v11 offset:21504
    v_mfma_f32_16x16x32_bf16 v[16:19], v[108:111], v[64:67], v[16:19]
    ds_read_b64_tr_b16 v[88:89], v12 offset:18432
    ds_read_b64_tr_b16 v[90:91], v12 offset:21504
    v_mfma_f32_16x16x32_bf16 v[28:31], v[108:111], v[68:71], v[28:31]
    ds_read_b64_tr_b16 v[92:93], v13 offset:18432
    ds_read_b64_tr_b16 v[94:95], v13 offset:21504
    v_mfma_f32_16x16x32_bf16 v[20:23], v[112:115], v[64:67], v[20:23]
    v_mfma_f32_16x16x32_bf16 v[32:35], v[112:115], v[68:71], v[32:35]
    v_mfma_f32_16x16x32_bf16 v[24:27], v[116:119], v[64:67], v[24:27]
    v_mfma_f32_16x16x32_bf16 v[36:39], v[116:119], v[68:71], v[36:39]
    s_barrier
    s_waitcnt lgkmcnt(0)
    v_mfma_f32_16x16x32_bf16 v[16:19], v[72:75], v[40:43], v[16:19]
    ds_read_b128 v[56:59], v14 offset:32768
    ds_read_b128 v[60:63], v14 offset:34816
    v_mfma_f32_16x16x32_bf16 v[28:31], v[72:75], v[44:47], v[28:31]
    ds_read_b64_tr_b16 v[96:97], v11 offset:0
    ds_read_b64_tr_b16 v[98:99], v11 offset:3072
    v_mfma_f32_16x16x32_bf16 v[20:23], v[76:79], v[40:43], v[20:23]
    ds_read_b64_tr_b16 v[100:101], v12 offset:0
    ds_read_b64_tr_b16 v[102:103], v12 offset:3072
    v_mfma_f32_16x16x32_bf16 v[32:35], v[76:79], v[44:47], v[32:35]
    ds_read_b64_tr_b16 v[104:105], v13 offset:0
    ds_read_b64_tr_b16 v[106:107], v13 offset:3072
    v_mfma_f32_16x16x32_bf16 v[24:27], v[80:83], v[40:43], v[24:27]
    ds_read_b128 v[64:67], v14 offset:33792
    ds_read_b128 v[68:71], v14 offset:35840
    v_mfma_f32_16x16x32_bf16 v[36:39], v[80:83], v[44:47], v[36:39]
    ds_read_b64_tr_b16 v[108:109], v11 offset:6144
    ds_read_b64_tr_b16 v[110:111], v11 offset:9216
    v_mfma_f32_16x16x32_bf16 v[16:19], v[84:87], v[48:51], v[16:19]
    ds_read_b64_tr_b16 v[112:113], v12 offset:6144
    ds_read_b64_tr_b16 v[114:115], v12 offset:9216
    v_mfma_f32_16x16x32_bf16 v[28:31], v[84:87], v[52:55], v[28:31]
    ds_read_b64_tr_b16 v[116:117], v13 offset:6144
    ds_read_b64_tr_b16 v[118:119], v13 offset:9216
    v_mfma_f32_16x16x32_bf16 v[20:23], v[88:91], v[48:51], v[20:23]
    v_mfma_f32_16x16x32_bf16 v[32:35], v[88:91], v[52:55], v[32:35]
    v_mfma_f32_16x16x32_bf16 v[24:27], v[92:95], v[48:51], v[24:27]
    v_mfma_f32_16x16x32_bf16 v[36:39], v[92:95], v[52:55], v[36:39]
    s_barrier
    s_waitcnt lgkmcnt(0)
    v_mfma_f32_16x16x32_bf16 v[16:19], v[96:99], v[56:59], v[16:19]
    ds_read_b128 v[40:43], v14 offset:24576
    ds_read_b128 v[44:47], v14 offset:26624
    ds_read_b64_tr_b16 v[72:73], v8 offset:36864
    v_mfma_f32_16x16x32_bf16 v[28:31], v[96:99], v[60:63], v[28:31]
    ds_read_b64_tr_b16 v[74:75], v8 offset:39936
    ds_read_b64_tr_b16 v[76:77], v9 offset:36864
    ds_read_b64_tr_b16 v[78:79], v9 offset:39936
    v_mfma_f32_16x16x32_bf16 v[20:23], v[100:103], v[56:59], v[20:23]
    ds_read_b64_tr_b16 v[80:81], v10 offset:36864
    ds_read_b64_tr_b16 v[82:83], v10 offset:39936
    ds_read_b128 v[48:51], v14 offset:25600
    v_mfma_f32_16x16x32_bf16 v[32:35], v[100:103], v[60:63], v[32:35]
    ds_read_b128 v[52:55], v14 offset:27648
    ds_read_b64_tr_b16 v[84:85], v8 offset:43008
    ds_read_b64_tr_b16 v[86:87], v8 offset:46080
    v_mfma_f32_16x16x32_bf16 v[24:27], v[104:107], v[56:59], v[24:27]
    ds_read_b64_tr_b16 v[88:89], v9 offset:43008
    ds_read_b64_tr_b16 v[90:91], v9 offset:46080
    ds_read_b64_tr_b16 v[92:93], v10 offset:43008
    v_mfma_f32_16x16x32_bf16 v[36:39], v[104:107], v[60:63], v[36:39]
    ds_read_b64_tr_b16 v[94:95], v10 offset:46080
    s_and_b32 s60, s56, 1
    s_and_b32 s61, s53, 1
    v_mfma_f32_16x16x32_bf16 v[16:19], v[108:111], v[64:67], v[16:19]
    s_lshl1_add_u32 s60, s60, s61
    s_lshl_b32 s60, s60, 7
    s_add_u32 s60, s60, 161344
    v_mfma_f32_16x16x32_bf16 v[28:31], v[108:111], v[68:71], v[28:31]
    v_and_b32 v2, 15, v0
    v_lshl_add_u32 v2, v2, 2, s60
    ds_read_b32 v132, v2
    v_mfma_f32_16x16x32_bf16 v[20:23], v[112:115], v[64:67], v[20:23]
    ds_read_b32 v134, v2 offset:64
    v_mfma_f32_16x16x32_bf16 v[32:35], v[112:115], v[68:71], v[32:35]
    v_mfma_f32_16x16x32_bf16 v[24:27], v[116:119], v[64:67], v[24:27]
    v_mfma_f32_16x16x32_bf16 v[36:39], v[116:119], v[68:71], v[36:39]
    s_barrier
    s_waitcnt lgkmcnt(0)
    v_mfma_f32_16x16x32_bf16 v[16:19], v[72:75], v[40:43], v[16:19]
    ds_read_b128 v[56:59], v14 offset:16384
    ds_read_b128 v[60:63], v14 offset:18432
    v_mfma_f32_16x16x32_bf16 v[28:31], v[72:75], v[44:47], v[28:31]
    ds_read_b64_tr_b16 v[96:97], v8 offset:24576
    ds_read_b64_tr_b16 v[98:99], v8 offset:27648
    v_mfma_f32_16x16x32_bf16 v[20:23], v[76:79], v[40:43], v[20:23]
    ds_read_b64_tr_b16 v[100:101], v9 offset:24576
    ds_read_b64_tr_b16 v[102:103], v9 offset:27648
    v_mfma_f32_16x16x32_bf16 v[32:35], v[76:79], v[44:47], v[32:35]
    ds_read_b64_tr_b16 v[104:105], v10 offset:24576
    ds_read_b64_tr_b16 v[106:107], v10 offset:27648
    v_mfma_f32_16x16x32_bf16 v[24:27], v[80:83], v[40:43], v[24:27]
    ds_read_b128 v[64:67], v14 offset:17408
    ds_read_b128 v[68:71], v14 offset:19456
    v_mfma_f32_16x16x32_bf16 v[36:39], v[80:83], v[44:47], v[36:39]
    ds_read_b64_tr_b16 v[108:109], v8 offset:30720
    ds_read_b64_tr_b16 v[110:111], v8 offset:33792
    v_mfma_f32_16x16x32_bf16 v[16:19], v[84:87], v[48:51], v[16:19]
    ds_read_b64_tr_b16 v[112:113], v9 offset:30720
    ds_read_b64_tr_b16 v[114:115], v9 offset:33792
    v_mfma_f32_16x16x32_bf16 v[28:31], v[84:87], v[52:55], v[28:31]
    ds_read_b64_tr_b16 v[116:117], v10 offset:30720
    ds_read_b64_tr_b16 v[118:119], v10 offset:33792
    v_mfma_f32_16x16x32_bf16 v[20:23], v[88:91], v[48:51], v[20:23]
    v_mfma_f32_16x16x32_bf16 v[32:35], v[88:91], v[52:55], v[32:35]
    v_mfma_f32_16x16x32_bf16 v[24:27], v[92:95], v[48:51], v[24:27]
    v_mfma_f32_16x16x32_bf16 v[36:39], v[92:95], v[52:55], v[36:39]
    s_barrier
    s_waitcnt lgkmcnt(0)
    v_mfma_f32_16x16x32_bf16 v[16:19], v[96:99], v[56:59], v[16:19]
    ds_read_b128 v[40:43], v14 offset:8192
    ds_read_b128 v[44:47], v14 offset:10240
    v_mfma_f32_16x16x32_bf16 v[28:31], v[96:99], v[60:63], v[28:31]
    ds_read_b64_tr_b16 v[72:73], v8 offset:12288
    ds_read_b64_tr_b16 v[74:75], v8 offset:15360
    v_mfma_f32_16x16x32_bf16 v[20:23], v[100:103], v[56:59], v[20:23]
    ds_read_b64_tr_b16 v[76:77], v9 offset:12288
    ds_read_b64_tr_b16 v[78:79], v9 offset:15360
    v_mfma_f32_16x16x32_bf16 v[32:35], v[100:103], v[60:63], v[32:35]
    ds_read_b64_tr_b16 v[80:81], v10 offset:12288
    ds_read_b64_tr_b16 v[82:83], v10 offset:15360
    v_mfma_f32_16x16x32_bf16 v[24:27], v[104:107], v[56:59], v[24:27]
    ds_read_b128 v[48:51], v14 offset:9216
    ds_read_b128 v[52:55], v14 offset:11264
    v_mfma_f32_16x16x32_bf16 v[36:39], v[104:107], v[60:63], v[36:39]
    ds_read_b64_tr_b16 v[84:85], v8 offset:18432
    ds_read_b64_tr_b16 v[86:87], v8 offset:21504
    v_mfma_f32_16x16x32_bf16 v[16:19], v[108:111], v[64:67], v[16:19]
    ds_read_b64_tr_b16 v[88:89], v9 offset:18432
    ds_read_b64_tr_b16 v[90:91], v9 offset:21504
    v_mfma_f32_16x16x32_bf16 v[28:31], v[108:111], v[68:71], v[28:31]
    ds_read_b64_tr_b16 v[92:93], v10 offset:18432
    ds_read_b64_tr_b16 v[94:95], v10 offset:21504
    v_mfma_f32_16x16x32_bf16 v[20:23], v[112:115], v[64:67], v[20:23]
    v_mfma_f32_16x16x32_bf16 v[32:35], v[112:115], v[68:71], v[32:35]
    v_mfma_f32_16x16x32_bf16 v[24:27], v[116:119], v[64:67], v[24:27]
    v_mfma_f32_16x16x32_bf16 v[36:39], v[116:119], v[68:71], v[36:39]
    s_barrier
    s_waitcnt lgkmcnt(0)
    v_mfma_f32_16x16x32_bf16 v[16:19], v[72:75], v[40:43], v[16:19]
    ds_read_b128 v[56:59], v14 offset:0
    ds_read_b128 v[60:63], v14 offset:2048
    v_mfma_f32_16x16x32_bf16 v[28:31], v[72:75], v[44:47], v[28:31]
    ds_read_b64_tr_b16 v[96:97], v8 offset:0
    ds_read_b64_tr_b16 v[98:99], v8 offset:3072
    v_mfma_f32_16x16x32_bf16 v[20:23], v[76:79], v[40:43], v[20:23]
    ds_read_b64_tr_b16 v[100:101], v9 offset:0
    ds_read_b64_tr_b16 v[102:103], v9 offset:3072
    v_mfma_f32_16x16x32_bf16 v[32:35], v[76:79], v[44:47], v[32:35]
    ds_read_b64_tr_b16 v[104:105], v10 offset:0
    ds_read_b64_tr_b16 v[106:107], v10 offset:3072
    v_mfma_f32_16x16x32_bf16 v[24:27], v[80:83], v[40:43], v[24:27]
    ds_read_b128 v[64:67], v14 offset:1024
    ds_read_b128 v[68:71], v14 offset:3072
    v_mfma_f32_16x16x32_bf16 v[36:39], v[80:83], v[44:47], v[36:39]
    ds_read_b64_tr_b16 v[108:109], v8 offset:6144
    ds_read_b64_tr_b16 v[110:111], v8 offset:9216
    v_mfma_f32_16x16x32_bf16 v[16:19], v[84:87], v[48:51], v[16:19]
    ds_read_b64_tr_b16 v[112:113], v9 offset:6144
    ds_read_b64_tr_b16 v[114:115], v9 offset:9216
    v_mfma_f32_16x16x32_bf16 v[28:31], v[84:87], v[52:55], v[28:31]
    ds_read_b64_tr_b16 v[116:117], v10 offset:6144
    ds_read_b64_tr_b16 v[118:119], v10 offset:9216
    v_mfma_f32_16x16x32_bf16 v[20:23], v[88:91], v[48:51], v[20:23]
    v_mfma_f32_16x16x32_bf16 v[32:35], v[88:91], v[52:55], v[32:35]
    v_mfma_f32_16x16x32_bf16 v[24:27], v[92:95], v[48:51], v[24:27]
    v_mfma_f32_16x16x32_bf16 v[36:39], v[92:95], v[52:55], v[36:39]
    s_barrier
    s_waitcnt lgkmcnt(0)
    v_mfma_f32_16x16x32_bf16 v[16:19], v[96:99], v[56:59], v[16:19]
    ds_read_b64 v[40:41], v15 offset:40960
    ds_read_b64 v[42:43], v15 offset:41472
    ds_read_b64 v[44:45], v15 offset:43008
    v_mfma_f32_16x16x32_bf16 v[28:31], v[96:99], v[60:63], v[28:31]
    ds_read_b64 v[46:47], v15 offset:43520
    ds_read_b64_tr_b16 v[72:73], v11 offset:36864
    ds_read_b64_tr_b16 v[74:75], v11 offset:39936
    v_mfma_f32_16x16x32_bf16 v[20:23], v[100:103], v[56:59], v[20:23]
    ds_read_b64_tr_b16 v[76:77], v12 offset:36864
    ds_read_b64_tr_b16 v[78:79], v12 offset:39936
    ds_read_b64_tr_b16 v[80:81], v13 offset:36864
    v_mfma_f32_16x16x32_bf16 v[32:35], v[100:103], v[60:63], v[32:35]
    ds_read_b64_tr_b16 v[82:83], v13 offset:39936
    ds_read_b64 v[48:49], v15 offset:41984
    ds_read_b64 v[50:51], v15 offset:42496
    v_mfma_f32_16x16x32_bf16 v[24:27], v[104:107], v[56:59], v[24:27]
    ds_read_b64 v[52:53], v15 offset:44032
    ds_read_b64 v[54:55], v15 offset:44544
    ds_read_b64_tr_b16 v[84:85], v11 offset:43008
    v_mfma_f32_16x16x32_bf16 v[36:39], v[104:107], v[60:63], v[36:39]
    ds_read_b64_tr_b16 v[86:87], v11 offset:46080
    ds_read_b64_tr_b16 v[88:89], v12 offset:43008
    ds_read_b64_tr_b16 v[90:91], v12 offset:46080
    v_mfma_f32_16x16x32_bf16 v[16:19], v[108:111], v[64:67], v[16:19]
    ds_read_b64_tr_b16 v[92:93], v13 offset:43008
    ds_read_b64_tr_b16 v[94:95], v13 offset:46080
    s_waitcnt vmcnt(0)
    v_mfma_f32_16x16x32_bf16 v[28:31], v[108:111], v[68:71], v[28:31]
    v_permlane16_swap_b32 v120, v122
    v_permlane16_swap_b32 v121, v123
    v_lshlrev_b32 v136, 16, v120
    v_mfma_f32_16x16x32_bf16 v[20:23], v[112:115], v[64:67], v[20:23]
    v_and_b32 v137, 0xffff0000, v120
    v_lshlrev_b32 v138, 16, v121
    v_mfma_f32_16x16x32_bf16 v[32:35], v[112:115], v[68:71], v[32:35]
    v_mfma_f32_16x16x32_bf16 v[24:27], v[116:119], v[64:67], v[24:27]
    v_mfma_f32_16x16x32_bf16 v[36:39], v[116:119], v[68:71], v[36:39]
    s_barrier
    s_waitcnt lgkmcnt(0)
    v_pk_mul_f32 v[16:17], v[16:17], v[132:133] op_sel_hi:[1,0]
    v_pk_mul_f32 v[18:19], v[18:19], v[132:133] op_sel_hi:[1,0]
    v_pk_mul_f32 v[20:21], v[20:21], v[132:133] op_sel_hi:[1,0]
    v_pk_mul_f32 v[22:23], v[22:23], v[132:133] op_sel_hi:[1,0]
    s_nop 0
    v_pk_mul_f32 v[24:25], v[24:25], v[132:133] op_sel_hi:[1,0]
    v_pk_mul_f32 v[26:27], v[26:27], v[132:133] op_sel_hi:[1,0]
    v_pk_mul_f32 v[28:29], v[28:29], v[134:135] op_sel_hi:[1,0]
    v_pk_mul_f32 v[30:31], v[30:31], v[134:135] op_sel_hi:[1,0]
    v_pk_mul_f32 v[32:33], v[32:33], v[134:135] op_sel_hi:[1,0]
    v_pk_mul_f32 v[34:35], v[34:35], v[134:135] op_sel_hi:[1,0]
    v_pk_mul_f32 v[36:37], v[36:37], v[134:135] op_sel_hi:[1,0]
    v_pk_mul_f32 v[38:39], v[38:39], v[134:135] op_sel_hi:[1,0]
    v_mfma_f32_16x16x32_bf16 v[16:19], v[72:75], v[40:43], v[16:19]
    ds_read_b64 v[56:57], v15 offset:32768
    ds_read_b64 v[58:59], v15 offset:33280
    ds_read_b64 v[60:61], v15 offset:34816
    v_mfma_f32_16x16x32_bf16 v[28:31], v[72:75], v[44:47], v[28:31]
    ds_read_b64 v[62:63], v15 offset:35328
    ds_read_b64_tr_b16 v[96:97], v11 offset:24576
    ds_read_b64_tr_b16 v[98:99], v11 offset:27648
    v_mfma_f32_16x16x32_bf16 v[20:23], v[76:79], v[40:43], v[20:23]
    ds_read_b64_tr_b16 v[100:101], v12 offset:24576
    ds_read_b64_tr_b16 v[102:103], v12 offset:27648
    ds_read_b64_tr_b16 v[104:105], v13 offset:24576
    v_mfma_f32_16x16x32_bf16 v[32:35], v[76:79], v[44:47], v[32:35]
    ds_read_b64_tr_b16 v[106:107], v13 offset:27648
    ds_read_b64 v[64:65], v15 offset:33792
    ds_read_b64 v[66:67], v15 offset:34304
    v_mfma_f32_16x16x32_bf16 v[24:27], v[80:83], v[40:43], v[24:27]
    ds_read_b64 v[68:69], v15 offset:35840
    ds_read_b64 v[70:71], v15 offset:36352
    ds_read_b64_tr_b16 v[108:109], v11 offset:30720
    v_mfma_f32_16x16x32_bf16 v[36:39], v[80:83], v[44:47], v[36:39]
    ds_read_b64_tr_b16 v[110:111], v11 offset:33792
    ds_read_b64_tr_b16 v[112:113], v12 offset:30720
    ds_read_b64_tr_b16 v[114:115], v12 offset:33792
    v_mfma_f32_16x16x32_bf16 v[16:19], v[84:87], v[48:51], v[16:19]
    ds_read_b64_tr_b16 v[116:117], v13 offset:30720
    ds_read_b64_tr_b16 v[118:119], v13 offset:33792
    v_and_b32 v139, 0xffff0000, v121
    v_mfma_f32_16x16x32_bf16 v[28:31], v[84:87], v[52:55], v[28:31]
    v_lshlrev_b32 v140, 16, v122
    v_and_b32 v141, 0xffff0000, v122
    v_lshlrev_b32 v142, 16, v123
    v_mfma_f32_16x16x32_bf16 v[20:23], v[88:91], v[48:51], v[20:23]
    v_and_b32 v143, 0xffff0000, v123
    v_mfma_f32_16x16x32_bf16 v[32:35], v[88:91], v[52:55], v[32:35]
    v_mfma_f32_16x16x32_bf16 v[24:27], v[92:95], v[48:51], v[24:27]
    v_mfma_f32_16x16x32_bf16 v[36:39], v[92:95], v[52:55], v[36:39]
    s_barrier
    s_waitcnt lgkmcnt(0)
    v_mfma_f32_16x16x32_bf16 v[16:19], v[96:99], v[56:59], v[16:19]
    ds_read_b64 v[40:41], v15 offset:24576
    ds_read_b64 v[42:43], v15 offset:25088
    ds_read_b64 v[44:45], v15 offset:26624
    v_mfma_f32_16x16x32_bf16 v[28:31], v[96:99], v[60:63], v[28:31]
    ds_read_b64 v[46:47], v15 offset:27136
    ds_read_b64_tr_b16 v[72:73], v11 offset:12288
    ds_read_b64_tr_b16 v[74:75], v11 offset:15360
    v_mfma_f32_16x16x32_bf16 v[20:23], v[100:103], v[56:59], v[20:23]
    ds_read_b64_tr_b16 v[76:77], v12 offset:12288
    ds_read_b64_tr_b16 v[78:79], v12 offset:15360
    ds_read_b64_tr_b16 v[80:81], v13 offset:12288
    v_mfma_f32_16x16x32_bf16 v[32:35], v[100:103], v[60:63], v[32:35]
    ds_read_b64_tr_b16 v[82:83], v13 offset:15360
    ds_read_b64 v[48:49], v15 offset:25600
    ds_read_b64 v[50:51], v15 offset:26112
    v_mfma_f32_16x16x32_bf16 v[24:27], v[104:107], v[56:59], v[24:27]
    ds_read_b64 v[52:53], v15 offset:27648
    ds_read_b64 v[54:55], v15 offset:28160
    ds_read_b64_tr_b16 v[84:85], v11 offset:18432
    v_mfma_f32_16x16x32_bf16 v[36:39], v[104:107], v[60:63], v[36:39]
    ds_read_b64_tr_b16 v[86:87], v11 offset:21504
    ds_read_b64_tr_b16 v[88:89], v12 offset:18432
    ds_read_b64_tr_b16 v[90:91], v12 offset:21504
    v_mfma_f32_16x16x32_bf16 v[16:19], v[108:111], v[64:67], v[16:19]
    ds_read_b64_tr_b16 v[92:93], v13 offset:18432
    ds_read_b64_tr_b16 v[94:95], v13 offset:21504
    v_permlane16_swap_b32 v124, v126
    v_mfma_f32_16x16x32_bf16 v[28:31], v[108:111], v[68:71], v[28:31]
    v_permlane16_swap_b32 v125, v127
    v_lshlrev_b32 v148, 16, v124
    v_and_b32 v149, 0xffff0000, v124
    v_mfma_f32_16x16x32_bf16 v[20:23], v[112:115], v[64:67], v[20:23]
    v_lshlrev_b32 v150, 16, v125
    v_mfma_f32_16x16x32_bf16 v[32:35], v[112:115], v[68:71], v[32:35]
    v_mfma_f32_16x16x32_bf16 v[24:27], v[116:119], v[64:67], v[24:27]
    v_mfma_f32_16x16x32_bf16 v[36:39], v[116:119], v[68:71], v[36:39]
    s_barrier
    s_waitcnt lgkmcnt(0)
    v_mfma_f32_16x16x32_bf16 v[16:19], v[72:75], v[40:43], v[16:19]
    ds_read_b64 v[56:57], v15 offset:16384
    ds_read_b64 v[58:59], v15 offset:16896
    ds_read_b64 v[60:61], v15 offset:18432
    v_mfma_f32_16x16x32_bf16 v[28:31], v[72:75], v[44:47], v[28:31]
    ds_read_b64 v[62:63], v15 offset:18944
    ds_read_b64_tr_b16 v[96:97], v11 offset:0
    ds_read_b64_tr_b16 v[98:99], v11 offset:3072
    v_mfma_f32_16x16x32_bf16 v[20:23], v[76:79], v[40:43], v[20:23]
    ds_read_b64_tr_b16 v[100:101], v12 offset:0
    ds_read_b64_tr_b16 v[102:103], v12 offset:3072
    ds_read_b64_tr_b16 v[104:105], v13 offset:0
    v_mfma_f32_16x16x32_bf16 v[32:35], v[76:79], v[44:47], v[32:35]
    ds_read_b64_tr_b16 v[106:107], v13 offset:3072
    ds_read_b64 v[64:65], v15 offset:17408
    ds_read_b64 v[66:67], v15 offset:17920
    v_mfma_f32_16x16x32_bf16 v[24:27], v[80:83], v[40:43], v[24:27]
    ds_read_b64 v[68:69], v15 offset:19456
    ds_read_b64 v[70:71], v15 offset:19968
    ds_read_b64_tr_b16 v[108:109], v11 offset:6144
    v_mfma_f32_16x16x32_bf16 v[36:39], v[80:83], v[44:47], v[36:39]
    ds_read_b64_tr_b16 v[110:111], v11 offset:9216
    ds_read_b64_tr_b16 v[112:113], v12 offset:6144
    ds_read_b64_tr_b16 v[114:115], v12 offset:9216
    v_mfma_f32_16x16x32_bf16 v[16:19], v[84:87], v[48:51], v[16:19]
    ds_read_b64_tr_b16 v[116:117], v13 offset:6144
    ds_read_b64_tr_b16 v[118:119], v13 offset:9216
    v_and_b32 v151, 0xffff0000, v125
    v_mfma_f32_16x16x32_bf16 v[28:31], v[84:87], v[52:55], v[28:31]
    v_lshlrev_b32 v152, 16, v126
    v_and_b32 v153, 0xffff0000, v126
    v_lshlrev_b32 v154, 16, v127
    v_mfma_f32_16x16x32_bf16 v[20:23], v[88:91], v[48:51], v[20:23]
    v_and_b32 v155, 0xffff0000, v127
    v_mfma_f32_16x16x32_bf16 v[32:35], v[88:91], v[52:55], v[32:35]
    v_mfma_f32_16x16x32_bf16 v[24:27], v[92:95], v[48:51], v[24:27]
    v_mfma_f32_16x16x32_bf16 v[36:39], v[92:95], v[52:55], v[36:39]
    s_barrier
    s_waitcnt lgkmcnt(0)
    v_mfma_f32_16x16x32_bf16 v[16:19], v[96:99], v[56:59], v[16:19]
    ds_read_b64 v[40:41], v15 offset:8192
    ds_read_b64 v[42:43], v15 offset:8704
    ds_read_b64 v[44:45], v15 offset:10240
    v_mfma_f32_16x16x32_bf16 v[28:31], v[96:99], v[60:63], v[28:31]
    ds_read_b64 v[46:47], v15 offset:10752
    ds_read_b64_tr_b16 v[72:73], v8 offset:36864
    ds_read_b64_tr_b16 v[74:75], v8 offset:39936
    v_mfma_f32_16x16x32_bf16 v[20:23], v[100:103], v[56:59], v[20:23]
    ds_read_b64_tr_b16 v[76:77], v9 offset:36864
    ds_read_b64_tr_b16 v[78:79], v9 offset:39936
    ds_read_b64_tr_b16 v[80:81], v10 offset:36864
    v_mfma_f32_16x16x32_bf16 v[32:35], v[100:103], v[60:63], v[32:35]
    ds_read_b64_tr_b16 v[82:83], v10 offset:39936
    ds_read_b64 v[48:49], v15 offset:9216
    ds_read_b64 v[50:51], v15 offset:9728
    v_mfma_f32_16x16x32_bf16 v[24:27], v[104:107], v[56:59], v[24:27]
    ds_read_b64 v[52:53], v15 offset:11264
    ds_read_b64 v[54:55], v15 offset:11776
    ds_read_b64_tr_b16 v[84:85], v8 offset:43008
    v_mfma_f32_16x16x32_bf16 v[36:39], v[104:107], v[60:63], v[36:39]
    ds_read_b64_tr_b16 v[86:87], v8 offset:46080
    ds_read_b64_tr_b16 v[88:89], v9 offset:43008
    ds_read_b64_tr_b16 v[90:91], v9 offset:46080
    v_mfma_f32_16x16x32_bf16 v[16:19], v[108:111], v[64:67], v[16:19]
    ds_read_b64_tr_b16 v[92:93], v10 offset:43008
    ds_read_b64_tr_b16 v[94:95], v10 offset:46080
    v_permlane16_swap_b32 v128, v130
    v_mfma_f32_16x16x32_bf16 v[28:31], v[108:111], v[68:71], v[28:31]
    v_permlane16_swap_b32 v129, v131
    v_lshlrev_b32 v144, 16, v128
    v_and_b32 v145, 0xffff0000, v128
    v_mfma_f32_16x16x32_bf16 v[20:23], v[112:115], v[64:67], v[20:23]
    v_lshlrev_b32 v146, 16, v129
    v_mfma_f32_16x16x32_bf16 v[32:35], v[112:115], v[68:71], v[32:35]
    v_mfma_f32_16x16x32_bf16 v[24:27], v[116:119], v[64:67], v[24:27]
    v_mfma_f32_16x16x32_bf16 v[36:39], v[116:119], v[68:71], v[36:39]
    s_barrier
    s_waitcnt lgkmcnt(0)
    v_mfma_f32_16x16x32_bf16 v[16:19], v[72:75], v[40:43], v[16:19]
    ds_read_b64 v[56:57], v15 offset:0
    ds_read_b64 v[58:59], v15 offset:512
    ds_read_b64 v[60:61], v15 offset:2048
    v_mfma_f32_16x16x32_bf16 v[28:31], v[72:75], v[44:47], v[28:31]
    ds_read_b64 v[62:63], v15 offset:2560
    ds_read_b64_tr_b16 v[96:97], v8 offset:24576
    ds_read_b64_tr_b16 v[98:99], v8 offset:27648
    v_mfma_f32_16x16x32_bf16 v[20:23], v[76:79], v[40:43], v[20:23]
    ds_read_b64_tr_b16 v[100:101], v9 offset:24576
    ds_read_b64_tr_b16 v[102:103], v9 offset:27648
    ds_read_b64_tr_b16 v[104:105], v10 offset:24576
    v_mfma_f32_16x16x32_bf16 v[32:35], v[76:79], v[44:47], v[32:35]
    ds_read_b64_tr_b16 v[106:107], v10 offset:27648
    ds_read_b64 v[64:65], v15 offset:1024
    ds_read_b64 v[66:67], v15 offset:1536
    v_mfma_f32_16x16x32_bf16 v[24:27], v[80:83], v[40:43], v[24:27]
    ds_read_b64 v[68:69], v15 offset:3072
    ds_read_b64 v[70:71], v15 offset:3584
    ds_read_b64_tr_b16 v[108:109], v8 offset:30720
    v_mfma_f32_16x16x32_bf16 v[36:39], v[80:83], v[44:47], v[36:39]
    ds_read_b64_tr_b16 v[110:111], v8 offset:33792
    ds_read_b64_tr_b16 v[112:113], v9 offset:30720
    ds_read_b64_tr_b16 v[114:115], v9 offset:33792
    v_mfma_f32_16x16x32_bf16 v[16:19], v[84:87], v[48:51], v[16:19]
    ds_read_b64_tr_b16 v[116:117], v10 offset:30720
    ds_read_b64_tr_b16 v[118:119], v10 offset:33792
    v_and_b32 v147, 0xffff0000, v129
    v_mfma_f32_16x16x32_bf16 v[28:31], v[84:87], v[52:55], v[28:31]
    v_lshlrev_b32 v156, 16, v130
    v_and_b32 v157, 0xffff0000, v130
    v_lshlrev_b32 v158, 16, v131
    v_mfma_f32_16x16x32_bf16 v[20:23], v[88:91], v[48:51], v[20:23]
    v_and_b32 v159, 0xffff0000, v131
    v_mfma_f32_16x16x32_bf16 v[32:35], v[88:91], v[52:55], v[32:35]
    v_mfma_f32_16x16x32_bf16 v[24:27], v[92:95], v[48:51], v[24:27]
    v_mfma_f32_16x16x32_bf16 v[36:39], v[92:95], v[52:55], v[36:39]
    s_barrier
    s_waitcnt lgkmcnt(0)
    v_mfma_f32_16x16x32_bf16 v[16:19], v[96:99], v[56:59], v[16:19]
    ds_read_b64 v[40:41], v15 offset:40960
    ds_read_b64 v[42:43], v15 offset:41472
    v_mfma_f32_16x16x32_bf16 v[28:31], v[96:99], v[60:63], v[28:31]
    ds_read_b64 v[44:45], v15 offset:43008
    ds_read_b64 v[46:47], v15 offset:43520
    v_mfma_f32_16x16x32_bf16 v[20:23], v[100:103], v[56:59], v[20:23]
    ds_read_b64_tr_b16 v[72:73], v8 offset:12288
    ds_read_b64_tr_b16 v[74:75], v8 offset:15360
    v_mfma_f32_16x16x32_bf16 v[32:35], v[100:103], v[60:63], v[32:35]
    ds_read_b64_tr_b16 v[76:77], v9 offset:12288
    ds_read_b64_tr_b16 v[78:79], v9 offset:15360
    v_mfma_f32_16x16x32_bf16 v[24:27], v[104:107], v[56:59], v[24:27]
    ds_read_b64_tr_b16 v[80:81], v10 offset:12288
    ds_read_b64_tr_b16 v[82:83], v10 offset:15360
    v_mfma_f32_16x16x32_bf16 v[36:39], v[104:107], v[60:63], v[36:39]
    ds_read_b64 v[48:49], v15 offset:41984
    ds_read_b64 v[50:51], v15 offset:42496
    v_mfma_f32_16x16x32_bf16 v[16:19], v[108:111], v[64:67], v[16:19]
    ds_read_b64 v[52:53], v15 offset:44032
    ds_read_b64 v[54:55], v15 offset:44544
    v_mfma_f32_16x16x32_bf16 v[28:31], v[108:111], v[68:71], v[28:31]
    ds_read_b64_tr_b16 v[84:85], v8 offset:18432
    ds_read_b64_tr_b16 v[86:87], v8 offset:21504
    v_mfma_f32_16x16x32_bf16 v[20:23], v[112:115], v[64:67], v[20:23]
    ds_read_b64_tr_b16 v[88:89], v9 offset:18432
    ds_read_b64_tr_b16 v[90:91], v9 offset:21504
    v_mfma_f32_16x16x32_bf16 v[32:35], v[112:115], v[68:71], v[32:35]
    ds_read_b64_tr_b16 v[92:93], v10 offset:18432
    ds_read_b64_tr_b16 v[94:95], v10 offset:21504
    v_mfma_f32_16x16x32_bf16 v[24:27], v[116:119], v[64:67], v[24:27]
    v_mfma_f32_16x16x32_bf16 v[36:39], v[116:119], v[68:71], v[36:39]
    s_barrier
    s_waitcnt lgkmcnt(0)
    v_mfma_f32_16x16x32_bf16 v[16:19], v[72:75], v[40:43], v[16:19]
    ds_read_b64 v[56:57], v15 offset:32768
    ds_read_b64 v[58:59], v15 offset:33280
    v_mfma_f32_16x16x32_bf16 v[28:31], v[72:75], v[44:47], v[28:31]
    ds_read_b64 v[60:61], v15 offset:34816
    ds_read_b64 v[62:63], v15 offset:35328
    v_mfma_f32_16x16x32_bf16 v[20:23], v[76:79], v[40:43], v[20:23]
    ds_read_b64_tr_b16 v[96:97], v8 offset:0
    ds_read_b64_tr_b16 v[98:99], v8 offset:3072
    v_mfma_f32_16x16x32_bf16 v[32:35], v[76:79], v[44:47], v[32:35]
    ds_read_b64_tr_b16 v[100:101], v9 offset:0
    ds_read_b64_tr_b16 v[102:103], v9 offset:3072
    v_mfma_f32_16x16x32_bf16 v[24:27], v[80:83], v[40:43], v[24:27]
    ds_read_b64_tr_b16 v[104:105], v10 offset:0
    ds_read_b64_tr_b16 v[106:107], v10 offset:3072
    v_mfma_f32_16x16x32_bf16 v[36:39], v[80:83], v[44:47], v[36:39]
    ds_read_b64 v[64:65], v15 offset:33792
    ds_read_b64 v[66:67], v15 offset:34304
    v_mfma_f32_16x16x32_bf16 v[16:19], v[84:87], v[48:51], v[16:19]
    ds_read_b64 v[68:69], v15 offset:35840
    ds_read_b64 v[70:71], v15 offset:36352
    v_mfma_f32_16x16x32_bf16 v[28:31], v[84:87], v[52:55], v[28:31]
    ds_read_b64_tr_b16 v[108:109], v8 offset:6144
    ds_read_b64_tr_b16 v[110:111], v8 offset:9216
    v_mfma_f32_16x16x32_bf16 v[20:23], v[88:91], v[48:51], v[20:23]
    ds_read_b64_tr_b16 v[112:113], v9 offset:6144
    ds_read_b64_tr_b16 v[114:115], v9 offset:9216
    v_mfma_f32_16x16x32_bf16 v[32:35], v[88:91], v[52:55], v[32:35]
    ds_read_b64_tr_b16 v[116:117], v10 offset:6144
    ds_read_b64_tr_b16 v[118:119], v10 offset:9216
    v_mfma_f32_16x16x32_bf16 v[24:27], v[92:95], v[48:51], v[24:27]
    v_mfma_f32_16x16x32_bf16 v[36:39], v[92:95], v[52:55], v[36:39]
    s_barrier
    s_waitcnt lgkmcnt(0)
    v_mfma_f32_16x16x32_bf16 v[16:19], v[96:99], v[56:59], v[16:19]
    ds_read_b64 v[40:41], v15 offset:24576
    ds_read_b64 v[42:43], v15 offset:25088
    v_mfma_f32_16x16x32_bf16 v[28:31], v[96:99], v[60:63], v[28:31]
    ds_read_b64 v[44:45], v15 offset:26624
    ds_read_b64 v[46:47], v15 offset:27136
    v_mfma_f32_16x16x32_bf16 v[20:23], v[100:103], v[56:59], v[20:23]
    ds_read_b64_tr_b16 v[72:73], v11 offset:36864
    ds_read_b64_tr_b16 v[74:75], v11 offset:39936
    v_mfma_f32_16x16x32_bf16 v[32:35], v[100:103], v[60:63], v[32:35]
    ds_read_b64_tr_b16 v[76:77], v12 offset:36864
    ds_read_b64_tr_b16 v[78:79], v12 offset:39936
    v_mfma_f32_16x16x32_bf16 v[24:27], v[104:107], v[56:59], v[24:27]
    ds_read_b64_tr_b16 v[80:81], v13 offset:36864
    ds_read_b64_tr_b16 v[82:83], v13 offset:39936
    v_mfma_f32_16x16x32_bf16 v[36:39], v[104:107], v[60:63], v[36:39]
    ds_read_b64 v[48:49], v15 offset:25600
    ds_read_b64 v[50:51], v15 offset:26112
    v_mfma_f32_16x16x32_bf16 v[16:19], v[108:111], v[64:67], v[16:19]
    ds_read_b64 v[52:53], v15 offset:27648
    ds_read_b64 v[54:55], v15 offset:28160
    v_mfma_f32_16x16x32_bf16 v[28:31], v[108:111], v[68:71], v[28:31]
    ds_read_b64_tr_b16 v[84:85], v11 offset:43008
    ds_read_b64_tr_b16 v[86:87], v11 offset:46080
    v_mfma_f32_16x16x32_bf16 v[20:23], v[112:115], v[64:67], v[20:23]
    ds_read_b64_tr_b16 v[88:89], v12 offset:43008
    ds_read_b64_tr_b16 v[90:91], v12 offset:46080
    v_mfma_f32_16x16x32_bf16 v[32:35], v[112:115], v[68:71], v[32:35]
    ds_read_b64_tr_b16 v[92:93], v13 offset:43008
    ds_read_b64_tr_b16 v[94:95], v13 offset:46080
    v_mfma_f32_16x16x32_bf16 v[24:27], v[116:119], v[64:67], v[24:27]
    v_mfma_f32_16x16x32_bf16 v[36:39], v[116:119], v[68:71], v[36:39]
    s_barrier
    s_waitcnt lgkmcnt(0)
    v_mfma_f32_16x16x32_bf16 v[16:19], v[72:75], v[40:43], v[16:19]
    ds_read_b64 v[56:57], v15 offset:16384
    ds_read_b64 v[58:59], v15 offset:16896
    v_mfma_f32_16x16x32_bf16 v[28:31], v[72:75], v[44:47], v[28:31]
    ds_read_b64 v[60:61], v15 offset:18432
    ds_read_b64 v[62:63], v15 offset:18944
    v_mfma_f32_16x16x32_bf16 v[20:23], v[76:79], v[40:43], v[20:23]
    ds_read_b64_tr_b16 v[96:97], v11 offset:24576
    ds_read_b64_tr_b16 v[98:99], v11 offset:27648
    v_mfma_f32_16x16x32_bf16 v[32:35], v[76:79], v[44:47], v[32:35]
    ds_read_b64_tr_b16 v[100:101], v12 offset:24576
    ds_read_b64_tr_b16 v[102:103], v12 offset:27648
    v_mfma_f32_16x16x32_bf16 v[24:27], v[80:83], v[40:43], v[24:27]
    ds_read_b64_tr_b16 v[104:105], v13 offset:24576
    ds_read_b64_tr_b16 v[106:107], v13 offset:27648
    v_mfma_f32_16x16x32_bf16 v[36:39], v[80:83], v[44:47], v[36:39]
    ds_read_b64 v[64:65], v15 offset:17408
    ds_read_b64 v[66:67], v15 offset:17920
    v_mfma_f32_16x16x32_bf16 v[16:19], v[84:87], v[48:51], v[16:19]
    ds_read_b64 v[68:69], v15 offset:19456
    ds_read_b64 v[70:71], v15 offset:19968
    v_mfma_f32_16x16x32_bf16 v[28:31], v[84:87], v[52:55], v[28:31]
    ds_read_b64_tr_b16 v[108:109], v11 offset:30720
    ds_read_b64_tr_b16 v[110:111], v11 offset:33792
    v_mfma_f32_16x16x32_bf16 v[20:23], v[88:91], v[48:51], v[20:23]
    ds_read_b64_tr_b16 v[112:113], v12 offset:30720
    ds_read_b64_tr_b16 v[114:115], v12 offset:33792
    v_mfma_f32_16x16x32_bf16 v[32:35], v[88:91], v[52:55], v[32:35]
    ds_read_b64_tr_b16 v[116:117], v13 offset:30720
    ds_read_b64_tr_b16 v[118:119], v13 offset:33792
    v_mfma_f32_16x16x32_bf16 v[24:27], v[92:95], v[48:51], v[24:27]
    v_mfma_f32_16x16x32_bf16 v[36:39], v[92:95], v[52:55], v[36:39]
    s_waitcnt lgkmcnt(0)
    v_mfma_f32_16x16x32_bf16 v[16:19], v[96:99], v[56:59], v[16:19]
    v_mfma_f32_16x16x32_bf16 v[28:31], v[96:99], v[60:63], v[28:31]
    v_mfma_f32_16x16x32_bf16 v[20:23], v[100:103], v[56:59], v[20:23]
    v_mfma_f32_16x16x32_bf16 v[32:35], v[100:103], v[60:63], v[32:35]
    v_mfma_f32_16x16x32_bf16 v[24:27], v[104:107], v[56:59], v[24:27]
    v_mfma_f32_16x16x32_bf16 v[36:39], v[104:107], v[60:63], v[36:39]
    v_mfma_f32_16x16x32_bf16 v[16:19], v[108:111], v[64:67], v[16:19]
    v_mfma_f32_16x16x32_bf16 v[28:31], v[108:111], v[68:71], v[28:31]
    v_mfma_f32_16x16x32_bf16 v[20:23], v[112:115], v[64:67], v[20:23]
    v_mfma_f32_16x16x32_bf16 v[32:35], v[112:115], v[68:71], v[32:35]
    v_mfma_f32_16x16x32_bf16 v[24:27], v[116:119], v[64:67], v[24:27]
    v_mfma_f32_16x16x32_bf16 v[36:39], v[116:119], v[68:71], v[36:39]
    s_nop 2
    v_pk_add_f32 v[16:17], v[16:17], v[136:137]
    v_pk_add_f32 v[18:19], v[18:19], v[138:139]
    v_cvt_pk_bf16_f32 v40, v16, v17
    v_cvt_pk_bf16_f32 v41, v18, v19
    v_pk_add_f32 v[20:21], v[20:21], v[140:141]
    v_pk_add_f32 v[22:23], v[22:23], v[142:143]
    v_cvt_pk_bf16_f32 v42, v20, v21
    v_cvt_pk_bf16_f32 v43, v22, v23
    s_nop 0
    v_permlane16_swap_b32 v40, v42
    v_permlane16_swap_b32 v41, v43
    buffer_store_dwordx4 v[40:43], v6, s[48:51], s69 offen offset:0
    v_pk_add_f32 v[28:29], v[28:29], v[148:149]
    v_pk_add_f32 v[30:31], v[30:31], v[150:151]
    v_cvt_pk_bf16_f32 v44, v28, v29
    v_cvt_pk_bf16_f32 v45, v30, v31
    v_pk_add_f32 v[32:33], v[32:33], v[152:153]
    v_pk_add_f32 v[34:35], v[34:35], v[154:155]
    v_cvt_pk_bf16_f32 v46, v32, v33
    v_cvt_pk_bf16_f32 v47, v34, v35
    s_nop 0
    v_permlane16_swap_b32 v44, v46
    v_permlane16_swap_b32 v45, v47
    buffer_store_dwordx4 v[44:47], v6, s[48:51], s68 offen offset:0
    v_pk_add_f32 v[24:25], v[24:25], v[144:145]
    v_pk_add_f32 v[26:27], v[26:27], v[146:147]
    v_cvt_pk_bf16_f32 v48, v24, v25
    v_cvt_pk_bf16_f32 v49, v26, v27
    v_pk_add_f32 v[36:37], v[36:37], v[156:157]
    v_pk_add_f32 v[38:39], v[38:39], v[158:159]
    v_cvt_pk_bf16_f32 v50, v36, v37
    v_cvt_pk_bf16_f32 v51, v38, v39
    s_nop 0
    v_permlane16_swap_b32 v48, v50
    v_permlane16_swap_b32 v49, v51
    buffer_store_dwordx4 v[48:51], v7, s[48:51], s69 offen offset:64
    s_endpgm
L_end_a:
    s_endpgm
.section .rodata,"a"
.p2align 6
.amdhsa_kernel parallel_sum__sliding_local_dilated__dense_activation_relu__prompt_kernel
.amdhsa_next_free_vgpr 256
.amdhsa_next_free_sgpr 102
.amdhsa_accum_offset 256
.amdhsa_group_segment_fixed_size 0
.amdhsa_kernarg_size 72
.amdhsa_user_sgpr_count 2
.amdhsa_user_sgpr_kernarg_segment_ptr 1
.amdhsa_system_sgpr_workgroup_id_x 1
.end_amdhsa_kernel
```
